```python
import torch

def _softmax(x, axis=-1):
    return torch.softmax(x, dim=axis)

def _gelu(x):
    return torch.nn.functional.gelu(x, approximate='tanh')

def _silu(x):
    return torch.nn.functional.silu(x)

def _sigmoid(x):
    return torch.sigmoid(x)

def _layernorm(x, axis=-1, eps=1e-05):
    m = x.mean(dim=axis, keepdim=True)
    v = x.var(dim=axis, keepdim=True, unbiased=False)
    return (x - m) / torch.sqrt(v + eps)

def _scatter_add(tgt, idx, src, axis=0):
    return tgt.clone().index_add_(axis, idx, src)

def _segment_sum(src, seg, n):
    out = torch.zeros((n,) + src.shape[1:], dtype=src.dtype)
    return out.index_add_(0, seg, src)

def _pad(x, pw):
    flat = tuple((v for pair in reversed(pw) for v in pair))
    return torch.nn.functional.pad(x, flat)
kernel_name = 'adaLN_cond__spectral_gfnet__dense_activation_silu__prompt'

def setup_inputs():

    _w = lambda a: (lambda t: t.to(torch.bfloat16) if t.is_floating_point() else t)(torch.as_tensor(a))

    def _A_setup():
        B, S, D = (1, 2048, 448)
        Df = D // 2 + 1
        return {'x': _w((lambda *s: torch.randn(*s, dtype=torch.bfloat16) * 0.05)(B, S, D)), 'w_r': _w((lambda *s: torch.randn(*s, dtype=torch.bfloat16) * 1.6)(S, Df) * 0.02), 'w_i': _w((lambda *s: torch.randn(*s, dtype=torch.bfloat16) * 1.6)(S, Df) * 0.02)}
    _A_in = _A_setup()

    def _B_setup():
        B, S, D, F = (1, 2048, 448, 1792)
        return {'x': _w((lambda *s: torch.randn(*s, dtype=torch.bfloat16) * 0.05)(B, S, D)), 'w1': _w((lambda *s: torch.randn(*s, dtype=torch.bfloat16) * 0.8)(D, F) * D ** (-0.5)), 'w2': _w((lambda *s: torch.randn(*s, dtype=torch.bfloat16) * 0.2)(F, D) * F ** (-0.5))}
    _B_in = _B_setup()
    return {'A_x': _A_in['x'], 'A_w_r': _A_in['w_r'], 'A_w_i': _A_in['w_i'], 'B_x': _B_in['x'], 'B_w1': _B_in['w1'], 'B_w2': _B_in['w2'], 'c': _w((lambda *s: torch.randn(*s, dtype=torch.bfloat16) * 0.2)(1, 448) * 8.0), 'w_mod': _w((lambda *s: torch.randn(*s, dtype=torch.bfloat16) * 0.2)(448, 6 * 448) * 448 ** (-0.5) * 8.0)}

def reference(A_x, A_w_r, A_w_i, B_x, B_w1, B_w2, c, w_mod):

    def _A_ref(x, w_r, w_i):
        B, S, D = x.shape
        X = (lambda x, axes=(-2, -1): torch.fft.rfft2(x.float(), dim=axes))(x, axes=(-2, -1))
        W = w_r + 1j * w_i
        X = X * W
        y = (lambda x, s, axes=(-2, -1): torch.fft.irfft2(x, s=s, dim=axes).to(torch.bfloat16))(X, (S, D), axes=(-2, -1))
        return y

    def _B_ref(x, w1, w2):
        h = torch.einsum('bsd,df->bsf', x, w1)
        h = _silu(h)
        out = torch.einsum('bsf,fd->bsd', h, w2)
        return out
    x = A_x
    mod = (_silu(c) @ w_mod).reshape(c.shape[0], 6, 1, -1)
    sa, ca, ga, sb, cb, gb = (mod[:, 0].clone(), mod[:, 1].clone(), mod[:, 2].clone(), mod[:, 3].clone(), mod[:, 4].clone(), mod[:, 5].clone())
    h = _layernorm(x, axis=-1) * (1 + ca) + sa
    x = x + ga * _A_ref(h, A_w_r, A_w_i)
    h = _layernorm(x, axis=-1) * (1 + cb) + sb
    x = x + gb * _B_ref(h, B_w1, B_w2)
    return x
```

```asm
; @launch grid=(256,1,1) block=(256,1,1) lds=163840
.amdgcn_target "amdgcn-amd-amdhsa--gfx950"
.text
.globl adaLN_cond__spectral_gfnet__dense_activation_silu__prompt_kernel
.p2align 8
.type adaLN_cond__spectral_gfnet__dense_activation_silu__prompt_kernel,@function
adaLN_cond__spectral_gfnet__dense_activation_silu__prompt_kernel:
s_load_dwordx16 s[40:55], s[0:1], 0
s_load_dwordx4 s[56:59], s[0:1], 64
s_load_dwordx2 s[60:61], s[0:1], 80
s_cmp_ge_u32 s2, 8
s_cbranch_scc1 L_nocpf
v_cmp_gt_u32 vcc, 64, v0
s_nop 0
s_cbranch_vccnz L_nocpf
s_getpc_b64 s[4:5]
pc_1:
v_lshlrev_b32 v7, 4, v0
v_mov_b32 v249, s5
v_add_co_u32 v248, vcc, s4, v7
s_mov_b32 s6, (const_tbl-pc_1+38912)/3072
s_nop 0
v_addc_co_u32 v249, vcc, 0, v249, vcc
L_cpf:
global_load_dwordx4 v[244:247], v[248:249], off
v_add_co_u32 v248, vcc, 3072, v248
s_sub_u32 s6, s6, 1
s_nop 0
v_addc_co_u32 v249, vcc, 0, v249, vcc
s_cmp_lg_u32 s6, 0
s_cbranch_scc1 L_cpf
L_nocpf:
s_cmp_ge_u32 s2, 256
s_cbranch_scc1 L_end
v_lshrrev_b32 v1, 6, v0
s_mov_b32 s99, 0xffff0000
v_readfirstlane_b32 s62, v1
v_and_b32 v1, 63, v0
s_cmp_ge_u32 s62, 2
s_cbranch_scc1 L_top2
s_cmp_ge_u32 s2, 64
s_cbranch_scc1 L_top2
s_cmp_ge_u32 s2, 8
s_cbranch_scc1 L_top1
s_or_b32 s4, s2, s62
s_cmp_lg_u32 s4, 0
s_cbranch_scc1 L_top2
v_lshlrev_b32 v7, 4, v1
v_mov_b32 v20, 0
v_mov_b32 v21, 0
v_mov_b32 v22, 0
v_mov_b32 v23, 0
s_mov_b32 s6, 24576
s_mov_b32 s7, 28672
s_waitcnt lgkmcnt(0)
s_mov_b32 s12, s60
s_and_b32 s13, s61, 0xffff
s_mov_b32 s14, 25165824
s_mov_b32 s15, 0x20000
v_lshrrev_b32 v8, 3, v1
v_lshl_add_u32 v8, v8, 7, v7
buffer_store_dwordx4 v[20:23], v8, s[12:15], s6 offen offset:0 sc1
buffer_store_dwordx4 v[20:23], v8, s[12:15], s6 offen offset:2048 sc1
buffer_store_dwordx4 v[20:23], v8, s[12:15], s7 offen offset:0 sc1
buffer_store_dwordx4 v[20:23], v8, s[12:15], s7 offen offset:2048 sc1
s_add_u32 s6, s6, 40960
s_add_u32 s7, s7, 40960
buffer_store_dwordx4 v[20:23], v8, s[12:15], s6 offen offset:0 sc1
buffer_store_dwordx4 v[20:23], v8, s[12:15], s6 offen offset:2048 sc1
buffer_store_dwordx4 v[20:23], v8, s[12:15], s7 offen offset:0 sc1
buffer_store_dwordx4 v[20:23], v8, s[12:15], s7 offen offset:2048 sc1
v_mov_b32 v7, 192
s_mov_b64 exec, 1
v_mov_b32 v24, 1
s_waitcnt vmcnt(0)
global_store_dword v7, v24, s[58:59] sc1
s_mov_b64 exec, -1
s_branch L_top2
L_top1:
s_lshr_b32 s4, s2, 3
s_sub_u32 s4, s4, 1
s_bfe_u32 s6, s2, 0x20001
s_mul_i32 s6, s6, 7
s_add_u32 s6, s6, s4
s_and_b32 s76, s2, 1
s_mov_b32 s77, s6
s_lshl_b32 s4, s77, 7
s_mul_i32 s5, s76, 3584
s_add_u32 s4, s4, s5
s_add_u32 s75, s4, 36864
s_mul_i32 s5, s76, 224
s_cmp_eq_u32 s62, 0
s_cbranch_scc1 L_top3
v_mov_b32 v13, -1
v_lshlrev_b32 v14, 2, v1
s_waitcnt lgkmcnt(0)
s_mov_b32 s12, s60
s_and_b32 s13, s61, 0xffff
s_mov_b32 s14, 25165824
s_mov_b32 s15, 0x20000
s_mov_b32 exec_hi, 0
buffer_store_dword v13, v14, s[12:15], s75 offen sc1
s_lshl_b32 s4, s76, 7
v_mov_b32 v13, 0
v_mov_b32 v14, 1
s_mov_b64 exec, 1
s_waitcnt vmcnt(0)
global_atomic_add v16, v13, v14, s[58:59] sc0 sc1
s_mov_b64 exec, -1
s_branch L_top2
L_top3:
v_lshrrev_b32 v7, 2, v1
v_mul_u32_u24 v8, 75264, v7
v_and_b32 v9, 3, v1
v_lshl_add_u32 v8, v9, 4, v8
v_mul_u32_u24 v7, 28, v7
s_lshl_b32 s7, s5, 1
s_mul_i32 s5, s5, 5376
s_lshl_b32 s4, s6, 6
s_add_u32 s4, s4, s5
s_waitcnt lgkmcnt(0)
s_mov_b32 s32, s52
s_and_b32 s33, s53, 0xffff
s_mov_b32 s34, 896
s_mov_b32 s35, 0x20000
s_mov_b32 s28, s54
s_and_b32 s29, s55, 0xffff
s_mov_b32 s30, 2408448
s_mov_b32 s31, 0x20000
buffer_load_dwordx4 v[64:67], v7, s[32:35], s7 offen offset:0
buffer_load_dwordx3 v[68:70], v7, s[32:35], s7 offen offset:16
buffer_load_dwordx4 v[128:131], v8, s[28:31], s4 offen
s_add_u32 s4, s4, 5376
buffer_load_dwordx4 v[132:135], v8, s[28:31], s4 offen
s_add_u32 s4, s4, 5376
buffer_load_dwordx4 v[136:139], v8, s[28:31], s4 offen
s_add_u32 s4, s4, 5376
buffer_load_dwordx4 v[140:143], v8, s[28:31], s4 offen
s_add_u32 s4, s4, 5376
buffer_load_dwordx4 v[144:147], v8, s[28:31], s4 offen
s_add_u32 s4, s4, 5376
buffer_load_dwordx4 v[148:151], v8, s[28:31], s4 offen
s_add_u32 s4, s4, 5376
buffer_load_dwordx4 v[152:155], v8, s[28:31], s4 offen
s_add_u32 s4, s4, 5376
buffer_load_dwordx4 v[156:159], v8, s[28:31], s4 offen
s_add_u32 s4, s4, 5376
buffer_load_dwordx4 v[160:163], v8, s[28:31], s4 offen
s_add_u32 s4, s4, 5376
buffer_load_dwordx4 v[164:167], v8, s[28:31], s4 offen
s_add_u32 s4, s4, 5376
buffer_load_dwordx4 v[168:171], v8, s[28:31], s4 offen
s_add_u32 s4, s4, 5376
buffer_load_dwordx4 v[172:175], v8, s[28:31], s4 offen
s_add_u32 s4, s4, 5376
buffer_load_dwordx4 v[176:179], v8, s[28:31], s4 offen
s_add_u32 s4, s4, 5376
buffer_load_dwordx4 v[180:183], v8, s[28:31], s4 offen
L_top2:
s_lshr_b32 s4, s2, 3
s_max_u32 s7, s4, 4
s_sub_u32 s7, s7, 4
s_mul_i32 s5, s7, 37
s_lshr_b32 s5, s5, 8
s_mul_i32 s6, s5, 7
s_sub_u32 s63, s7, s6
s_and_b32 s80, s2, 7
s_lshl_b32 s6, s80, 2
s_add_u32 s96, s6, s5
s_lshr_b32 s6, s96, 1
s_lshl_b32 s6, s6, 7
s_and_b32 s5, s96, 1
s_lshl_b32 s5, s5, 4
s_add_u32 s97, s6, s5
s_sub_u32 s4, s4, 8
s_mul_i32 s81, s4, 86
s_lshr_b32 s81, s81, 8
s_mul_i32 s5, s81, 3
s_sub_u32 s82, s4, s5
s_lshl_b32 s4, s80, 8
s_lshl_b32 s5, s81, 2
s_add_u32 s4, s4, s5
s_lshr_b32 s5, s62, 1
s_lshl_b32 s5, s5, 7
s_add_u32 s4, s4, s5
s_and_b32 s39, s62, 1
s_lshl_b32 s5, s39, 1
s_add_u32 s4, s4, s5
s_mul_i32 s83, s4, 896
v_lshlrev_b32 v2, 3, v1
v_sub_u32 v3, 888, v2
v_cmp_gt_u32 vcc, 56, v1
v_mov_b32 v4, 0x40000000
s_nop 0
v_cndmask_b32 v5, v4, v2, vcc
v_cndmask_b32 v6, v4, v3, vcc
s_mul_i32 s4, s82, 5
s_lshr_b32 s5, s62, 1
s_mul_i32 s5, s5, 3
s_add_u32 s4, s4, s5
s_lshl_b32 s4, s4, 4
v_and_b32 v9, 15, v1
v_add_u32 v9, s4, v9
v_lshrrev_b32 v10, 4, v1
v_cvt_f32_u32 v11, s39
v_mul_f32 v11, 0x3e800000, v11
v_lshlrev_b32 v12, 4, v10
v_add_u32 v12, 1, v12
v_cvt_f32_u32 v12, v12
s_cmp_lt_u32 s2, 64
s_cbranch_scc1 L_not0
v_add_u32 v13, 0, v9
v_cvt_f32_u32 v13, v13
v_mul_f32 v13, 0x3a924925, v13
v_fma_f32 v14, v13, v12, v11
v_mul_f32 v202, 0x42800000, v13
v_cos_f32 v200, v202
v_add_f32 v202, v202, v14
v_add_f32 v13, v13, v13
v_add_f32 v200, v200, v200
v_cos_f32 v184, v14
v_cos_f32 v192, v202
v_add_f32 v14, v14, v13
v_add_f32 v202, v202, v13
v_cos_f32 v185, v14
v_cos_f32 v193, v202
v_add_f32 v14, v14, v13
v_add_f32 v202, v202, v13
v_cos_f32 v186, v14
v_cos_f32 v194, v202
v_add_f32 v14, v14, v13
v_add_f32 v202, v202, v13
v_cos_f32 v187, v14
v_cos_f32 v195, v202
v_add_f32 v14, v14, v13
v_add_f32 v202, v202, v13
v_cos_f32 v188, v14
v_cos_f32 v196, v202
v_add_f32 v14, v14, v13
v_add_f32 v202, v202, v13
v_cos_f32 v189, v14
v_cos_f32 v197, v202
v_add_f32 v14, v14, v13
v_add_f32 v202, v202, v13
v_cos_f32 v190, v14
v_cos_f32 v198, v202
v_add_f32 v14, v14, v13
v_add_f32 v202, v202, v13
v_cos_f32 v191, v14
v_cos_f32 v199, v202
v_cvt_pk_bf16_f32 v44, v184, v185
v_cvt_pk_bf16_f32 v45, v186, v187
v_cvt_pk_bf16_f32 v46, v188, v189
v_cvt_pk_bf16_f32 v47, v190, v191
v_cvt_pk_bf16_f32 v48, v192, v193
v_cvt_pk_bf16_f32 v49, v194, v195
v_cvt_pk_bf16_f32 v50, v196, v197
v_cvt_pk_bf16_f32 v51, v198, v199
v_pk_fma_f32 v[184:185], v[192:193], v[200:201], v[184:185] op_sel_hi:[1,0,1] neg_lo:[0,0,1] neg_hi:[0,0,1]
v_pk_fma_f32 v[186:187], v[194:195], v[200:201], v[186:187] op_sel_hi:[1,0,1] neg_lo:[0,0,1] neg_hi:[0,0,1]
v_pk_fma_f32 v[188:189], v[196:197], v[200:201], v[188:189] op_sel_hi:[1,0,1] neg_lo:[0,0,1] neg_hi:[0,0,1]
v_pk_fma_f32 v[190:191], v[198:199], v[200:201], v[190:191] op_sel_hi:[1,0,1] neg_lo:[0,0,1] neg_hi:[0,0,1]
v_cvt_pk_bf16_f32 v52, v184, v185
v_cvt_pk_bf16_f32 v53, v186, v187
v_cvt_pk_bf16_f32 v54, v188, v189
v_cvt_pk_bf16_f32 v55, v190, v191
v_pk_fma_f32 v[192:193], v[184:185], v[200:201], v[192:193] op_sel_hi:[1,0,1] neg_lo:[0,0,1] neg_hi:[0,0,1]
v_pk_fma_f32 v[194:195], v[186:187], v[200:201], v[194:195] op_sel_hi:[1,0,1] neg_lo:[0,0,1] neg_hi:[0,0,1]
v_pk_fma_f32 v[196:197], v[188:189], v[200:201], v[196:197] op_sel_hi:[1,0,1] neg_lo:[0,0,1] neg_hi:[0,0,1]
v_pk_fma_f32 v[198:199], v[190:191], v[200:201], v[198:199] op_sel_hi:[1,0,1] neg_lo:[0,0,1] neg_hi:[0,0,1]
v_cvt_pk_bf16_f32 v56, v192, v193
v_cvt_pk_bf16_f32 v57, v194, v195
v_cvt_pk_bf16_f32 v58, v196, v197
v_cvt_pk_bf16_f32 v59, v198, v199
v_pk_fma_f32 v[184:185], v[192:193], v[200:201], v[184:185] op_sel_hi:[1,0,1] neg_lo:[0,0,1] neg_hi:[0,0,1]
v_pk_fma_f32 v[186:187], v[194:195], v[200:201], v[186:187] op_sel_hi:[1,0,1] neg_lo:[0,0,1] neg_hi:[0,0,1]
v_pk_fma_f32 v[188:189], v[196:197], v[200:201], v[188:189] op_sel_hi:[1,0,1] neg_lo:[0,0,1] neg_hi:[0,0,1]
v_pk_fma_f32 v[190:191], v[198:199], v[200:201], v[190:191] op_sel_hi:[1,0,1] neg_lo:[0,0,1] neg_hi:[0,0,1]
v_cvt_pk_bf16_f32 v60, v184, v185
v_cvt_pk_bf16_f32 v61, v186, v187
v_cvt_pk_bf16_f32 v62, v188, v189
v_cvt_pk_bf16_f32 v63, v190, v191
v_pk_fma_f32 v[192:193], v[184:185], v[200:201], v[192:193] op_sel_hi:[1,0,1] neg_lo:[0,0,1] neg_hi:[0,0,1]
v_pk_fma_f32 v[194:195], v[186:187], v[200:201], v[194:195] op_sel_hi:[1,0,1] neg_lo:[0,0,1] neg_hi:[0,0,1]
v_pk_fma_f32 v[196:197], v[188:189], v[200:201], v[196:197] op_sel_hi:[1,0,1] neg_lo:[0,0,1] neg_hi:[0,0,1]
v_pk_fma_f32 v[198:199], v[190:191], v[200:201], v[198:199] op_sel_hi:[1,0,1] neg_lo:[0,0,1] neg_hi:[0,0,1]
v_cvt_pk_bf16_f32 v64, v192, v193
v_cvt_pk_bf16_f32 v65, v194, v195
v_cvt_pk_bf16_f32 v66, v196, v197
v_cvt_pk_bf16_f32 v67, v198, v199
v_pk_fma_f32 v[184:185], v[192:193], v[200:201], v[184:185] op_sel_hi:[1,0,1] neg_lo:[0,0,1] neg_hi:[0,0,1]
v_pk_fma_f32 v[186:187], v[194:195], v[200:201], v[186:187] op_sel_hi:[1,0,1] neg_lo:[0,0,1] neg_hi:[0,0,1]
v_pk_fma_f32 v[188:189], v[196:197], v[200:201], v[188:189] op_sel_hi:[1,0,1] neg_lo:[0,0,1] neg_hi:[0,0,1]
v_pk_fma_f32 v[190:191], v[198:199], v[200:201], v[190:191] op_sel_hi:[1,0,1] neg_lo:[0,0,1] neg_hi:[0,0,1]
v_cvt_pk_bf16_f32 v68, v184, v185
v_cvt_pk_bf16_f32 v69, v186, v187
v_cvt_pk_bf16_f32 v70, v188, v189
v_cvt_pk_bf16_f32 v71, v190, v191
L_not0:
s_waitcnt lgkmcnt(0)
s_mov_b32 s8, s40
s_and_b32 s9, s41, 0xffff
s_mov_b32 s10, 1835008
s_mov_b32 s11, 0x20000
s_mov_b32 s12, s60
s_and_b32 s13, s61, 0xffff
s_mov_b32 s14, 25165824
s_mov_b32 s15, 0x20000
s_sub_u32 s46, s2, 32
s_cselect_b32 s46, 224, s46
s_cmp_lt_u32 s2, 64
s_cbranch_scc1 L_service
s_add_u32 s5, s83, 0
buffer_load_dwordx2 v[128:129], v5, s[8:11], s5 offen
buffer_load_dwordx2 v[130:131], v6, s[8:11], s5 offen
s_add_u32 s5, s83, 28672
buffer_load_dwordx2 v[132:133], v5, s[8:11], s5 offen
buffer_load_dwordx2 v[134:135], v6, s[8:11], s5 offen
s_add_u32 s5, s83, 57344
buffer_load_dwordx2 v[136:137], v5, s[8:11], s5 offen
buffer_load_dwordx2 v[138:139], v6, s[8:11], s5 offen
s_add_u32 s5, s83, 86016
buffer_load_dwordx2 v[140:141], v5, s[8:11], s5 offen
buffer_load_dwordx2 v[142:143], v6, s[8:11], s5 offen
s_add_u32 s5, s83, 896
buffer_load_dwordx2 v[144:145], v5, s[8:11], s5 offen
buffer_load_dwordx2 v[146:147], v6, s[8:11], s5 offen
s_add_u32 s5, s83, 29568
buffer_load_dwordx2 v[148:149], v5, s[8:11], s5 offen
buffer_load_dwordx2 v[150:151], v6, s[8:11], s5 offen
s_add_u32 s5, s83, 58240
buffer_load_dwordx2 v[152:153], v5, s[8:11], s5 offen
buffer_load_dwordx2 v[154:155], v6, s[8:11], s5 offen
s_add_u32 s5, s83, 86912
buffer_load_dwordx2 v[156:157], v5, s[8:11], s5 offen
buffer_load_dwordx2 v[158:159], v6, s[8:11], s5 offen
v_add_u32 v13, 16, v9
v_cvt_f32_u32 v13, v13
v_mul_f32 v13, 0x3a924925, v13
v_fma_f32 v14, v13, v12, v11
v_mul_f32 v202, 0x42800000, v13
v_cos_f32 v200, v202
v_add_f32 v202, v202, v14
v_add_f32 v13, v13, v13
v_add_f32 v200, v200, v200
v_cos_f32 v184, v14
v_cos_f32 v192, v202
v_add_f32 v14, v14, v13
v_add_f32 v202, v202, v13
v_cos_f32 v185, v14
v_cos_f32 v193, v202
v_add_f32 v14, v14, v13
v_add_f32 v202, v202, v13
v_cos_f32 v186, v14
v_cos_f32 v194, v202
v_add_f32 v14, v14, v13
v_add_f32 v202, v202, v13
v_cos_f32 v187, v14
v_cos_f32 v195, v202
v_add_f32 v14, v14, v13
v_add_f32 v202, v202, v13
v_cos_f32 v188, v14
v_cos_f32 v196, v202
v_add_f32 v14, v14, v13
v_add_f32 v202, v202, v13
v_cos_f32 v189, v14
v_cos_f32 v197, v202
v_add_f32 v14, v14, v13
v_add_f32 v202, v202, v13
v_cos_f32 v190, v14
v_cos_f32 v198, v202
v_add_f32 v14, v14, v13
v_add_f32 v202, v202, v13
v_cos_f32 v191, v14
v_cos_f32 v199, v202
v_cvt_pk_bf16_f32 v72, v184, v185
v_cvt_pk_bf16_f32 v73, v186, v187
v_cvt_pk_bf16_f32 v74, v188, v189
v_cvt_pk_bf16_f32 v75, v190, v191
v_cvt_pk_bf16_f32 v76, v192, v193
v_cvt_pk_bf16_f32 v77, v194, v195
v_cvt_pk_bf16_f32 v78, v196, v197
v_cvt_pk_bf16_f32 v79, v198, v199
v_pk_fma_f32 v[184:185], v[192:193], v[200:201], v[184:185] op_sel_hi:[1,0,1] neg_lo:[0,0,1] neg_hi:[0,0,1]
v_pk_fma_f32 v[186:187], v[194:195], v[200:201], v[186:187] op_sel_hi:[1,0,1] neg_lo:[0,0,1] neg_hi:[0,0,1]
v_pk_fma_f32 v[188:189], v[196:197], v[200:201], v[188:189] op_sel_hi:[1,0,1] neg_lo:[0,0,1] neg_hi:[0,0,1]
v_pk_fma_f32 v[190:191], v[198:199], v[200:201], v[190:191] op_sel_hi:[1,0,1] neg_lo:[0,0,1] neg_hi:[0,0,1]
v_cvt_pk_bf16_f32 v80, v184, v185
v_cvt_pk_bf16_f32 v81, v186, v187
v_cvt_pk_bf16_f32 v82, v188, v189
v_cvt_pk_bf16_f32 v83, v190, v191
v_pk_fma_f32 v[192:193], v[184:185], v[200:201], v[192:193] op_sel_hi:[1,0,1] neg_lo:[0,0,1] neg_hi:[0,0,1]
v_pk_fma_f32 v[194:195], v[186:187], v[200:201], v[194:195] op_sel_hi:[1,0,1] neg_lo:[0,0,1] neg_hi:[0,0,1]
v_pk_fma_f32 v[196:197], v[188:189], v[200:201], v[196:197] op_sel_hi:[1,0,1] neg_lo:[0,0,1] neg_hi:[0,0,1]
v_pk_fma_f32 v[198:199], v[190:191], v[200:201], v[198:199] op_sel_hi:[1,0,1] neg_lo:[0,0,1] neg_hi:[0,0,1]
v_cvt_pk_bf16_f32 v84, v192, v193
v_cvt_pk_bf16_f32 v85, v194, v195
v_cvt_pk_bf16_f32 v86, v196, v197
v_cvt_pk_bf16_f32 v87, v198, v199
v_pk_fma_f32 v[184:185], v[192:193], v[200:201], v[184:185] op_sel_hi:[1,0,1] neg_lo:[0,0,1] neg_hi:[0,0,1]
v_pk_fma_f32 v[186:187], v[194:195], v[200:201], v[186:187] op_sel_hi:[1,0,1] neg_lo:[0,0,1] neg_hi:[0,0,1]
v_pk_fma_f32 v[188:189], v[196:197], v[200:201], v[188:189] op_sel_hi:[1,0,1] neg_lo:[0,0,1] neg_hi:[0,0,1]
v_pk_fma_f32 v[190:191], v[198:199], v[200:201], v[190:191] op_sel_hi:[1,0,1] neg_lo:[0,0,1] neg_hi:[0,0,1]
v_cvt_pk_bf16_f32 v88, v184, v185
v_cvt_pk_bf16_f32 v89, v186, v187
v_cvt_pk_bf16_f32 v90, v188, v189
v_cvt_pk_bf16_f32 v91, v190, v191
v_pk_fma_f32 v[192:193], v[184:185], v[200:201], v[192:193] op_sel_hi:[1,0,1] neg_lo:[0,0,1] neg_hi:[0,0,1]
v_pk_fma_f32 v[194:195], v[186:187], v[200:201], v[194:195] op_sel_hi:[1,0,1] neg_lo:[0,0,1] neg_hi:[0,0,1]
v_pk_fma_f32 v[196:197], v[188:189], v[200:201], v[196:197] op_sel_hi:[1,0,1] neg_lo:[0,0,1] neg_hi:[0,0,1]
v_pk_fma_f32 v[198:199], v[190:191], v[200:201], v[198:199] op_sel_hi:[1,0,1] neg_lo:[0,0,1] neg_hi:[0,0,1]
v_cvt_pk_bf16_f32 v92, v192, v193
v_cvt_pk_bf16_f32 v93, v194, v195
v_cvt_pk_bf16_f32 v94, v196, v197
v_cvt_pk_bf16_f32 v95, v198, v199
v_pk_fma_f32 v[184:185], v[192:193], v[200:201], v[184:185] op_sel_hi:[1,0,1] neg_lo:[0,0,1] neg_hi:[0,0,1]
v_pk_fma_f32 v[186:187], v[194:195], v[200:201], v[186:187] op_sel_hi:[1,0,1] neg_lo:[0,0,1] neg_hi:[0,0,1]
v_pk_fma_f32 v[188:189], v[196:197], v[200:201], v[188:189] op_sel_hi:[1,0,1] neg_lo:[0,0,1] neg_hi:[0,0,1]
v_pk_fma_f32 v[190:191], v[198:199], v[200:201], v[190:191] op_sel_hi:[1,0,1] neg_lo:[0,0,1] neg_hi:[0,0,1]
v_cvt_pk_bf16_f32 v96, v184, v185
v_cvt_pk_bf16_f32 v97, v186, v187
v_cvt_pk_bf16_f32 v98, v188, v189
v_cvt_pk_bf16_f32 v99, v190, v191
s_cmp_ge_u32 s62, 2
s_cbranch_scc1 L_tbl2
v_add_u32 v13, 32, v9
v_cvt_f32_u32 v13, v13
v_mul_f32 v13, 0x3a924925, v13
v_fma_f32 v14, v13, v12, v11
v_mul_f32 v202, 0x42800000, v13
v_cos_f32 v200, v202
v_add_f32 v202, v202, v14
v_add_f32 v13, v13, v13
v_add_f32 v200, v200, v200
v_cos_f32 v184, v14
v_cos_f32 v192, v202
v_add_f32 v14, v14, v13
v_add_f32 v202, v202, v13
v_cos_f32 v185, v14
v_cos_f32 v193, v202
v_add_f32 v14, v14, v13
v_add_f32 v202, v202, v13
v_cos_f32 v186, v14
v_cos_f32 v194, v202
v_add_f32 v14, v14, v13
v_add_f32 v202, v202, v13
v_cos_f32 v187, v14
v_cos_f32 v195, v202
v_add_f32 v14, v14, v13
v_add_f32 v202, v202, v13
v_cos_f32 v188, v14
v_cos_f32 v196, v202
v_add_f32 v14, v14, v13
v_add_f32 v202, v202, v13
v_cos_f32 v189, v14
v_cos_f32 v197, v202
v_add_f32 v14, v14, v13
v_add_f32 v202, v202, v13
v_cos_f32 v190, v14
v_cos_f32 v198, v202
v_add_f32 v14, v14, v13
v_add_f32 v202, v202, v13
v_cos_f32 v191, v14
v_cos_f32 v199, v202
v_cvt_pk_bf16_f32 v100, v184, v185
v_cvt_pk_bf16_f32 v101, v186, v187
v_cvt_pk_bf16_f32 v102, v188, v189
v_cvt_pk_bf16_f32 v103, v190, v191
v_cvt_pk_bf16_f32 v104, v192, v193
v_cvt_pk_bf16_f32 v105, v194, v195
v_cvt_pk_bf16_f32 v106, v196, v197
v_cvt_pk_bf16_f32 v107, v198, v199
v_pk_fma_f32 v[184:185], v[192:193], v[200:201], v[184:185] op_sel_hi:[1,0,1] neg_lo:[0,0,1] neg_hi:[0,0,1]
v_pk_fma_f32 v[186:187], v[194:195], v[200:201], v[186:187] op_sel_hi:[1,0,1] neg_lo:[0,0,1] neg_hi:[0,0,1]
v_pk_fma_f32 v[188:189], v[196:197], v[200:201], v[188:189] op_sel_hi:[1,0,1] neg_lo:[0,0,1] neg_hi:[0,0,1]
v_pk_fma_f32 v[190:191], v[198:199], v[200:201], v[190:191] op_sel_hi:[1,0,1] neg_lo:[0,0,1] neg_hi:[0,0,1]
v_cvt_pk_bf16_f32 v108, v184, v185
v_cvt_pk_bf16_f32 v109, v186, v187
v_cvt_pk_bf16_f32 v110, v188, v189
v_cvt_pk_bf16_f32 v111, v190, v191
v_pk_fma_f32 v[192:193], v[184:185], v[200:201], v[192:193] op_sel_hi:[1,0,1] neg_lo:[0,0,1] neg_hi:[0,0,1]
v_pk_fma_f32 v[194:195], v[186:187], v[200:201], v[194:195] op_sel_hi:[1,0,1] neg_lo:[0,0,1] neg_hi:[0,0,1]
v_pk_fma_f32 v[196:197], v[188:189], v[200:201], v[196:197] op_sel_hi:[1,0,1] neg_lo:[0,0,1] neg_hi:[0,0,1]
v_pk_fma_f32 v[198:199], v[190:191], v[200:201], v[198:199] op_sel_hi:[1,0,1] neg_lo:[0,0,1] neg_hi:[0,0,1]
v_cvt_pk_bf16_f32 v112, v192, v193
v_cvt_pk_bf16_f32 v113, v194, v195
v_cvt_pk_bf16_f32 v114, v196, v197
v_cvt_pk_bf16_f32 v115, v198, v199
v_pk_fma_f32 v[184:185], v[192:193], v[200:201], v[184:185] op_sel_hi:[1,0,1] neg_lo:[0,0,1] neg_hi:[0,0,1]
v_pk_fma_f32 v[186:187], v[194:195], v[200:201], v[186:187] op_sel_hi:[1,0,1] neg_lo:[0,0,1] neg_hi:[0,0,1]
v_pk_fma_f32 v[188:189], v[196:197], v[200:201], v[188:189] op_sel_hi:[1,0,1] neg_lo:[0,0,1] neg_hi:[0,0,1]
v_pk_fma_f32 v[190:191], v[198:199], v[200:201], v[190:191] op_sel_hi:[1,0,1] neg_lo:[0,0,1] neg_hi:[0,0,1]
v_cvt_pk_bf16_f32 v116, v184, v185
v_cvt_pk_bf16_f32 v117, v186, v187
v_cvt_pk_bf16_f32 v118, v188, v189
v_cvt_pk_bf16_f32 v119, v190, v191
v_pk_fma_f32 v[192:193], v[184:185], v[200:201], v[192:193] op_sel_hi:[1,0,1] neg_lo:[0,0,1] neg_hi:[0,0,1]
v_pk_fma_f32 v[194:195], v[186:187], v[200:201], v[194:195] op_sel_hi:[1,0,1] neg_lo:[0,0,1] neg_hi:[0,0,1]
v_pk_fma_f32 v[196:197], v[188:189], v[200:201], v[196:197] op_sel_hi:[1,0,1] neg_lo:[0,0,1] neg_hi:[0,0,1]
v_pk_fma_f32 v[198:199], v[190:191], v[200:201], v[198:199] op_sel_hi:[1,0,1] neg_lo:[0,0,1] neg_hi:[0,0,1]
v_cvt_pk_bf16_f32 v120, v192, v193
v_cvt_pk_bf16_f32 v121, v194, v195
v_cvt_pk_bf16_f32 v122, v196, v197
v_cvt_pk_bf16_f32 v123, v198, v199
v_pk_fma_f32 v[184:185], v[192:193], v[200:201], v[184:185] op_sel_hi:[1,0,1] neg_lo:[0,0,1] neg_hi:[0,0,1]
v_pk_fma_f32 v[186:187], v[194:195], v[200:201], v[186:187] op_sel_hi:[1,0,1] neg_lo:[0,0,1] neg_hi:[0,0,1]
v_pk_fma_f32 v[188:189], v[196:197], v[200:201], v[188:189] op_sel_hi:[1,0,1] neg_lo:[0,0,1] neg_hi:[0,0,1]
v_pk_fma_f32 v[190:191], v[198:199], v[200:201], v[190:191] op_sel_hi:[1,0,1] neg_lo:[0,0,1] neg_hi:[0,0,1]
v_cvt_pk_bf16_f32 v124, v184, v185
v_cvt_pk_bf16_f32 v125, v186, v187
v_cvt_pk_bf16_f32 v126, v188, v189
v_cvt_pk_bf16_f32 v127, v190, v191
L_tbl2:
s_sub_u32 s87, s2, 64
v_mov_b32 v253, v10
s_mov_b32 s28, s42
s_and_b32 s29, s43, 0xffff
s_mov_b32 s30, 921600
s_mov_b32 s31, 0x20000
s_mov_b32 s32, s44
s_and_b32 s33, s45, 0xffff
s_mov_b32 s34, 921600
s_mov_b32 s35, 0x20000
s_lshr_b32 s4, s2, 6
s_bfe_u32 s5, s2, 0x10005
s_bfe_u32 s6, s2, 0x20003
s_bfe_u32 s7, s2, 0x20001
s_lshl_b32 s85, s5, 10
s_lshl_b32 s6, s6, 8
s_add_u32 s85, s85, s6
s_lshl_b32 s84, s4, 4
s_lshl_b32 s5, s7, 2
s_add_u32 s84, s84, s5
s_add_u32 s84, s84, s85
s_lshl_b32 s86, s4, 11
s_add_u32 s86, s86, s85
s_lshl_b32 s5, s7, 6
s_add_u32 s86, s86, s5
s_and_b32 s85, s2, 1
s_lshl_b32 s85, s85, 2
s_add_u32 s85, s85, s62
s_lshl_b32 s85, s85, 5
v_bfe_u32 v7, v1, 2, 2
v_lshrrev_b32 v8, 4, v1
v_lshl_add_u32 v7, v8, 6, v7
v_mul_u32_u24 v7, 450, v7
v_and_b32 v8, 3, v1
v_lshl_add_u32 v7, v8, 4, v7
s_mul_i32 s4, s84, 450
s_lshl_b32 s5, s85, 1
s_add_u32 s4, s4, s5
s_lshl_b32 s95, s62, 11
s_mov_b32 m0, s95
s_nop 0
buffer_load_dwordx4 v7, s[28:31], s4 offen lds
s_add_u32 m0, s95, 1024
s_nop 0
buffer_load_dwordx4 v7, s[32:35], s4 offen lds
s_lshl_b32 s4, s2, 2
s_add_u32 s4, s4, s62
s_cmp_lg_u32 s4, 1023
s_cbranch_scc1 L_nopatch1
v_mov_b32 v13, 921598
global_load_ushort v43, v13, s[42:43]
global_load_ushort v251, v13, s[44:45]
L_nopatch1:
s_mul_i32 s89, s87, 9363
s_lshr_b32 s89, s89, 16
s_mul_i32 s4, s89, 7
s_sub_u32 s98, s87, s4
s_lshl_b32 s4, s62, 11
s_add_u32 s94, s4, 144384
s_mov_b32 s28, s48
s_and_b32 s29, s49, 0xffff
s_mov_b32 s30, 1605632
s_mov_b32 s31, 0x20000
v_lshrrev_b32 v7, 3, v1
v_lshrrev_b32 v8, 1, v7
v_and_b32 v10, 1, v8
v_lshlrev_b32 v10, 2, v10
v_and_b32 v11, 7, v1
v_xor_b32 v10, v10, v11
v_lshlrev_b32 v10, 4, v10
v_mul_u32_u24 v8, 14, v8
v_and_b32 v11, 1, v7
v_add_u32 v8, v8, v11
v_mul_u32_u24 v8, 3584, v8
s_lshl_b32 s4, s98, 9
s_lshl_b32 s5, s62, 7
s_add_u32 s4, s4, s5
s_mul_i32 s6, s89, 37
s_lshr_b32 s6, s6, 8
s_mul_i32 s6, s6, 98
s_lshl_b32 s5, s89, 1
s_add_u32 s5, s5, s6
s_mul_i32 s5, s5, 3584
s_add_u32 s4, s5, s4
s_add_u32 s5, s4, 200704
v_add_u32 v8, v8, v10
s_mov_b32 m0, s94
s_nop 0
buffer_load_dwordx4 v8, s[28:31], s4 offen lds
s_add_u32 m0, s94, 1024
s_nop 0
buffer_load_dwordx4 v8, s[28:31], s5 offen lds
L_nopre1p:
v_mov_b32 v10, v253
s_waitcnt vmcnt(19)
v_lshlrev_b32 v184, 16, v128
v_and_b32 v185, s99, v128
v_lshlrev_b32 v186, 16, v129
v_and_b32 v187, s99, v129
s_waitcnt vmcnt(18)
v_lshlrev_b32 v188, 16, v130
v_and_b32 v189, s99, v130
v_lshlrev_b32 v190, 16, v131
v_and_b32 v191, s99, v131
s_waitcnt vmcnt(17)
v_lshlrev_b32 v192, 16, v132
v_and_b32 v193, s99, v132
v_lshlrev_b32 v194, 16, v133
v_and_b32 v195, s99, v133
s_waitcnt vmcnt(16)
v_lshlrev_b32 v196, 16, v134
v_and_b32 v197, s99, v134
v_lshlrev_b32 v198, 16, v135
v_and_b32 v199, s99, v135
s_waitcnt vmcnt(15)
v_lshlrev_b32 v200, 16, v136
v_and_b32 v201, s99, v136
v_lshlrev_b32 v202, 16, v137
v_and_b32 v203, s99, v137
s_waitcnt vmcnt(14)
v_lshlrev_b32 v204, 16, v138
v_and_b32 v205, s99, v138
v_lshlrev_b32 v206, 16, v139
v_and_b32 v207, s99, v139
s_waitcnt vmcnt(13)
v_lshlrev_b32 v208, 16, v140
v_and_b32 v209, s99, v140
v_lshlrev_b32 v210, 16, v141
v_and_b32 v211, s99, v141
s_waitcnt vmcnt(12)
v_lshlrev_b32 v212, 16, v142
v_and_b32 v213, s99, v142
v_lshlrev_b32 v214, 16, v143
v_and_b32 v215, s99, v143
s_waitcnt vmcnt(11)
v_lshlrev_b32 v216, 16, v144
v_and_b32 v217, s99, v144
v_lshlrev_b32 v218, 16, v145
v_and_b32 v219, s99, v145
s_waitcnt vmcnt(10)
v_lshlrev_b32 v220, 16, v146
v_and_b32 v221, s99, v146
v_lshlrev_b32 v222, 16, v147
v_and_b32 v223, s99, v147
s_waitcnt vmcnt(9)
v_lshlrev_b32 v224, 16, v148
v_and_b32 v225, s99, v148
v_lshlrev_b32 v226, 16, v149
v_and_b32 v227, s99, v149
s_waitcnt vmcnt(8)
v_lshlrev_b32 v228, 16, v150
v_and_b32 v229, s99, v150
v_lshlrev_b32 v230, 16, v151
v_and_b32 v231, s99, v151
s_waitcnt vmcnt(7)
v_lshlrev_b32 v232, 16, v152
v_and_b32 v233, s99, v152
v_lshlrev_b32 v234, 16, v153
v_and_b32 v235, s99, v153
s_waitcnt vmcnt(6)
v_lshlrev_b32 v236, 16, v154
v_and_b32 v237, s99, v154
v_lshlrev_b32 v238, 16, v155
v_and_b32 v239, s99, v155
s_waitcnt vmcnt(5)
v_lshlrev_b32 v240, 16, v156
v_and_b32 v241, s99, v156
v_lshlrev_b32 v242, 16, v157
v_and_b32 v243, s99, v157
s_waitcnt vmcnt(4)
v_lshlrev_b32 v244, 16, v158
v_and_b32 v245, s99, v158
v_lshlrev_b32 v246, 16, v159
v_and_b32 v247, s99, v159
v_pk_add_f32 v[144:145], v[184:185], v[186:187]
v_pk_mul_f32 v[146:147], v[184:185], v[184:185]
v_pk_add_f32 v[148:149], v[188:189], v[190:191]
v_pk_fma_f32 v[146:147], v[186:187], v[186:187], v[146:147]
v_pk_fma_f32 v[146:147], v[188:189], v[188:189], v[146:147]
v_pk_fma_f32 v[146:147], v[190:191], v[190:191], v[146:147]
v_pk_add_f32 v[144:145], v[144:145], v[148:149]
v_add_f32 v136, v146, v147
v_add_f32 v128, v144, v145
v_pk_add_f32 v[144:145], v[192:193], v[194:195]
v_pk_mul_f32 v[146:147], v[192:193], v[192:193]
v_pk_add_f32 v[148:149], v[196:197], v[198:199]
v_pk_fma_f32 v[146:147], v[194:195], v[194:195], v[146:147]
v_pk_fma_f32 v[146:147], v[196:197], v[196:197], v[146:147]
v_pk_fma_f32 v[146:147], v[198:199], v[198:199], v[146:147]
v_pk_add_f32 v[144:145], v[144:145], v[148:149]
v_add_f32 v137, v146, v147
v_add_f32 v129, v144, v145
v_pk_add_f32 v[144:145], v[200:201], v[202:203]
v_pk_mul_f32 v[146:147], v[200:201], v[200:201]
v_pk_add_f32 v[148:149], v[204:205], v[206:207]
v_pk_fma_f32 v[146:147], v[202:203], v[202:203], v[146:147]
v_pk_fma_f32 v[146:147], v[204:205], v[204:205], v[146:147]
v_pk_fma_f32 v[146:147], v[206:207], v[206:207], v[146:147]
v_pk_add_f32 v[144:145], v[144:145], v[148:149]
v_add_f32 v138, v146, v147
v_add_f32 v130, v144, v145
v_pk_add_f32 v[144:145], v[208:209], v[210:211]
v_pk_mul_f32 v[146:147], v[208:209], v[208:209]
v_pk_add_f32 v[148:149], v[212:213], v[214:215]
v_pk_fma_f32 v[146:147], v[210:211], v[210:211], v[146:147]
v_pk_fma_f32 v[146:147], v[212:213], v[212:213], v[146:147]
v_pk_fma_f32 v[146:147], v[214:215], v[214:215], v[146:147]
v_pk_add_f32 v[144:145], v[144:145], v[148:149]
v_add_f32 v139, v146, v147
v_add_f32 v131, v144, v145
v_pk_add_f32 v[144:145], v[216:217], v[218:219]
v_pk_mul_f32 v[146:147], v[216:217], v[216:217]
v_pk_add_f32 v[148:149], v[220:221], v[222:223]
v_pk_fma_f32 v[146:147], v[218:219], v[218:219], v[146:147]
v_pk_fma_f32 v[146:147], v[220:221], v[220:221], v[146:147]
v_pk_fma_f32 v[146:147], v[222:223], v[222:223], v[146:147]
v_pk_add_f32 v[144:145], v[144:145], v[148:149]
v_add_f32 v140, v146, v147
v_add_f32 v132, v144, v145
v_pk_add_f32 v[144:145], v[224:225], v[226:227]
v_pk_mul_f32 v[146:147], v[224:225], v[224:225]
v_pk_add_f32 v[148:149], v[228:229], v[230:231]
v_pk_fma_f32 v[146:147], v[226:227], v[226:227], v[146:147]
v_pk_fma_f32 v[146:147], v[228:229], v[228:229], v[146:147]
v_pk_fma_f32 v[146:147], v[230:231], v[230:231], v[146:147]
v_pk_add_f32 v[144:145], v[144:145], v[148:149]
v_add_f32 v141, v146, v147
v_add_f32 v133, v144, v145
v_pk_add_f32 v[144:145], v[232:233], v[234:235]
v_pk_mul_f32 v[146:147], v[232:233], v[232:233]
v_pk_add_f32 v[148:149], v[236:237], v[238:239]
v_pk_fma_f32 v[146:147], v[234:235], v[234:235], v[146:147]
v_pk_fma_f32 v[146:147], v[236:237], v[236:237], v[146:147]
v_pk_fma_f32 v[146:147], v[238:239], v[238:239], v[146:147]
v_pk_add_f32 v[144:145], v[144:145], v[148:149]
v_add_f32 v142, v146, v147
v_add_f32 v134, v144, v145
v_pk_add_f32 v[144:145], v[240:241], v[242:243]
v_pk_mul_f32 v[146:147], v[240:241], v[240:241]
v_pk_add_f32 v[148:149], v[244:245], v[246:247]
v_pk_fma_f32 v[146:147], v[242:243], v[242:243], v[146:147]
v_pk_fma_f32 v[146:147], v[244:245], v[244:245], v[146:147]
v_pk_fma_f32 v[146:147], v[246:247], v[246:247], v[146:147]
v_pk_add_f32 v[144:145], v[144:145], v[148:149]
v_add_f32 v143, v146, v147
v_add_f32 v135, v144, v145
v_permlane32_swap_b32 v128, v132
v_permlane32_swap_b32 v129, v133
v_permlane32_swap_b32 v130, v134
v_permlane32_swap_b32 v131, v135
v_permlane32_swap_b32 v136, v140
v_permlane32_swap_b32 v137, v141
v_permlane32_swap_b32 v138, v142
v_permlane32_swap_b32 v139, v143
v_add_f32 v128, v128, v132
v_add_f32 v129, v129, v133
v_add_f32 v130, v130, v134
v_add_f32 v131, v131, v135
v_add_f32 v136, v136, v140
v_add_f32 v137, v137, v141
v_add_f32 v138, v138, v142
v_add_f32 v139, v139, v143
v_permlane16_swap_b32 v128, v130
v_permlane16_swap_b32 v129, v131
v_permlane16_swap_b32 v136, v138
v_permlane16_swap_b32 v137, v139
v_add_f32 v128, v128, v130
v_add_f32 v129, v129, v131
v_add_f32 v136, v136, v138
v_add_f32 v137, v137, v139
v_add_f32_dpp v128, v128, v128 row_ror:1 row_mask:0xf bank_mask:0xf
v_add_f32_dpp v129, v129, v129 row_ror:1 row_mask:0xf bank_mask:0xf
v_add_f32_dpp v136, v136, v136 row_ror:1 row_mask:0xf bank_mask:0xf
v_add_f32_dpp v137, v137, v137 row_ror:1 row_mask:0xf bank_mask:0xf
v_add_f32_dpp v128, v128, v128 row_ror:2 row_mask:0xf bank_mask:0xf
v_add_f32_dpp v129, v129, v129 row_ror:2 row_mask:0xf bank_mask:0xf
v_add_f32_dpp v136, v136, v136 row_ror:2 row_mask:0xf bank_mask:0xf
v_add_f32_dpp v137, v137, v137 row_ror:2 row_mask:0xf bank_mask:0xf
v_add_f32_dpp v128, v128, v128 row_ror:4 row_mask:0xf bank_mask:0xf
v_add_f32_dpp v129, v129, v129 row_ror:4 row_mask:0xf bank_mask:0xf
v_add_f32_dpp v136, v136, v136 row_ror:4 row_mask:0xf bank_mask:0xf
v_add_f32_dpp v137, v137, v137 row_ror:4 row_mask:0xf bank_mask:0xf
v_add_f32_dpp v128, v128, v128 row_ror:8 row_mask:0xf bank_mask:0xf
v_add_f32_dpp v129, v129, v129 row_ror:8 row_mask:0xf bank_mask:0xf
v_add_f32_dpp v136, v136, v136 row_ror:8 row_mask:0xf bank_mask:0xf
v_add_f32_dpp v137, v137, v137 row_ror:8 row_mask:0xf bank_mask:0xf
v_mul_f32 v128, 0x3b124925, v128
v_mul_f32 v136, 0x3b124925, v136
v_mul_f32 v129, 0x3b124925, v129
v_mul_f32 v137, 0x3b124925, v137
v_fma_f32 v136, -v128, v128, v136
v_max_f32 v136, 0, v136
v_add_f32 v136, 0x3727c5ac, v136
v_fma_f32 v137, -v129, v129, v137
v_max_f32 v137, 0, v137
v_add_f32 v137, 0x3727c5ac, v137
v_rsq_f32 v136, v136
v_rsq_f32 v137, v137
v_mul_f32 v128, -v128, v136
v_mul_f32 v129, -v129, v137
v_lshlrev_b32 v13, 6, v1
v_and_b32 v13, 64, v13
global_load_dword v42, v13, s[58:59] offset:128 sc1
v_readlane_b32 s64, v136, 0
v_readlane_b32 s65, v128, 0
v_readlane_b32 s66, v137, 0
v_readlane_b32 s67, v129, 0
v_readlane_b32 s68, v136, 16
v_readlane_b32 s69, v128, 16
v_readlane_b32 s70, v137, 16
v_readlane_b32 s71, v129, 16
v_readlane_b32 s72, v136, 32
v_readlane_b32 s73, v128, 32
v_readlane_b32 s74, v137, 32
v_readlane_b32 s75, v129, 32
v_readlane_b32 s76, v136, 48
v_readlane_b32 s77, v128, 48
v_readlane_b32 s78, v137, 48
v_readlane_b32 s79, v129, 48
v_pk_fma_f32 v[184:185], v[184:185], s[64:65], s[64:65] op_sel:[0,0,1] op_sel_hi:[1,0,1]
v_pk_fma_f32 v[186:187], v[186:187], s[64:65], s[64:65] op_sel:[0,0,1] op_sel_hi:[1,0,1]
v_pk_fma_f32 v[188:189], v[188:189], s[64:65], s[64:65] op_sel:[0,0,1] op_sel_hi:[1,0,1]
v_pk_fma_f32 v[190:191], v[190:191], s[64:65], s[64:65] op_sel:[0,0,1] op_sel_hi:[1,0,1]
v_pk_fma_f32 v[192:193], v[192:193], s[66:67], s[66:67] op_sel:[0,0,1] op_sel_hi:[1,0,1]
v_pk_fma_f32 v[194:195], v[194:195], s[66:67], s[66:67] op_sel:[0,0,1] op_sel_hi:[1,0,1]
v_pk_fma_f32 v[196:197], v[196:197], s[66:67], s[66:67] op_sel:[0,0,1] op_sel_hi:[1,0,1]
v_pk_fma_f32 v[198:199], v[198:199], s[66:67], s[66:67] op_sel:[0,0,1] op_sel_hi:[1,0,1]
v_pk_fma_f32 v[200:201], v[200:201], s[68:69], s[68:69] op_sel:[0,0,1] op_sel_hi:[1,0,1]
v_pk_fma_f32 v[202:203], v[202:203], s[68:69], s[68:69] op_sel:[0,0,1] op_sel_hi:[1,0,1]
v_pk_fma_f32 v[204:205], v[204:205], s[68:69], s[68:69] op_sel:[0,0,1] op_sel_hi:[1,0,1]
v_pk_fma_f32 v[206:207], v[206:207], s[68:69], s[68:69] op_sel:[0,0,1] op_sel_hi:[1,0,1]
v_pk_fma_f32 v[208:209], v[208:209], s[70:71], s[70:71] op_sel:[0,0,1] op_sel_hi:[1,0,1]
v_pk_fma_f32 v[210:211], v[210:211], s[70:71], s[70:71] op_sel:[0,0,1] op_sel_hi:[1,0,1]
v_pk_fma_f32 v[212:213], v[212:213], s[70:71], s[70:71] op_sel:[0,0,1] op_sel_hi:[1,0,1]
v_pk_fma_f32 v[214:215], v[214:215], s[70:71], s[70:71] op_sel:[0,0,1] op_sel_hi:[1,0,1]
v_pk_fma_f32 v[216:217], v[216:217], s[72:73], s[72:73] op_sel:[0,0,1] op_sel_hi:[1,0,1]
v_pk_fma_f32 v[218:219], v[218:219], s[72:73], s[72:73] op_sel:[0,0,1] op_sel_hi:[1,0,1]
v_pk_fma_f32 v[220:221], v[220:221], s[72:73], s[72:73] op_sel:[0,0,1] op_sel_hi:[1,0,1]
v_pk_fma_f32 v[222:223], v[222:223], s[72:73], s[72:73] op_sel:[0,0,1] op_sel_hi:[1,0,1]
v_pk_fma_f32 v[224:225], v[224:225], s[74:75], s[74:75] op_sel:[0,0,1] op_sel_hi:[1,0,1]
v_pk_fma_f32 v[226:227], v[226:227], s[74:75], s[74:75] op_sel:[0,0,1] op_sel_hi:[1,0,1]
v_pk_fma_f32 v[228:229], v[228:229], s[74:75], s[74:75] op_sel:[0,0,1] op_sel_hi:[1,0,1]
v_pk_fma_f32 v[230:231], v[230:231], s[74:75], s[74:75] op_sel:[0,0,1] op_sel_hi:[1,0,1]
v_pk_fma_f32 v[232:233], v[232:233], s[76:77], s[76:77] op_sel:[0,0,1] op_sel_hi:[1,0,1]
v_pk_fma_f32 v[234:235], v[234:235], s[76:77], s[76:77] op_sel:[0,0,1] op_sel_hi:[1,0,1]
v_pk_fma_f32 v[236:237], v[236:237], s[76:77], s[76:77] op_sel:[0,0,1] op_sel_hi:[1,0,1]
v_pk_fma_f32 v[238:239], v[238:239], s[76:77], s[76:77] op_sel:[0,0,1] op_sel_hi:[1,0,1]
v_pk_fma_f32 v[240:241], v[240:241], s[78:79], s[78:79] op_sel:[0,0,1] op_sel_hi:[1,0,1]
v_pk_fma_f32 v[242:243], v[242:243], s[78:79], s[78:79] op_sel:[0,0,1] op_sel_hi:[1,0,1]
v_pk_fma_f32 v[244:245], v[244:245], s[78:79], s[78:79] op_sel:[0,0,1] op_sel_hi:[1,0,1]
v_pk_fma_f32 v[246:247], v[246:247], s[78:79], s[78:79] op_sel:[0,0,1] op_sel_hi:[1,0,1]
s_add_u32 s16, s60, 2097152
s_addc_u32 s17, s61, 0
s_and_b32 s17, s17, 0xffff
s_mov_b32 s18, 1843200
s_mov_b32 s19, 0x20000
s_add_u32 s20, s60, 2097152
s_addc_u32 s21, s61, 0
s_and_b32 s21, s21, 0xffff
s_mov_b32 s22, 1843200
s_mov_b32 s23, 0x20000
s_lshl_b32 s4, s62, 3
s_mul_i32 s4, s4, 544
s_add_u32 s4, s4, 107520
v_lshl_add_u32 v2, v1, 3, s4
v_and_b32 v3, 15, v1
v_mul_u32_u24 v3, 544, v3
v_lshl_add_u32 v3, v10, 4, v3
s_mul_i32 s4, s39, 17408
s_add_u32 s4, s4, 107520
v_add_u32 v3, s4, v3
s_lshl_b32 s4, s39, 12
s_lshr_b32 s5, s81, 2
s_lshl_b32 s5, s5, 11
s_add_u32 s4, s4, s5
s_lshl_b32 s5, s80, 8
s_add_u32 s4, s4, s5
s_and_b32 s5, s81, 3
s_lshl_b32 s5, s5, 6
s_add_u32 s4, s4, s5
v_lshlrev_b32 v4, 13, v9
v_lshl_add_u32 v4, v10, 4, v4
v_add_u32 v4, s4, v4
s_mov_b32 s36, 262144
s_mov_b32 s38, 131072
v_lshlrev_b32 v252, 1, v5
v_lshlrev_b32 v254, 1, v6
s_waitcnt vmcnt(0)
v_readlane_b32 s4, v42, 2
s_nop 0
s_cmp_lg_u32 s4, 0
s_cbranch_scc1 iok_2
s_mov_b32 s3, 0
poll_3:
s_sleep 1
v_lshlrev_b32 v13, 6, v1
v_and_b32 v13, 64, v13
global_load_dword v42, v13, s[58:59] offset:128 sc1
s_waitcnt vmcnt(0)
v_readlane_b32 s4, v42, 2
s_nop 0
s_cmp_lg_u32 s4, 0
s_cbranch_scc1 pollok_4
s_add_u32 s3, s3, 1
s_cmp_lt_u32 s3, 131072
s_cbranch_scc1 poll_3
pollok_4:
iok_2:
s_mov_b32 s6, 36864
s_mov_b32 s7, 40448
buffer_load_dwordx4 v[168:171], v252, s[12:15], s6 offen offset:1792 sc1
buffer_load_dwordx4 v[172:175], v254, s[12:15], s6 offen offset:1792 sc1
buffer_load_dwordx4 v[176:179], v252, s[12:15], s6 offen sc1
buffer_load_dwordx4 v[180:183], v254, s[12:15], s6 offen sc1
buffer_load_dwordx4 v[128:131], v252, s[12:15], s7 offen offset:1792 sc1
buffer_load_dwordx4 v[132:135], v254, s[12:15], s7 offen offset:1792 sc1
buffer_load_dwordx4 v[136:139], v252, s[12:15], s7 offen sc1
buffer_load_dwordx4 v[140:143], v254, s[12:15], s7 offen sc1
s_waitcnt vmcnt(8)
s_add_u32 s24, s60, 6291456
s_addc_u32 s25, s61, 0
s_and_b32 s25, s25, 0xffff
s_mov_b32 s26, 1843200
s_mov_b32 s27, 0x20000
v_and_b32 v7, 15, v1
v_lshrrev_b32 v8, 4, v1
v_lshlrev_b32 v11, 6, v7
v_lshl_add_u32 v11, v8, 3, v11
v_add_u32 v11, s95, v11
ds_read_b64_tr_b16 v[16:17], v11 offset:0
ds_read_b64_tr_b16 v[18:19], v11 offset:1024
ds_read_b64_tr_b16 v[20:21], v11 offset:32
ds_read_b64_tr_b16 v[22:23], v11 offset:1056
v_and_b32 v12, 3, v7
v_lshl_add_u32 v12, v8, 2, v12
v_add_u32 v12, s85, v12
v_lshlrev_b32 v40, 13, v12
v_lshrrev_b32 v12, 2, v7
v_lshl_add_u32 v40, v12, 4, v40
v_add_u32 v40, s86, v40
s_mov_b32 s38, 131072
v_lshlrev_b32 v41, 4, v1
s_lshl_b32 s4, s2, 2
s_add_u32 s4, s4, s62
s_cmp_lg_u32 s4, 1023
s_cbranch_scc1 L_nopatch2p
s_waitcnt lgkmcnt(0)
s_mov_b64 exec, 0x1000
v_and_b32 v17, 0xffff, v17
v_and_b32 v19, 0xffff, v19
v_lshl_or_b32 v17, v43, 16, v17
v_lshl_or_b32 v19, v251, 16, v19
s_mov_b64 exec, -1
L_nopatch2p:
v_and_b32 v7, 15, v1
v_lshrrev_b32 v8, 4, v1
v_lshrrev_b32 v12, 2, v7
v_lshrrev_b32 v13, 1, v12
v_lshlrev_b32 v11, 2, v13
v_and_b32 v13, 1, v8
v_lshl_or_b32 v11, v13, 1, v11
v_bfe_u32 v13, v7, 1, 1
v_or_b32 v11, v11, v13
v_lshlrev_b32 v11, 4, v11
v_and_b32 v13, 1, v7
v_lshl_or_b32 v11, v13, 3, v11
v_lshl_or_b32 v11, v12, 7, v11
v_lshrrev_b32 v13, 1, v8
v_lshl_add_u32 v11, v13, 10, v11
v_add_u32 v11, s94, v11
v_xor_b32 v12, 64, v11
ds_read_b64_tr_b16 v[24:25], v11
ds_read_b64_tr_b16 v[26:27], v11 offset:512
ds_read_b64_tr_b16 v[28:29], v12
ds_read_b64_tr_b16 v[30:31], v12 offset:512
s_add_u32 s4, s98, 0
s_lshl_b32 s4, s4, 2
s_add_u32 s4, s4, s62
s_mul_i32 s4, s4, 57344
s_lshl_b32 s5, s89, 11
s_add_u32 s4, s4, s5
s_add_u32 s88, s4, 8388608
s_waitcnt vmcnt(5)
v_max3_u32 v13, v168, v172, v176
s_waitcnt vmcnt(3)
v_max3_u32 v13, v13, v180, v128
s_waitcnt vmcnt(1)
v_max3_u32 v13, v13, v132, v136
s_waitcnt vmcnt(0)
v_max_u32 v13, v13, v140
v_cmp_eq_u32 vcc, -1, v13
s_nop 0
s_cbranch_vccz L_modok
s_mov_b32 s3, 0
poll_5:
buffer_load_dwordx4 v[168:171], v252, s[12:15], s6 offen offset:1792 sc1
buffer_load_dwordx4 v[172:175], v254, s[12:15], s6 offen offset:1792 sc1
buffer_load_dwordx4 v[176:179], v252, s[12:15], s6 offen sc1
buffer_load_dwordx4 v[180:183], v254, s[12:15], s6 offen sc1
buffer_load_dwordx4 v[128:131], v252, s[12:15], s7 offen offset:1792 sc1
buffer_load_dwordx4 v[132:135], v254, s[12:15], s7 offen offset:1792 sc1
buffer_load_dwordx4 v[136:139], v252, s[12:15], s7 offen sc1
buffer_load_dwordx4 v[140:143], v254, s[12:15], s7 offen sc1
s_waitcnt vmcnt(0)
v_max3_u32 v13, v168, v172, v176
v_max3_u32 v13, v13, v180, v128
v_max3_u32 v13, v13, v132, v136
v_max_u32 v13, v13, v140
v_cmp_eq_u32 vcc, -1, v13
s_nop 0
s_cbranch_vccz pollok_6
s_sleep 6
s_add_u32 s3, s3, 1
s_cmp_lt_u32 s3, 131072
s_cbranch_scc1 poll_5
pollok_6:
L_modok:
v_pk_add_f32 v[168:169], v[168:169], v[128:129]
v_pk_add_f32 v[170:171], v[170:171], v[130:131]
v_pk_add_f32 v[172:173], v[172:173], v[132:133]
v_pk_add_f32 v[174:175], v[174:175], v[134:135]
v_pk_add_f32 v[176:177], v[176:177], v[136:137]
v_pk_add_f32 v[178:179], v[178:179], v[138:139]
v_pk_add_f32 v[180:181], v[180:181], v[140:141]
v_pk_add_f32 v[182:183], v[182:183], v[142:143]
s_waitcnt lgkmcnt(6)
buffer_store_dwordx4 v[16:19], v40, s[24:27], 0 offen sc1
s_waitcnt lgkmcnt(4)
buffer_store_dwordx4 v[20:23], v40, s[24:27], s38 offen sc1
s_waitcnt lgkmcnt(2)
buffer_store_dwordx4 v[24:27], v41, s[12:15], s88 offen offset:0 sc1
s_waitcnt lgkmcnt(0)
buffer_store_dwordx4 v[28:31], v41, s[12:15], s88 offen offset:1024 sc1
v_pk_fma_f32 v[184:185], v[184:185], v[168:169], v[176:177]
v_pk_fma_f32 v[186:187], v[186:187], v[170:171], v[178:179]
v_pk_fma_f32 v[188:189], v[188:189], v[172:173], v[180:181]
v_pk_fma_f32 v[190:191], v[190:191], v[174:175], v[182:183]
v_pk_add_f32 v[128:129], v[184:185], v[190:191] op_sel:[0,1] op_sel_hi:[1,0]
v_pk_add_f32 v[130:131], v[186:187], v[188:189] op_sel:[0,1] op_sel_hi:[1,0]
v_pk_add_f32 v[132:133], v[184:185], v[190:191] op_sel:[0,1] op_sel_hi:[1,0] neg_lo:[0,1] neg_hi:[0,1]
v_pk_add_f32 v[134:135], v[186:187], v[188:189] op_sel:[0,1] op_sel_hi:[1,0] neg_lo:[0,1] neg_hi:[0,1]
v_cvt_pk_bf16_f32 v184, v128, v129
v_cvt_pk_bf16_f32 v185, v130, v131
v_cvt_pk_bf16_f32 v186, v132, v133
v_cvt_pk_bf16_f32 v187, v134, v135
ds_write_b64 v2, v[184:185] offset:0
ds_write_b64 v2, v[186:187] offset:17408
v_pk_fma_f32 v[192:193], v[192:193], v[168:169], v[176:177]
v_pk_fma_f32 v[194:195], v[194:195], v[170:171], v[178:179]
v_pk_fma_f32 v[196:197], v[196:197], v[172:173], v[180:181]
v_pk_fma_f32 v[198:199], v[198:199], v[174:175], v[182:183]
v_pk_add_f32 v[136:137], v[192:193], v[198:199] op_sel:[0,1] op_sel_hi:[1,0]
v_pk_add_f32 v[138:139], v[194:195], v[196:197] op_sel:[0,1] op_sel_hi:[1,0]
v_pk_add_f32 v[140:141], v[192:193], v[198:199] op_sel:[0,1] op_sel_hi:[1,0] neg_lo:[0,1] neg_hi:[0,1]
v_pk_add_f32 v[142:143], v[194:195], v[196:197] op_sel:[0,1] op_sel_hi:[1,0] neg_lo:[0,1] neg_hi:[0,1]
v_cvt_pk_bf16_f32 v192, v136, v137
v_cvt_pk_bf16_f32 v193, v138, v139
v_cvt_pk_bf16_f32 v194, v140, v141
v_cvt_pk_bf16_f32 v195, v142, v143
ds_write_b64 v2, v[192:193] offset:544
ds_write_b64 v2, v[194:195] offset:17952
v_pk_fma_f32 v[200:201], v[200:201], v[168:169], v[176:177]
v_pk_fma_f32 v[202:203], v[202:203], v[170:171], v[178:179]
v_pk_fma_f32 v[204:205], v[204:205], v[172:173], v[180:181]
v_pk_fma_f32 v[206:207], v[206:207], v[174:175], v[182:183]
v_pk_add_f32 v[128:129], v[200:201], v[206:207] op_sel:[0,1] op_sel_hi:[1,0]
v_pk_add_f32 v[130:131], v[202:203], v[204:205] op_sel:[0,1] op_sel_hi:[1,0]
v_pk_add_f32 v[132:133], v[200:201], v[206:207] op_sel:[0,1] op_sel_hi:[1,0] neg_lo:[0,1] neg_hi:[0,1]
v_pk_add_f32 v[134:135], v[202:203], v[204:205] op_sel:[0,1] op_sel_hi:[1,0] neg_lo:[0,1] neg_hi:[0,1]
v_cvt_pk_bf16_f32 v200, v128, v129
v_cvt_pk_bf16_f32 v201, v130, v131
v_cvt_pk_bf16_f32 v202, v132, v133
v_cvt_pk_bf16_f32 v203, v134, v135
ds_write_b64 v2, v[200:201] offset:1088
ds_write_b64 v2, v[202:203] offset:18496
v_pk_fma_f32 v[208:209], v[208:209], v[168:169], v[176:177]
v_pk_fma_f32 v[210:211], v[210:211], v[170:171], v[178:179]
v_pk_fma_f32 v[212:213], v[212:213], v[172:173], v[180:181]
v_pk_fma_f32 v[214:215], v[214:215], v[174:175], v[182:183]
v_pk_add_f32 v[136:137], v[208:209], v[214:215] op_sel:[0,1] op_sel_hi:[1,0]
v_pk_add_f32 v[138:139], v[210:211], v[212:213] op_sel:[0,1] op_sel_hi:[1,0]
v_pk_add_f32 v[140:141], v[208:209], v[214:215] op_sel:[0,1] op_sel_hi:[1,0] neg_lo:[0,1] neg_hi:[0,1]
v_pk_add_f32 v[142:143], v[210:211], v[212:213] op_sel:[0,1] op_sel_hi:[1,0] neg_lo:[0,1] neg_hi:[0,1]
v_cvt_pk_bf16_f32 v208, v136, v137
v_cvt_pk_bf16_f32 v209, v138, v139
v_cvt_pk_bf16_f32 v210, v140, v141
v_cvt_pk_bf16_f32 v211, v142, v143
ds_write_b64 v2, v[208:209] offset:1632
ds_write_b64 v2, v[210:211] offset:19040
v_pk_fma_f32 v[216:217], v[216:217], v[168:169], v[176:177]
v_pk_fma_f32 v[218:219], v[218:219], v[170:171], v[178:179]
v_pk_fma_f32 v[220:221], v[220:221], v[172:173], v[180:181]
v_pk_fma_f32 v[222:223], v[222:223], v[174:175], v[182:183]
v_pk_add_f32 v[128:129], v[216:217], v[222:223] op_sel:[0,1] op_sel_hi:[1,0]
v_pk_add_f32 v[130:131], v[218:219], v[220:221] op_sel:[0,1] op_sel_hi:[1,0]
v_pk_add_f32 v[132:133], v[216:217], v[222:223] op_sel:[0,1] op_sel_hi:[1,0] neg_lo:[0,1] neg_hi:[0,1]
v_pk_add_f32 v[134:135], v[218:219], v[220:221] op_sel:[0,1] op_sel_hi:[1,0] neg_lo:[0,1] neg_hi:[0,1]
v_cvt_pk_bf16_f32 v216, v128, v129
v_cvt_pk_bf16_f32 v217, v130, v131
v_cvt_pk_bf16_f32 v218, v132, v133
v_cvt_pk_bf16_f32 v219, v134, v135
ds_write_b64 v2, v[216:217] offset:2176
ds_write_b64 v2, v[218:219] offset:19584
v_pk_fma_f32 v[224:225], v[224:225], v[168:169], v[176:177]
v_pk_fma_f32 v[226:227], v[226:227], v[170:171], v[178:179]
v_pk_fma_f32 v[228:229], v[228:229], v[172:173], v[180:181]
v_pk_fma_f32 v[230:231], v[230:231], v[174:175], v[182:183]
v_pk_add_f32 v[136:137], v[224:225], v[230:231] op_sel:[0,1] op_sel_hi:[1,0]
v_pk_add_f32 v[138:139], v[226:227], v[228:229] op_sel:[0,1] op_sel_hi:[1,0]
v_pk_add_f32 v[140:141], v[224:225], v[230:231] op_sel:[0,1] op_sel_hi:[1,0] neg_lo:[0,1] neg_hi:[0,1]
v_pk_add_f32 v[142:143], v[226:227], v[228:229] op_sel:[0,1] op_sel_hi:[1,0] neg_lo:[0,1] neg_hi:[0,1]
v_cvt_pk_bf16_f32 v224, v136, v137
v_cvt_pk_bf16_f32 v225, v138, v139
v_cvt_pk_bf16_f32 v226, v140, v141
v_cvt_pk_bf16_f32 v227, v142, v143
ds_write_b64 v2, v[224:225] offset:2720
ds_write_b64 v2, v[226:227] offset:20128
v_pk_fma_f32 v[232:233], v[232:233], v[168:169], v[176:177]
v_pk_fma_f32 v[234:235], v[234:235], v[170:171], v[178:179]
v_pk_fma_f32 v[236:237], v[236:237], v[172:173], v[180:181]
v_pk_fma_f32 v[238:239], v[238:239], v[174:175], v[182:183]
v_pk_add_f32 v[128:129], v[232:233], v[238:239] op_sel:[0,1] op_sel_hi:[1,0]
v_pk_add_f32 v[130:131], v[234:235], v[236:237] op_sel:[0,1] op_sel_hi:[1,0]
v_pk_add_f32 v[132:133], v[232:233], v[238:239] op_sel:[0,1] op_sel_hi:[1,0] neg_lo:[0,1] neg_hi:[0,1]
v_pk_add_f32 v[134:135], v[234:235], v[236:237] op_sel:[0,1] op_sel_hi:[1,0] neg_lo:[0,1] neg_hi:[0,1]
v_cvt_pk_bf16_f32 v232, v128, v129
v_cvt_pk_bf16_f32 v233, v130, v131
v_cvt_pk_bf16_f32 v234, v132, v133
v_cvt_pk_bf16_f32 v235, v134, v135
ds_write_b64 v2, v[232:233] offset:3264
ds_write_b64 v2, v[234:235] offset:20672
v_pk_fma_f32 v[240:241], v[240:241], v[168:169], v[176:177]
v_pk_fma_f32 v[242:243], v[242:243], v[170:171], v[178:179]
v_pk_fma_f32 v[244:245], v[244:245], v[172:173], v[180:181]
v_pk_fma_f32 v[246:247], v[246:247], v[174:175], v[182:183]
v_pk_add_f32 v[136:137], v[240:241], v[246:247] op_sel:[0,1] op_sel_hi:[1,0]
v_pk_add_f32 v[138:139], v[242:243], v[244:245] op_sel:[0,1] op_sel_hi:[1,0]
v_pk_add_f32 v[140:141], v[240:241], v[246:247] op_sel:[0,1] op_sel_hi:[1,0] neg_lo:[0,1] neg_hi:[0,1]
v_pk_add_f32 v[142:143], v[242:243], v[244:245] op_sel:[0,1] op_sel_hi:[1,0] neg_lo:[0,1] neg_hi:[0,1]
v_cvt_pk_bf16_f32 v240, v136, v137
v_cvt_pk_bf16_f32 v241, v138, v139
v_cvt_pk_bf16_f32 v242, v140, v141
v_cvt_pk_bf16_f32 v243, v142, v143
ds_write_b64 v2, v[240:241] offset:3808
ds_write_b64 v2, v[242:243] offset:21216
s_waitcnt lgkmcnt(0)
s_barrier
ds_read_b128 v[184:187], v3 offset:0
ds_read_b128 v[188:191], v3 offset:8704
ds_read_b128 v[192:195], v3 offset:64
ds_read_b128 v[196:199], v3 offset:8768
ds_read_b128 v[200:203], v3 offset:128
ds_read_b128 v[204:207], v3 offset:8832
ds_read_b128 v[208:211], v3 offset:192
ds_read_b128 v[212:215], v3 offset:8896
ds_read_b128 v[216:219], v3 offset:256
ds_read_b128 v[220:223], v3 offset:8960
ds_read_b128 v[224:227], v3 offset:320
ds_read_b128 v[228:231], v3 offset:9024
ds_read_b128 v[232:235], v3 offset:384
ds_read_b128 v[236:239], v3 offset:9088
s_cmp_ge_u32 s62, 2
s_cbranch_scc1 L_p1m1
L_p1m0:
s_waitcnt lgkmcnt(13)
v_mfma_f32_16x16x32_bf16 v[128:131], v[184:187], v[44:47], 0
v_mfma_f32_16x16x32_bf16 v[136:139], v[184:187], v[72:75], 0
v_mfma_f32_16x16x32_bf16 v[144:147], v[184:187], v[100:103], 0
s_waitcnt lgkmcnt(12)
v_mfma_f32_16x16x32_bf16 v[132:135], v[188:191], v[44:47], 0
v_mfma_f32_16x16x32_bf16 v[140:143], v[188:191], v[72:75], 0
v_mfma_f32_16x16x32_bf16 v[148:151], v[188:191], v[100:103], 0
s_waitcnt lgkmcnt(11)
v_mfma_f32_16x16x32_bf16 v[128:131], v[192:195], v[48:51], v[128:131]
v_mfma_f32_16x16x32_bf16 v[136:139], v[192:195], v[76:79], v[136:139]
v_mfma_f32_16x16x32_bf16 v[144:147], v[192:195], v[104:107], v[144:147]
s_waitcnt lgkmcnt(10)
v_mfma_f32_16x16x32_bf16 v[132:135], v[196:199], v[48:51], v[132:135]
v_mfma_f32_16x16x32_bf16 v[140:143], v[196:199], v[76:79], v[140:143]
v_mfma_f32_16x16x32_bf16 v[148:151], v[196:199], v[104:107], v[148:151]
s_waitcnt lgkmcnt(9)
v_mfma_f32_16x16x32_bf16 v[128:131], v[200:203], v[52:55], v[128:131]
v_mfma_f32_16x16x32_bf16 v[136:139], v[200:203], v[80:83], v[136:139]
v_mfma_f32_16x16x32_bf16 v[144:147], v[200:203], v[108:111], v[144:147]
s_waitcnt lgkmcnt(8)
v_mfma_f32_16x16x32_bf16 v[132:135], v[204:207], v[52:55], v[132:135]
v_mfma_f32_16x16x32_bf16 v[140:143], v[204:207], v[80:83], v[140:143]
v_mfma_f32_16x16x32_bf16 v[148:151], v[204:207], v[108:111], v[148:151]
s_waitcnt lgkmcnt(7)
v_mfma_f32_16x16x32_bf16 v[128:131], v[208:211], v[56:59], v[128:131]
v_mfma_f32_16x16x32_bf16 v[136:139], v[208:211], v[84:87], v[136:139]
v_mfma_f32_16x16x32_bf16 v[144:147], v[208:211], v[112:115], v[144:147]
s_waitcnt lgkmcnt(6)
v_mfma_f32_16x16x32_bf16 v[132:135], v[212:215], v[56:59], v[132:135]
v_mfma_f32_16x16x32_bf16 v[140:143], v[212:215], v[84:87], v[140:143]
v_mfma_f32_16x16x32_bf16 v[148:151], v[212:215], v[112:115], v[148:151]
s_waitcnt lgkmcnt(5)
v_mfma_f32_16x16x32_bf16 v[128:131], v[216:219], v[60:63], v[128:131]
v_mfma_f32_16x16x32_bf16 v[136:139], v[216:219], v[88:91], v[136:139]
v_mfma_f32_16x16x32_bf16 v[144:147], v[216:219], v[116:119], v[144:147]
s_waitcnt lgkmcnt(4)
v_mfma_f32_16x16x32_bf16 v[132:135], v[220:223], v[60:63], v[132:135]
v_mfma_f32_16x16x32_bf16 v[140:143], v[220:223], v[88:91], v[140:143]
v_mfma_f32_16x16x32_bf16 v[148:151], v[220:223], v[116:119], v[148:151]
s_waitcnt lgkmcnt(3)
v_mfma_f32_16x16x32_bf16 v[128:131], v[224:227], v[64:67], v[128:131]
v_mfma_f32_16x16x32_bf16 v[136:139], v[224:227], v[92:95], v[136:139]
v_mfma_f32_16x16x32_bf16 v[144:147], v[224:227], v[120:123], v[144:147]
s_waitcnt lgkmcnt(2)
v_mfma_f32_16x16x32_bf16 v[132:135], v[228:231], v[64:67], v[132:135]
v_mfma_f32_16x16x32_bf16 v[140:143], v[228:231], v[92:95], v[140:143]
v_mfma_f32_16x16x32_bf16 v[148:151], v[228:231], v[120:123], v[148:151]
s_waitcnt lgkmcnt(1)
v_mfma_f32_16x16x32_bf16 v[128:131], v[232:235], v[68:71], v[128:131]
v_mfma_f32_16x16x32_bf16 v[136:139], v[232:235], v[96:99], v[136:139]
v_mfma_f32_16x16x32_bf16 v[144:147], v[232:235], v[124:127], v[144:147]
s_waitcnt lgkmcnt(0)
v_mfma_f32_16x16x32_bf16 v[132:135], v[236:239], v[68:71], v[132:135]
v_mfma_f32_16x16x32_bf16 v[140:143], v[236:239], v[96:99], v[140:143]
v_mfma_f32_16x16x32_bf16 v[148:151], v[236:239], v[124:127], v[148:151]
s_nop 1
v_cvt_pk_bf16_f32 v152, v128, v129
v_cvt_pk_bf16_f32 v153, v130, v131
s_nop 1
v_cvt_pk_bf16_f32 v154, v132, v133
v_cvt_pk_bf16_f32 v155, v134, v135
buffer_store_dwordx4 v[152:155], v4, s[16:19], 0 offen sc1
v_cvt_pk_bf16_f32 v156, v136, v137
v_cvt_pk_bf16_f32 v157, v138, v139
v_cvt_pk_bf16_f32 v158, v140, v141
v_cvt_pk_bf16_f32 v159, v142, v143
buffer_store_dwordx4 v[156:159], v4, s[16:19], s38 offen sc1
v_cvt_pk_bf16_f32 v160, v144, v145
v_cvt_pk_bf16_f32 v161, v146, v147
v_cvt_pk_bf16_f32 v162, v148, v149
v_cvt_pk_bf16_f32 v163, v150, v151
buffer_store_dwordx4 v[160:163], v4, s[16:19], s36 offen sc1
s_branch L_p1me
L_p1m1:
s_waitcnt lgkmcnt(13)
v_mfma_f32_16x16x32_bf16 v[128:131], v[184:187], v[44:47], 0
v_mfma_f32_16x16x32_bf16 v[136:139], v[184:187], v[72:75], 0
s_waitcnt lgkmcnt(12)
v_mfma_f32_16x16x32_bf16 v[132:135], v[188:191], v[44:47], 0
v_mfma_f32_16x16x32_bf16 v[140:143], v[188:191], v[72:75], 0
s_waitcnt lgkmcnt(11)
v_mfma_f32_16x16x32_bf16 v[128:131], v[192:195], v[48:51], v[128:131]
v_mfma_f32_16x16x32_bf16 v[136:139], v[192:195], v[76:79], v[136:139]
s_waitcnt lgkmcnt(10)
v_mfma_f32_16x16x32_bf16 v[132:135], v[196:199], v[48:51], v[132:135]
v_mfma_f32_16x16x32_bf16 v[140:143], v[196:199], v[76:79], v[140:143]
s_waitcnt lgkmcnt(9)
v_mfma_f32_16x16x32_bf16 v[128:131], v[200:203], v[52:55], v[128:131]
v_mfma_f32_16x16x32_bf16 v[136:139], v[200:203], v[80:83], v[136:139]
s_waitcnt lgkmcnt(8)
v_mfma_f32_16x16x32_bf16 v[132:135], v[204:207], v[52:55], v[132:135]
v_mfma_f32_16x16x32_bf16 v[140:143], v[204:207], v[80:83], v[140:143]
s_waitcnt lgkmcnt(7)
v_mfma_f32_16x16x32_bf16 v[128:131], v[208:211], v[56:59], v[128:131]
v_mfma_f32_16x16x32_bf16 v[136:139], v[208:211], v[84:87], v[136:139]
s_waitcnt lgkmcnt(6)
v_mfma_f32_16x16x32_bf16 v[132:135], v[212:215], v[56:59], v[132:135]
v_mfma_f32_16x16x32_bf16 v[140:143], v[212:215], v[84:87], v[140:143]
s_waitcnt lgkmcnt(5)
v_mfma_f32_16x16x32_bf16 v[128:131], v[216:219], v[60:63], v[128:131]
v_mfma_f32_16x16x32_bf16 v[136:139], v[216:219], v[88:91], v[136:139]
s_waitcnt lgkmcnt(4)
v_mfma_f32_16x16x32_bf16 v[132:135], v[220:223], v[60:63], v[132:135]
v_mfma_f32_16x16x32_bf16 v[140:143], v[220:223], v[88:91], v[140:143]
s_waitcnt lgkmcnt(3)
v_mfma_f32_16x16x32_bf16 v[128:131], v[224:227], v[64:67], v[128:131]
v_mfma_f32_16x16x32_bf16 v[136:139], v[224:227], v[92:95], v[136:139]
s_waitcnt lgkmcnt(2)
v_mfma_f32_16x16x32_bf16 v[132:135], v[228:231], v[64:67], v[132:135]
v_mfma_f32_16x16x32_bf16 v[140:143], v[228:231], v[92:95], v[140:143]
s_waitcnt lgkmcnt(1)
v_mfma_f32_16x16x32_bf16 v[128:131], v[232:235], v[68:71], v[128:131]
v_mfma_f32_16x16x32_bf16 v[136:139], v[232:235], v[96:99], v[136:139]
s_waitcnt lgkmcnt(0)
v_mfma_f32_16x16x32_bf16 v[132:135], v[236:239], v[68:71], v[132:135]
v_mfma_f32_16x16x32_bf16 v[140:143], v[236:239], v[96:99], v[140:143]
s_nop 3
v_cvt_pk_bf16_f32 v152, v128, v129
v_cvt_pk_bf16_f32 v153, v130, v131
s_nop 0
v_cvt_pk_bf16_f32 v154, v132, v133
v_cvt_pk_bf16_f32 v155, v134, v135
buffer_store_dwordx4 v[152:155], v4, s[16:19], 0 offen sc1
v_cvt_pk_bf16_f32 v156, v136, v137
v_cvt_pk_bf16_f32 v157, v138, v139
v_cvt_pk_bf16_f32 v158, v140, v141
v_cvt_pk_bf16_f32 v159, v142, v143
buffer_store_dwordx4 v[156:159], v4, s[16:19], s38 offen sc1
L_p1me:
L_arrive1:
s_waitcnt vmcnt(0)
s_cmp_lg_u32 s62, 0
s_cbranch_scc1 w0_7
v_readlane_b32 s4, v42, 3
s_nop 0
s_cmp_lg_u32 s4, 0
s_cbranch_scc1 iok_8
s_mov_b32 s3, 0
poll_9:
s_sleep 1
v_lshlrev_b32 v13, 6, v1
v_and_b32 v13, 64, v13
global_load_dword v42, v13, s[58:59] offset:128 sc1
s_waitcnt vmcnt(0)
v_readlane_b32 s4, v42, 3
s_nop 0
s_cmp_lg_u32 s4, 0
s_cbranch_scc1 pollok_10
s_add_u32 s3, s3, 1
s_cmp_lt_u32 s3, 131072
s_cbranch_scc1 poll_9
pollok_10:
iok_8:
w0_7:
s_barrier
s_cmp_lg_u32 s62, 0
s_cbranch_scc1 w0_11
s_and_b32 s4, s2, 15
s_lshl_b32 s4, s4, 8
s_add_u32 s101, s4, 24576
v_mov_b32 v14, 1
s_mov_b64 exec, 1
buffer_atomic_add v14, off, s[12:15], s101 sc0 sc1
s_mov_b64 exec, -1
w0_11:
s_mov_b32 s28, s50
s_and_b32 s29, s51, 0xffff
s_mov_b32 s30, 1605632
s_mov_b32 s31, 0x20000
v_mov_b32 v253, 0
s_cmp_ge_u32 s87, 196
s_cbranch_scc1 L_nclddone
v_lshrrev_b32 v7, 3, v1
v_lshrrev_b32 v8, 1, v7
v_and_b32 v10, 1, v8
v_lshlrev_b32 v10, 2, v10
v_and_b32 v11, 7, v1
v_xor_b32 v10, v10, v11
v_lshlrev_b32 v10, 4, v10
v_lshrrev_b32 v8, 2, v7
v_lshlrev_b32 v8, 3, v8
v_and_b32 v11, 3, v7
v_add_u32 v8, v8, v11
v_mul_u32_u24 v8, 896, v8
s_lshl_b32 s4, s98, 7
s_mul_i32 s5, s62, 57344
s_add_u32 s4, s4, s5
s_lshr_b32 s6, s89, 2
s_lshl_b32 s6, s6, 8
s_and_b32 s5, s89, 3
s_lshl_b32 s5, s5, 4
s_add_u32 s5, s5, s6
s_mul_i32 s5, s5, 896
s_add_u32 s4, s5, s4
s_add_u32 s5, s4, 3584
v_add_u32 v253, v8, v10
s_mov_b32 s68, s4
s_mov_b32 s69, s5
L_nclddone:
s_sub_u32 s4, s2, 1
s_cmp_ge_u32 s4, 31
s_cbranch_scc1 L_p2
s_cmp_lg_u32 s62, 0
s_cbranch_scc1 w0_12
s_waitcnt vmcnt(0)
v_readfirstlane_b32 s3, v14
s_nop 0
s_cmp_lg_u32 s3, 15
s_cbranch_scc1 bl_13
s_mov_b64 exec, 1
s_add_u32 s3, s101, 40960
buffer_store_dword v14, off, s[12:15], s3 sc1
s_mov_b64 exec, -1
bl_13:
w0_12:
s_cmp_ge_u32 s2, 4
s_cbranch_scc1 L_idnc
s_mov_b32 m0, s94
s_nop 0
buffer_load_dwordx4 v253, s[28:31], s68 offen lds
s_add_u32 m0, s94, 1024
s_nop 0
buffer_load_dwordx4 v253, s[28:31], s69 offen lds
v_lshlrev_b32 v41, 4, v1
s_waitcnt vmcnt(0)
v_and_b32 v7, 15, v1
v_lshrrev_b32 v8, 4, v1
v_lshrrev_b32 v12, 2, v7
v_lshrrev_b32 v13, 1, v12
v_lshlrev_b32 v11, 2, v13
v_and_b32 v13, 1, v8
v_lshl_or_b32 v11, v13, 1, v11
v_bfe_u32 v13, v7, 1, 1
v_or_b32 v11, v11, v13
v_lshlrev_b32 v11, 4, v11
v_and_b32 v13, 1, v7
v_lshl_or_b32 v11, v13, 3, v11
v_lshl_or_b32 v11, v12, 7, v11
v_lshrrev_b32 v13, 1, v8
v_lshl_add_u32 v11, v13, 10, v11
v_add_u32 v11, s94, v11
v_xor_b32 v12, 64, v11
ds_read_b64_tr_b16 v[24:25], v11
ds_read_b64_tr_b16 v[26:27], v11 offset:512
ds_read_b64_tr_b16 v[28:29], v12
ds_read_b64_tr_b16 v[30:31], v12 offset:512
s_add_u32 s4, s98, 7
s_lshl_b32 s4, s4, 2
s_add_u32 s4, s4, s62
s_mul_i32 s4, s4, 57344
s_lshl_b32 s5, s89, 11
s_add_u32 s4, s4, s5
s_add_u32 s88, s4, 8388608
s_waitcnt lgkmcnt(2)
buffer_store_dwordx4 v[24:27], v41, s[12:15], s88 offen offset:0 sc1
s_waitcnt lgkmcnt(0)
buffer_store_dwordx4 v[28:31], v41, s[12:15], s88 offen offset:1024 sc1
s_branch L_idarr
L_idnc:
s_sub_u32 s79, s2, 4
s_lshl_b32 s6, s79, 1
s_add_u32 s6, s6, 28
s_mul_i32 s5, s62, 112
v_lshrrev_b32 v7, 3, v1
v_mul_u32_u24 v8, 75264, v7
v_and_b32 v9, 7, v1
v_lshl_add_u32 v8, v9, 4, v8
v_mul_u32_u24 v7, 28, v7
s_lshl_b32 s7, s5, 1
s_mul_i32 s5, s5, 5376
s_lshl_b32 s4, s6, 6
s_add_u32 s4, s4, s5
s_mov_b32 s32, s52
s_and_b32 s33, s53, 0xffff
s_mov_b32 s34, 896
s_mov_b32 s35, 0x20000
s_mov_b32 s28, s54
s_and_b32 s29, s55, 0xffff
s_mov_b32 s30, 2408448
s_mov_b32 s31, 0x20000
buffer_load_dwordx4 v[64:67], v7, s[32:35], s7 offen offset:0
buffer_load_dwordx3 v[68:70], v7, s[32:35], s7 offen offset:16
buffer_load_dwordx4 v[128:131], v8, s[28:31], s4 offen
s_add_u32 s4, s4, 5376
buffer_load_dwordx4 v[132:135], v8, s[28:31], s4 offen
s_add_u32 s4, s4, 5376
buffer_load_dwordx4 v[136:139], v8, s[28:31], s4 offen
s_add_u32 s4, s4, 5376
buffer_load_dwordx4 v[140:143], v8, s[28:31], s4 offen
s_add_u32 s4, s4, 5376
buffer_load_dwordx4 v[144:147], v8, s[28:31], s4 offen
s_add_u32 s4, s4, 5376
buffer_load_dwordx4 v[148:151], v8, s[28:31], s4 offen
s_add_u32 s4, s4, 5376
buffer_load_dwordx4 v[152:155], v8, s[28:31], s4 offen
s_add_u32 s4, s4, 5376
buffer_load_dwordx4 v[156:159], v8, s[28:31], s4 offen
s_add_u32 s4, s4, 5376
buffer_load_dwordx4 v[160:163], v8, s[28:31], s4 offen
s_add_u32 s4, s4, 5376
buffer_load_dwordx4 v[164:167], v8, s[28:31], s4 offen
s_add_u32 s4, s4, 5376
buffer_load_dwordx4 v[168:171], v8, s[28:31], s4 offen
s_add_u32 s4, s4, 5376
buffer_load_dwordx4 v[172:175], v8, s[28:31], s4 offen
s_add_u32 s4, s4, 5376
buffer_load_dwordx4 v[176:179], v8, s[28:31], s4 offen
s_add_u32 s4, s4, 5376
buffer_load_dwordx4 v[180:183], v8, s[28:31], s4 offen
s_waitcnt vmcnt(15)
v_lshlrev_b32 v32, 16, v64
v_and_b32 v33, s99, v64
v_lshlrev_b32 v34, 16, v65
v_and_b32 v35, s99, v65
v_lshlrev_b32 v36, 16, v66
v_and_b32 v37, s99, v66
v_lshlrev_b32 v38, 16, v67
v_and_b32 v39, s99, v67
s_waitcnt vmcnt(14)
v_lshlrev_b32 v40, 16, v68
v_and_b32 v41, s99, v68
v_lshlrev_b32 v42, 16, v69
v_and_b32 v43, s99, v69
v_lshlrev_b32 v44, 16, v70
v_and_b32 v45, s99, v70
v_mul_f32 v64, 0xbfb8aa3b, v32
v_mul_f32 v65, 0xbfb8aa3b, v33
v_mul_f32 v66, 0xbfb8aa3b, v34
v_mul_f32 v67, 0xbfb8aa3b, v35
v_mul_f32 v68, 0xbfb8aa3b, v36
v_mul_f32 v69, 0xbfb8aa3b, v37
v_mul_f32 v70, 0xbfb8aa3b, v38
v_mul_f32 v71, 0xbfb8aa3b, v39
v_mul_f32 v72, 0xbfb8aa3b, v40
v_mul_f32 v73, 0xbfb8aa3b, v41
v_mul_f32 v74, 0xbfb8aa3b, v42
v_mul_f32 v75, 0xbfb8aa3b, v43
v_mul_f32 v76, 0xbfb8aa3b, v44
v_mul_f32 v77, 0xbfb8aa3b, v45
v_exp_f32 v64, v64
v_exp_f32 v65, v65
v_exp_f32 v66, v66
v_exp_f32 v67, v67
v_exp_f32 v68, v68
v_exp_f32 v69, v69
v_exp_f32 v70, v70
v_exp_f32 v71, v71
v_exp_f32 v72, v72
v_exp_f32 v73, v73
v_exp_f32 v74, v74
v_exp_f32 v75, v75
v_exp_f32 v76, v76
v_exp_f32 v77, v77
v_add_f32 v64, 1.0, v64
v_add_f32 v65, 1.0, v65
v_add_f32 v66, 1.0, v66
v_add_f32 v67, 1.0, v67
v_add_f32 v68, 1.0, v68
v_add_f32 v69, 1.0, v69
v_add_f32 v70, 1.0, v70
v_add_f32 v71, 1.0, v71
v_add_f32 v72, 1.0, v72
v_add_f32 v73, 1.0, v73
v_add_f32 v74, 1.0, v74
v_add_f32 v75, 1.0, v75
v_add_f32 v76, 1.0, v76
v_add_f32 v77, 1.0, v77
v_rcp_f32 v64, v64
v_rcp_f32 v65, v65
v_rcp_f32 v66, v66
v_rcp_f32 v67, v67
v_rcp_f32 v68, v68
v_rcp_f32 v69, v69
v_rcp_f32 v70, v70
v_rcp_f32 v71, v71
v_rcp_f32 v72, v72
v_rcp_f32 v73, v73
v_rcp_f32 v74, v74
v_rcp_f32 v75, v75
v_rcp_f32 v76, v76
v_rcp_f32 v77, v77
v_mul_f32 v32, v32, v64
v_mul_f32 v33, v33, v65
v_mul_f32 v34, v34, v66
v_mul_f32 v35, v35, v67
v_mul_f32 v36, v36, v68
v_mul_f32 v37, v37, v69
v_mul_f32 v38, v38, v70
v_mul_f32 v39, v39, v71
v_mul_f32 v40, v40, v72
v_mul_f32 v41, v41, v73
v_mul_f32 v42, v42, v74
v_mul_f32 v43, v43, v75
v_mul_f32 v44, v44, v76
v_mul_f32 v45, v45, v77
v_cvt_pk_bf16_f32 v64, v32, 0
v_lshlrev_b32 v32, 16, v64
v_cvt_pk_bf16_f32 v65, v33, 0
v_lshlrev_b32 v33, 16, v65
v_cvt_pk_bf16_f32 v66, v34, 0
v_lshlrev_b32 v34, 16, v66
v_cvt_pk_bf16_f32 v67, v35, 0
v_lshlrev_b32 v35, 16, v67
v_cvt_pk_bf16_f32 v68, v36, 0
v_lshlrev_b32 v36, 16, v68
v_cvt_pk_bf16_f32 v69, v37, 0
v_lshlrev_b32 v37, 16, v69
v_cvt_pk_bf16_f32 v70, v38, 0
v_lshlrev_b32 v38, 16, v70
v_cvt_pk_bf16_f32 v71, v39, 0
v_lshlrev_b32 v39, 16, v71
v_cvt_pk_bf16_f32 v72, v40, 0
v_lshlrev_b32 v40, 16, v72
v_cvt_pk_bf16_f32 v73, v41, 0
v_lshlrev_b32 v41, 16, v73
v_cvt_pk_bf16_f32 v74, v42, 0
v_lshlrev_b32 v42, 16, v74
v_cvt_pk_bf16_f32 v75, v43, 0
v_lshlrev_b32 v43, 16, v75
v_cvt_pk_bf16_f32 v76, v44, 0
v_lshlrev_b32 v44, 16, v76
v_cvt_pk_bf16_f32 v77, v45, 0
v_lshlrev_b32 v45, 16, v77
v_and_b32 v4, 7, v1
v_lshlrev_b32 v4, 3, v4
v_lshrrev_b32 v3, 4, v1
v_lshl_add_u32 v3, v3, 1, v4
v_lshlrev_b32 v4, 2, v3
s_waitcnt vmcnt(13)
v_dot2_f32_bf16 v16, v128, v64, 0
v_dot2_f32_bf16 v17, v128, v32, 0
v_dot2_f32_bf16 v18, v129, v64, 0
v_dot2_f32_bf16 v19, v129, v32, 0
v_dot2_f32_bf16 v20, v130, v64, 0
v_dot2_f32_bf16 v21, v130, v32, 0
v_dot2_f32_bf16 v22, v131, v64, 0
v_dot2_f32_bf16 v23, v131, v32, 0
s_waitcnt vmcnt(12)
v_dot2_f32_bf16 v16, v132, v65, v16
v_dot2_f32_bf16 v17, v132, v33, v17
v_dot2_f32_bf16 v18, v133, v65, v18
v_dot2_f32_bf16 v19, v133, v33, v19
v_dot2_f32_bf16 v20, v134, v65, v20
v_dot2_f32_bf16 v21, v134, v33, v21
v_dot2_f32_bf16 v22, v135, v65, v22
v_dot2_f32_bf16 v23, v135, v33, v23
s_waitcnt vmcnt(11)
v_dot2_f32_bf16 v16, v136, v66, v16
v_dot2_f32_bf16 v17, v136, v34, v17
v_dot2_f32_bf16 v18, v137, v66, v18
v_dot2_f32_bf16 v19, v137, v34, v19
v_dot2_f32_bf16 v20, v138, v66, v20
v_dot2_f32_bf16 v21, v138, v34, v21
v_dot2_f32_bf16 v22, v139, v66, v22
v_dot2_f32_bf16 v23, v139, v34, v23
s_waitcnt vmcnt(10)
v_dot2_f32_bf16 v16, v140, v67, v16
v_dot2_f32_bf16 v17, v140, v35, v17
v_dot2_f32_bf16 v18, v141, v67, v18
v_dot2_f32_bf16 v19, v141, v35, v19
v_dot2_f32_bf16 v20, v142, v67, v20
v_dot2_f32_bf16 v21, v142, v35, v21
v_dot2_f32_bf16 v22, v143, v67, v22
v_dot2_f32_bf16 v23, v143, v35, v23
s_waitcnt vmcnt(9)
v_dot2_f32_bf16 v16, v144, v68, v16
v_dot2_f32_bf16 v17, v144, v36, v17
v_dot2_f32_bf16 v18, v145, v68, v18
v_dot2_f32_bf16 v19, v145, v36, v19
v_dot2_f32_bf16 v20, v146, v68, v20
v_dot2_f32_bf16 v21, v146, v36, v21
v_dot2_f32_bf16 v22, v147, v68, v22
v_dot2_f32_bf16 v23, v147, v36, v23
s_waitcnt vmcnt(8)
v_dot2_f32_bf16 v16, v148, v69, v16
v_dot2_f32_bf16 v17, v148, v37, v17
v_dot2_f32_bf16 v18, v149, v69, v18
v_dot2_f32_bf16 v19, v149, v37, v19
v_dot2_f32_bf16 v20, v150, v69, v20
v_dot2_f32_bf16 v21, v150, v37, v21
v_dot2_f32_bf16 v22, v151, v69, v22
v_dot2_f32_bf16 v23, v151, v37, v23
s_waitcnt vmcnt(7)
v_dot2_f32_bf16 v16, v152, v70, v16
v_dot2_f32_bf16 v17, v152, v38, v17
v_dot2_f32_bf16 v18, v153, v70, v18
v_dot2_f32_bf16 v19, v153, v38, v19
v_dot2_f32_bf16 v20, v154, v70, v20
v_dot2_f32_bf16 v21, v154, v38, v21
v_dot2_f32_bf16 v22, v155, v70, v22
v_dot2_f32_bf16 v23, v155, v38, v23
s_waitcnt vmcnt(6)
v_dot2_f32_bf16 v16, v156, v71, v16
v_dot2_f32_bf16 v17, v156, v39, v17
v_dot2_f32_bf16 v18, v157, v71, v18
v_dot2_f32_bf16 v19, v157, v39, v19
v_dot2_f32_bf16 v20, v158, v71, v20
v_dot2_f32_bf16 v21, v158, v39, v21
v_dot2_f32_bf16 v22, v159, v71, v22
v_dot2_f32_bf16 v23, v159, v39, v23
s_waitcnt vmcnt(5)
v_dot2_f32_bf16 v16, v160, v72, v16
v_dot2_f32_bf16 v17, v160, v40, v17
v_dot2_f32_bf16 v18, v161, v72, v18
v_dot2_f32_bf16 v19, v161, v40, v19
v_dot2_f32_bf16 v20, v162, v72, v20
v_dot2_f32_bf16 v21, v162, v40, v21
v_dot2_f32_bf16 v22, v163, v72, v22
v_dot2_f32_bf16 v23, v163, v40, v23
s_waitcnt vmcnt(4)
v_dot2_f32_bf16 v16, v164, v73, v16
v_dot2_f32_bf16 v17, v164, v41, v17
v_dot2_f32_bf16 v18, v165, v73, v18
v_dot2_f32_bf16 v19, v165, v41, v19
v_dot2_f32_bf16 v20, v166, v73, v20
v_dot2_f32_bf16 v21, v166, v41, v21
v_dot2_f32_bf16 v22, v167, v73, v22
v_dot2_f32_bf16 v23, v167, v41, v23
s_waitcnt vmcnt(3)
v_dot2_f32_bf16 v16, v168, v74, v16
v_dot2_f32_bf16 v17, v168, v42, v17
v_dot2_f32_bf16 v18, v169, v74, v18
v_dot2_f32_bf16 v19, v169, v42, v19
v_dot2_f32_bf16 v20, v170, v74, v20
v_dot2_f32_bf16 v21, v170, v42, v21
v_dot2_f32_bf16 v22, v171, v74, v22
v_dot2_f32_bf16 v23, v171, v42, v23
s_waitcnt vmcnt(2)
v_dot2_f32_bf16 v16, v172, v75, v16
v_dot2_f32_bf16 v17, v172, v43, v17
v_dot2_f32_bf16 v18, v173, v75, v18
v_dot2_f32_bf16 v19, v173, v43, v19
v_dot2_f32_bf16 v20, v174, v75, v20
v_dot2_f32_bf16 v21, v174, v43, v21
v_dot2_f32_bf16 v22, v175, v75, v22
v_dot2_f32_bf16 v23, v175, v43, v23
s_waitcnt vmcnt(1)
v_dot2_f32_bf16 v16, v176, v76, v16
v_dot2_f32_bf16 v17, v176, v44, v17
v_dot2_f32_bf16 v18, v177, v76, v18
v_dot2_f32_bf16 v19, v177, v44, v19
v_dot2_f32_bf16 v20, v178, v76, v20
v_dot2_f32_bf16 v21, v178, v44, v21
v_dot2_f32_bf16 v22, v179, v76, v22
v_dot2_f32_bf16 v23, v179, v44, v23
s_waitcnt vmcnt(0)
v_dot2_f32_bf16 v16, v180, v77, v16
v_dot2_f32_bf16 v17, v180, v45, v17
v_dot2_f32_bf16 v18, v181, v77, v18
v_dot2_f32_bf16 v19, v181, v45, v19
v_dot2_f32_bf16 v20, v182, v77, v20
v_dot2_f32_bf16 v21, v182, v45, v21
v_dot2_f32_bf16 v22, v183, v77, v22
v_dot2_f32_bf16 v23, v183, v45, v23
v_permlane32_swap_b32 v16, v20
v_permlane32_swap_b32 v17, v21
v_permlane32_swap_b32 v18, v22
v_permlane32_swap_b32 v19, v23
v_add_f32 v16, v16, v20
v_add_f32 v17, v17, v21
v_add_f32 v18, v18, v22
v_add_f32 v19, v19, v23
s_nop 0
v_permlane16_swap_b32 v16, v18
v_permlane16_swap_b32 v17, v19
v_add_f32 v16, v16, v18
v_add_f32 v17, v17, v19
s_nop 0
v_add_f32_dpp v16, v16, v16 row_ror:8 row_mask:0xf bank_mask:0xf
v_add_f32_dpp v17, v17, v17 row_ror:8 row_mask:0xf bank_mask:0xf
s_mov_b32 s6, s79
s_lshl_b32 s4, s62, 8
s_add_u32 s4, s4, 143360
v_add_u32 v4, s4, v4
ds_write_b64 v4, v[16:17]
v_lshlrev_b32 v7, 2, v1
v_add_u32 v7, 143360, v7
s_mul_i32 s5, s6, 37
s_lshr_b32 s5, s5, 8
s_mul_i32 s7, s5, 7
s_sub_u32 s7, s6, s7
s_lshl_b32 s7, s7, 6
s_waitcnt lgkmcnt(0)
s_barrier
ds_read2st64_b32 v[16:17], v7 offset0:0 offset1:1
ds_read2st64_b32 v[18:19], v7 offset0:2 offset1:3
s_waitcnt lgkmcnt(1)
v_add_f32 v16, v16, v17
s_waitcnt lgkmcnt(0)
v_add_f32 v18, v18, v19
v_add_f32 v16, v16, v18
v_add_u32 v3, s7, v1
s_cmp_eq_u32 s5, 2
s_cselect_b32 s7, 1.0, 0
v_cvt_pk_bf16_f32 v16, v16, v16
v_and_b32 v16, s99, v16
v_add_f32 v16, s7, v16
v_cvt_pk_bf16_f32 v16, v16, v16
v_and_b32 v16, s99, v16
s_cmp_ge_u32 s5, 1
s_cselect_b32 s4, 0xbfb8aa3b, 1.0
s_cmp_eq_u32 s5, 3
s_cselect_b32 s7, 0xbf317218, s4
v_mul_f32 v16, s7, v16
s_mul_i32 s4, s5, 1792
s_add_u32 s4, s4, 3584
v_lshlrev_b32 v4, 2, v3
buffer_store_dword v16, v4, s[12:15], s4 offen sc1
v_mul_u32_u24 v7, 586, v3
v_lshrrev_b32 v7, 16, v7
v_mul_u32_u24 v8, 112, v7
v_sub_u32 v3, v3, v8
v_mul_u32_u24 v8, 1171, v3
v_lshrrev_b32 v8, 14, v8
v_mul_u32_u24 v9, 14, v8
v_sub_u32 v3, v3, v9
v_and_b32 v9, 1, v3
v_lshl_add_u32 v8, v8, 1, v9
v_lshrrev_b32 v3, 1, v3
v_lshl_add_u32 v9, v7, 4, v8
v_lshl_add_u32 v9, v9, 3, v3
v_mul_u32_u24 v7, 7, v7
v_add_u32 v7, v7, v3
v_lshl_add_u32 v7, v7, 4, v8
s_lshl_b32 s7, s5, 11
s_add_u32 s7, s7, 12288
s_cmp_eq_u32 s5, 0
s_cselect_b64 vcc, -1, 0
v_cndmask_b32 v7, v7, v9, vcc
v_lshlrev_b32 v7, 2, v7
buffer_store_dword v16, v7, s[12:15], s7 offen sc1
L_idarr:
s_waitcnt vmcnt(0)
s_barrier
s_cmp_lg_u32 s62, 0
s_cbranch_scc1 w0_14
s_and_b32 s4, s2, 15
s_lshl_b32 s4, s4, 8
s_add_u32 s101, s4, 28672
v_mov_b32 v14, 1
s_mov_b64 exec, 1
buffer_atomic_add v14, off, s[12:15], s101 sc0 sc1
s_mov_b64 exec, -1
w0_14:
s_cmp_lg_u32 s62, 0
s_cbranch_scc1 w0_15
s_waitcnt vmcnt(0)
v_readfirstlane_b32 s3, v14
s_nop 0
s_cmp_lg_u32 s3, 15
s_cbranch_scc1 bl_16
s_mov_b64 exec, 1
s_add_u32 s3, s101, 40960
buffer_store_dword v14, off, s[12:15], s3 sc1
s_mov_b64 exec, -1
bl_16:
w0_15:
L_exit:
s_endpgm
L_p2:
v_lshlrev_b32 v2, 4, v1
v_and_b32 v5, 15, v1
v_lshrrev_b32 v6, 4, v1
s_lshl_b32 s4, s96, 2
s_add_u32 s4, s4, s62
s_mul_i32 s4, s4, 7
s_add_u32 s4, s4, s63
s_cmp_eq_u32 s2, 0
s_cselect_b32 s4, 896, s4
s_lshl_b32 s4, s4, 7
s_add_u32 s47, s4, 262144
v_lshlrev_b32 v250, 4, v1
s_mul_i32 s90, s62, 10240
v_add_u32 v250, s90, v250
s_getpc_b64 s[4:5]
pc_17:
s_add_u32 s4, s4, const_tbl-pc_17
s_addc_u32 s5, s5, 0
v_mov_b32 v249, s5
v_add_co_u32 v248, vcc, s4, v250
s_nop 1
v_addc_co_u32 v249, vcc, 0, v249, vcc
s_lshl_b32 s4, s62, 2
s_add_u32 s4, s4, s97
s_mul_i32 s91, s4, 896
s_mul_i32 s93, s62, 14592
s_add_u32 s93, s93, 49152
s_mov_b32 s95, 0xffffff
s_add_u32 m0, s90, 0
s_nop 0
global_load_lds_dwordx4 v[248:249], off offset:0
s_lshl_b32 s4, s62, 4
v_add_u32 v7, s4, v5
v_cvt_f32_u32 v7, v7
v_cvt_f32_u32 v8, v6
s_mov_b32 s5, 0x80008000
v_mul_f32 v9, 0x3c800000, v7
v_mul_f32 v10, 0x41000000, v8
v_mul_f32 v10, v10, v9
global_load_lds_dwordx4 v[248:249], off offset:1024
v_cos_f32 v96, v10
v_sin_f32 v104, v10
v_add_f32 v10, v10, v9
v_cos_f32 v97, v10
v_sin_f32 v105, v10
v_add_f32 v10, v10, v9
global_load_lds_dwordx4 v[248:249], off offset:2048
v_cos_f32 v98, v10
v_sin_f32 v106, v10
v_add_f32 v10, v10, v9
v_cos_f32 v99, v10
v_sin_f32 v107, v10
v_add_f32 v10, v10, v9
global_load_lds_dwordx4 v[248:249], off offset:3072
v_cos_f32 v100, v10
v_sin_f32 v108, v10
v_add_f32 v10, v10, v9
v_cos_f32 v101, v10
v_sin_f32 v109, v10
v_add_f32 v10, v10, v9
v_add_co_u32 v248, vcc, 4096, v248
s_nop 1
v_addc_co_u32 v249, vcc, 0, v249, vcc
s_add_u32 m0, s90, 4096
s_nop 0
global_load_lds_dwordx4 v[248:249], off offset:0
v_cos_f32 v102, v10
v_sin_f32 v110, v10
v_add_f32 v10, v10, v9
v_cos_f32 v103, v10
v_sin_f32 v111, v10
global_load_lds_dwordx4 v[248:249], off offset:1024
v_cvt_pk_bf16_f32 v16, v96, v97
v_cvt_pk_bf16_f32 v20, v104, v105
v_cvt_pk_bf16_f32 v17, v98, v99
v_cvt_pk_bf16_f32 v21, v106, v107
v_cvt_pk_bf16_f32 v18, v100, v101
v_cvt_pk_bf16_f32 v22, v108, v109
v_cvt_pk_bf16_f32 v19, v102, v103
v_cvt_pk_bf16_f32 v23, v110, v111
global_load_lds_dwordx4 v[248:249], off offset:2048
v_xor_b32 v80, s5, v20
v_xor_b32 v81, s5, v21
v_xor_b32 v82, s5, v22
v_xor_b32 v83, s5, v23
v_and_b32 v11, 1, v5
v_mul_lo_u32 v11, v11, s5
v_xor_b32 v24, v11, v16
v_xor_b32 v25, v11, v17
s_cmp_lg_u32 s62, 0
s_cbranch_scc1 w0_18
s_waitcnt vmcnt(7)
v_readfirstlane_b32 s3, v14
s_nop 0
s_cmp_lg_u32 s3, 15
s_cbranch_scc1 bl_19
s_mov_b64 exec, 1
s_add_u32 s3, s101, 40960
buffer_store_dword v14, off, s[12:15], s3 sc1
s_mov_b64 exec, -1
bl_19:
w0_18:
v_xor_b32 v26, v11, v18
global_load_lds_dwordx4 v[248:249], off offset:3072
v_xor_b32 v27, v11, v19
v_xor_b32 v28, v11, v20
v_xor_b32 v29, v11, v21
v_xor_b32 v30, v11, v22
v_xor_b32 v31, v11, v23
v_xor_b32 v84, v11, v80
v_xor_b32 v85, v11, v81
v_xor_b32 v86, v11, v82
v_add_co_u32 v248, vcc, 4096, v248
s_nop 1
v_addc_co_u32 v249, vcc, 0, v249, vcc
s_add_u32 m0, s90, 8192
s_nop 0
global_load_lds_dwordx4 v[248:249], off offset:0
v_xor_b32 v87, v11, v83
v_cvt_f32_u32 v11, v5
v_mul_f32 v9, 0x3d000000, v11
v_mul_f32 v10, 4.0, v8
v_mul_f32 v10, v10, v9
global_load_lds_dwordx4 v[248:249], off offset:1024
v_cos_f32 v96, v10
v_sin_f32 v104, v10
v_add_f32 v10, v10, v9
v_cos_f32 v97, v10
v_sin_f32 v105, v10
v_add_f32 v10, v10, v9
s_cmp_ge_u32 s87, 196
s_cbranch_scc1 L_nopre6
s_mov_b32 m0, s94
s_nop 0
buffer_load_dwordx4 v253, s[28:31], s68 offen lds
s_add_u32 m0, s94, 1024
s_nop 0
buffer_load_dwordx4 v253, s[28:31], s69 offen lds
L_nopre6:
v_cos_f32 v98, v10
v_sin_f32 v106, v10
s_add_u32 m0, s93, 0
s_add_u32 s92, s91, 0
s_mov_b32 exec_hi, s95
buffer_load_dwordx4 v2, s[8:11], s92 offen lds
s_mov_b32 exec_hi, -1
v_add_f32 v10, v10, v9
v_cos_f32 v99, v10
v_sin_f32 v107, v10
s_add_u32 m0, s93, 912
s_add_u32 s92, s91, 28672
s_mov_b32 exec_hi, s95
buffer_load_dwordx4 v2, s[8:11], s92 offen lds
s_mov_b32 exec_hi, -1
v_fmamk_f32 v10, v9, 0x41500000, v10
v_cos_f32 v100, v10
v_sin_f32 v108, v10
s_add_u32 m0, s93, 1824
s_add_u32 s92, s91, 57344
s_mov_b32 exec_hi, s95
buffer_load_dwordx4 v2, s[8:11], s92 offen lds
s_mov_b32 exec_hi, -1
v_add_f32 v10, v10, v9
v_cos_f32 v101, v10
v_sin_f32 v109, v10
s_add_u32 m0, s93, 2736
s_add_u32 s92, s91, 86016
s_mov_b32 exec_hi, s95
buffer_load_dwordx4 v2, s[8:11], s92 offen lds
s_mov_b32 exec_hi, -1
v_add_f32 v10, v10, v9
v_cos_f32 v102, v10
v_sin_f32 v110, v10
s_add_u32 m0, s93, 3648
s_add_u32 s92, s91, 896
s_mov_b32 exec_hi, s95
buffer_load_dwordx4 v2, s[8:11], s92 offen lds
s_mov_b32 exec_hi, -1
v_add_f32 v10, v10, v9
v_cos_f32 v103, v10
v_sin_f32 v111, v10
s_add_u32 m0, s93, 4560
s_add_u32 s92, s91, 29568
s_mov_b32 exec_hi, s95
buffer_load_dwordx4 v2, s[8:11], s92 offen lds
s_mov_b32 exec_hi, -1
v_cvt_pk_bf16_f32 v64, v96, v97
v_cvt_pk_bf16_f32 v68, v104, v105
v_cvt_pk_bf16_f32 v65, v98, v99
v_cvt_pk_bf16_f32 v69, v106, v107
s_add_u32 m0, s93, 5472
s_add_u32 s92, s91, 58240
s_mov_b32 exec_hi, s95
buffer_load_dwordx4 v2, s[8:11], s92 offen lds
s_mov_b32 exec_hi, -1
v_cvt_pk_bf16_f32 v66, v100, v101
v_cvt_pk_bf16_f32 v70, v108, v109
v_cvt_pk_bf16_f32 v67, v102, v103
v_cvt_pk_bf16_f32 v71, v110, v111
s_add_u32 m0, s93, 6384
s_add_u32 s92, s91, 86912
s_mov_b32 exec_hi, s95
buffer_load_dwordx4 v2, s[8:11], s92 offen lds
s_mov_b32 exec_hi, -1
v_xor_b32 v88, s5, v68
v_xor_b32 v89, s5, v69
v_xor_b32 v90, s5, v70
v_xor_b32 v91, s5, v71
s_add_u32 m0, s93, 7296
s_add_u32 s92, s91, 1792
s_mov_b32 exec_hi, s95
buffer_load_dwordx4 v2, s[8:11], s92 offen lds
s_mov_b32 exec_hi, -1
s_brev_b32 s5, 1
v_xor_b32 v72, s5, v64
v_xor_b32 v73, s5, v65
v_xor_b32 v74, s5, v66
s_add_u32 m0, s93, 8208
s_add_u32 s92, s91, 30464
s_mov_b32 exec_hi, s95
buffer_load_dwordx4 v2, s[8:11], s92 offen lds
s_mov_b32 exec_hi, -1
v_xor_b32 v75, s5, v67
v_xor_b32 v76, s5, v68
v_xor_b32 v77, s5, v69
v_xor_b32 v78, s5, v70
s_add_u32 m0, s93, 9120
s_add_u32 s92, s91, 59136
s_mov_b32 exec_hi, s95
buffer_load_dwordx4 v2, s[8:11], s92 offen lds
s_mov_b32 exec_hi, -1
v_xor_b32 v79, s5, v71
v_xor_b32 v92, s5, v88
v_xor_b32 v93, s5, v89
v_xor_b32 v94, s5, v90
s_add_u32 m0, s93, 10032
s_add_u32 s92, s91, 87808
s_mov_b32 exec_hi, s95
buffer_load_dwordx4 v2, s[8:11], s92 offen lds
s_mov_b32 exec_hi, -1
v_xor_b32 v95, s5, v91
v_mul_f32 v9, 0x3a000000, v11
v_cvt_f32_u32 v10, s4
v_fmac_f32 v10, 4.0, v8
v_mul_f32 v10, v10, v9
s_add_u32 m0, s93, 10944
s_add_u32 s92, s91, 2688
s_mov_b32 exec_hi, s95
buffer_load_dwordx4 v2, s[8:11], s92 offen lds
s_mov_b32 exec_hi, -1
v_cos_f32 v48, v10
v_sin_f32 v52, v10
v_add_f32 v10, v10, v9
s_add_u32 m0, s93, 11856
s_add_u32 s92, s91, 31360
s_mov_b32 exec_hi, s95
buffer_load_dwordx4 v2, s[8:11], s92 offen lds
s_mov_b32 exec_hi, -1
v_cos_f32 v49, v10
v_sin_f32 v53, v10
v_add_f32 v10, v10, v9
s_add_u32 m0, s93, 12768
s_add_u32 s92, s91, 60032
s_mov_b32 exec_hi, s95
buffer_load_dwordx4 v2, s[8:11], s92 offen lds
s_mov_b32 exec_hi, -1
v_cos_f32 v50, v10
v_sin_f32 v54, v10
v_add_f32 v10, v10, v9
s_add_u32 m0, s93, 13680
s_add_u32 s92, s91, 88704
s_mov_b32 exec_hi, s95
buffer_load_dwordx4 v2, s[8:11], s92 offen lds
s_mov_b32 exec_hi, -1
v_cos_f32 v51, v10
v_sin_f32 v55, v10
v_add_f32 v11, 0x41800000, v11
v_mul_f32 v9, 0x3a000000, v11
v_cvt_f32_u32 v10, s4
v_fmac_f32 v10, 4.0, v8
v_mul_f32 v10, v10, v9
v_cos_f32 v56, v10
v_sin_f32 v60, v10
v_add_f32 v10, v10, v9
v_cos_f32 v57, v10
v_sin_f32 v61, v10
v_add_f32 v10, v10, v9
v_cos_f32 v58, v10
v_sin_f32 v62, v10
v_add_f32 v10, v10, v9
v_cos_f32 v59, v10
v_sin_f32 v63, v10
v_mul_f32 v9, 0x3a000000, v7
v_mul_f32 v10, 4.0, v8
v_mul_f32 v10, v10, v9
s_mov_b32 s5, 0x35924925
v_cos_f32 v32, v10
v_sin_f32 v36, v10
v_add_f32 v10, v10, v9
v_cos_f32 v33, v10
v_sin_f32 v37, v10
v_add_f32 v10, v10, v9
v_cos_f32 v34, v10
v_sin_f32 v38, v10
v_add_f32 v10, v10, v9
v_cos_f32 v35, v10
v_sin_f32 v39, v10
v_fmamk_f32 v10, v9, 0x41500000, v10
v_cos_f32 v40, v10
v_sin_f32 v44, v10
v_add_f32 v10, v10, v9
v_cos_f32 v41, v10
v_sin_f32 v45, v10
v_add_f32 v10, v10, v9
v_cos_f32 v42, v10
v_sin_f32 v46, v10
v_add_f32 v10, v10, v9
v_cos_f32 v43, v10
v_sin_f32 v47, v10
v_mul_f32 v48, s5, v48
v_mul_f32 v49, s5, v49
v_mul_f32 v50, s5, v50
v_mul_f32 v51, s5, v51
v_mul_f32 v52, s5, v52
v_mul_f32 v53, s5, v53
v_mul_f32 v54, s5, v54
v_mul_f32 v55, s5, v55
v_mul_f32 v56, s5, v56
v_mul_f32 v57, s5, v57
v_mul_f32 v58, s5, v58
v_mul_f32 v59, s5, v59
v_mul_f32 v60, s5, v60
v_mul_f32 v61, s5, v61
v_mul_f32 v62, s5, v62
v_mul_f32 v63, s5, v63
L_w1end:
v_mul_u32_u24 v10, 160, v5
v_add_u32 v10, 107520, v10
v_lshl_add_u32 v11, v6, 4, v10
v_lshl_add_u32 v10, v6, 3, v10
s_lshl_b32 s7, s62, 5
v_add_u32 v10, s7, v10
s_lshl_b32 s4, s63, 2
s_add_u32 s4, s4, s62
s_mul_i32 s4, s4, 57344
s_add_u32 s37, s4, 8388608
v_add_u32 v9, 118784, v2
s_cmp_lg_u32 s62, 0
s_cbranch_scc1 w0_20
v_lshlrev_b32 v13, 8, v1
s_mov_b32 s4, 65536
s_mov_b64 exec, 0xffff
s_mov_b32 s3, 0
poll_21:
buffer_load_dword v14, v13, s[12:15], s4 offen sc1
s_waitcnt vmcnt(0)
v_cmp_gt_u32 vcc, 1, v14
s_nop 0
s_cbranch_vccz pollok_22
s_add_u32 s3, s3, 1
s_cmp_lt_u32 s3, 131072
s_cbranch_scc1 poll_21
pollok_22:
s_mov_b64 exec, -1
w0_20:
s_barrier
v_lshlrev_b32 v12, 9, v6
v_lshl_add_u32 v12, v5, 3, v12
s_lshl_b32 s4, s46, 13
s_lshl_b32 s5, s62, 11
s_add_u32 s4, s4, s5
s_add_u32 m0, s5, 118784
s_nop 0
buffer_load_dwordx4 v2, s[16:19], s4 offen sc1 lds
buffer_load_dwordx4 v2, s[16:19], s4 offen offset:1024 sc1 lds
buffer_load_dwordx4 v[160:163], v2, s[24:27], s4 offen offset:0 sc1
buffer_load_dwordx4 v[164:167], v2, s[24:27], s4 offen offset:1024 sc1
s_cmp_ge_u32 s87, 196
s_cbranch_scc1 L_nopre4
s_mov_b32 s92, s4
v_mov_b32 v192, v11
v_mov_b32 v193, v12
s_waitcnt vmcnt(4)
v_and_b32 v7, 15, v1
v_lshrrev_b32 v8, 4, v1
v_lshrrev_b32 v12, 2, v7
v_lshrrev_b32 v13, 1, v12
v_lshlrev_b32 v11, 2, v13
v_and_b32 v13, 1, v8
v_lshl_or_b32 v11, v13, 1, v11
v_bfe_u32 v13, v7, 1, 1
v_or_b32 v11, v11, v13
v_lshlrev_b32 v11, 4, v11
v_and_b32 v13, 1, v7
v_lshl_or_b32 v11, v13, 3, v11
v_lshl_or_b32 v11, v12, 7, v11
v_lshrrev_b32 v13, 1, v8
v_lshl_add_u32 v11, v13, 10, v11
v_add_u32 v11, s94, v11
v_xor_b32 v12, 64, v11
ds_read_b64_tr_b16 v[184:185], v11
ds_read_b64_tr_b16 v[186:187], v11 offset:512
ds_read_b64_tr_b16 v[188:189], v12
ds_read_b64_tr_b16 v[190:191], v12 offset:512
s_add_u32 s4, s98, 7
s_lshl_b32 s4, s4, 2
s_add_u32 s4, s4, s62
s_mul_i32 s4, s4, 57344
s_lshl_b32 s5, s89, 11
s_add_u32 s4, s4, s5
s_add_u32 s88, s4, 8388608
s_mov_b32 s4, s92
v_mov_b32 v11, v192
v_mov_b32 v12, v193
s_waitcnt lgkmcnt(0)
L_nopre4:
s_waitcnt vmcnt(2)
s_barrier
ds_read_b128 v[96:99], v9 offset:0
ds_read_b128 v[104:107], v9 offset:2048
ds_read_b128 v[112:115], v9 offset:4096
ds_read_b128 v[120:123], v9 offset:6144
ds_read_b128 v[100:103], v9 offset:1024
ds_read_b128 v[108:111], v9 offset:3072
ds_read_b128 v[116:119], v9 offset:5120
ds_read_b128 v[124:127], v9 offset:7168
s_waitcnt lgkmcnt(7)
v_mfma_f32_16x16x32_bf16 v[144:147], v[96:99], v[16:19], 0
s_waitcnt lgkmcnt(5)
v_mfma_f32_16x16x32_bf16 v[152:155], v[112:115], v[16:19], 0
v_mfma_f32_16x16x32_bf16 v[148:151], v[104:107], v[16:19], 0
s_waitcnt lgkmcnt(4)
v_mfma_f32_16x16x32_bf16 v[156:159], v[120:123], v[16:19], 0
v_mfma_f32_16x16x32_bf16 v[144:147], v[112:115], v[20:23], v[144:147]
v_mfma_f32_16x16x32_bf16 v[152:155], v[96:99], v[80:83], v[152:155]
v_mfma_f32_16x16x32_bf16 v[148:151], v[120:123], v[20:23], v[148:151]
s_add_u32 s36, s37, 0
buffer_load_dwordx4 a[0:3], v2, s[12:15], s36 offen offset:0 sc1
v_mfma_f32_16x16x32_bf16 v[156:159], v[104:107], v[80:83], v[156:159]
s_waitcnt lgkmcnt(3)
v_mfma_f32_16x16x32_bf16 v[144:147], v[100:103], v[24:27], v[144:147]
s_waitcnt lgkmcnt(1)
v_mfma_f32_16x16x32_bf16 v[152:155], v[116:119], v[24:27], v[152:155]
v_mfma_f32_16x16x32_bf16 v[148:151], v[108:111], v[24:27], v[148:151]
s_waitcnt lgkmcnt(0)
v_mfma_f32_16x16x32_bf16 v[156:159], v[124:127], v[24:27], v[156:159]
v_mfma_f32_16x16x32_bf16 v[144:147], v[116:119], v[28:31], v[144:147]
v_mfma_f32_16x16x32_bf16 v[152:155], v[100:103], v[84:87], v[152:155]
v_mfma_f32_16x16x32_bf16 v[148:151], v[124:127], v[28:31], v[148:151]
v_mfma_f32_16x16x32_bf16 v[156:159], v[108:111], v[84:87], v[156:159]
s_waitcnt vmcnt(2)
v_lshlrev_b32 v128, 16, v160
v_and_b32 v129, s99, v160
v_lshlrev_b32 v130, 16, v161
v_and_b32 v131, s99, v161
v_lshlrev_b32 v136, 16, v162
v_and_b32 v137, s99, v162
v_lshlrev_b32 v138, 16, v163
v_and_b32 v139, s99, v163
s_waitcnt vmcnt(1)
v_lshlrev_b32 v132, 16, v164
v_and_b32 v133, s99, v164
buffer_load_dwordx4 a[112:115], v2, s[12:15], s36 offen offset:1024 sc1
v_lshlrev_b32 v134, 16, v165
v_and_b32 v135, s99, v165
v_lshlrev_b32 v140, 16, v166
v_and_b32 v141, s99, v166
v_lshlrev_b32 v142, 16, v167
v_and_b32 v143, s99, v167
v_mov_b32 v13, 0
s_mov_b64 exec, 1
buffer_store_dword v13, off, s[12:15], s47 sc1
s_mov_b64 exec, -1
s_cmp_ge_u32 s87, 196
s_cbranch_scc1 L_nopre5
buffer_store_dwordx4 v[184:187], v2, s[12:15], s88 offen offset:0 sc1
buffer_store_dwordx4 v[188:191], v2, s[12:15], s88 offen offset:1024 sc1
L_nopre5:
v_pk_mul_f32 v[160:161], v[144:145], v[32:33]
v_pk_mul_f32 v[168:169], v[152:153], v[32:33]
v_pk_mul_f32 v[162:163], v[146:147], v[34:35]
v_pk_mul_f32 v[170:171], v[154:155], v[34:35]
v_pk_fma_f32 v[160:161], v[152:153], v[36:37], v[160:161]
v_pk_fma_f32 v[168:169], v[144:145], v[36:37], v[168:169] neg_lo:[1,0,0] neg_hi:[1,0,0]
v_pk_fma_f32 v[162:163], v[154:155], v[38:39], v[162:163]
v_pk_fma_f32 v[170:171], v[146:147], v[38:39], v[170:171] neg_lo:[1,0,0] neg_hi:[1,0,0]
v_pk_mul_f32 v[164:165], v[148:149], v[40:41]
v_pk_mul_f32 v[172:173], v[156:157], v[40:41]
v_pk_mul_f32 v[166:167], v[150:151], v[42:43]
v_pk_mul_f32 v[174:175], v[158:159], v[42:43]
v_pk_fma_f32 v[164:165], v[156:157], v[44:45], v[164:165]
v_pk_fma_f32 v[172:173], v[148:149], v[44:45], v[172:173] neg_lo:[1,0,0] neg_hi:[1,0,0]
v_pk_fma_f32 v[166:167], v[158:159], v[46:47], v[166:167]
v_pk_fma_f32 v[174:175], v[150:151], v[46:47], v[174:175] neg_lo:[1,0,0] neg_hi:[1,0,0]
v_cvt_pk_bf16_f32 v176, v160, v161
v_cvt_pk_bf16_f32 v177, v162, v163
v_cvt_pk_bf16_f32 v178, v164, v165
v_cvt_pk_bf16_f32 v179, v166, v167
v_cvt_pk_bf16_f32 v180, v168, v169
v_cvt_pk_bf16_f32 v181, v170, v171
v_cvt_pk_bf16_f32 v182, v172, v173
v_cvt_pk_bf16_f32 v183, v174, v175
v_mfma_f32_16x16x32_bf16 v[144:147], v[64:67], v[176:179], 0
buffer_load_dwordx4 a[4:7], v2, s[12:15], s36 offen offset:2048 sc1
v_mfma_f32_16x16x32_bf16 v[152:155], v[64:67], v[180:183], 0
v_mfma_f32_16x16x32_bf16 v[148:151], v[72:75], v[176:179], 0
v_mfma_f32_16x16x32_bf16 v[156:159], v[72:75], v[180:183], 0
v_mfma_f32_16x16x32_bf16 v[144:147], v[68:71], v[180:183], v[144:147]
v_mfma_f32_16x16x32_bf16 v[152:155], v[88:91], v[176:179], v[152:155]
v_mfma_f32_16x16x32_bf16 v[148:151], v[76:79], v[180:183], v[148:151]
v_mfma_f32_16x16x32_bf16 v[156:159], v[92:95], v[176:179], v[156:159]
s_nop 4
v_pk_mul_f32 v[160:161], v[144:145], v[128:129]
v_pk_mul_f32 v[168:169], v[152:153], v[128:129]
v_pk_mul_f32 v[162:163], v[146:147], v[130:131]
v_pk_mul_f32 v[170:171], v[154:155], v[130:131]
v_pk_fma_f32 v[160:161], v[152:153], v[136:137], v[160:161] neg_lo:[1,0,0] neg_hi:[1,0,0]
v_pk_fma_f32 v[168:169], v[144:145], v[136:137], v[168:169]
v_pk_fma_f32 v[162:163], v[154:155], v[138:139], v[162:163] neg_lo:[1,0,0] neg_hi:[1,0,0]
v_pk_fma_f32 v[170:171], v[146:147], v[138:139], v[170:171]
v_pk_mul_f32 v[164:165], v[148:149], v[132:133]
v_pk_mul_f32 v[172:173], v[156:157], v[132:133]
v_pk_mul_f32 v[166:167], v[150:151], v[134:135]
v_pk_mul_f32 v[174:175], v[158:159], v[134:135]
v_pk_fma_f32 v[164:165], v[156:157], v[140:141], v[164:165] neg_lo:[1,0,0] neg_hi:[1,0,0]
v_pk_fma_f32 v[172:173], v[148:149], v[140:141], v[172:173]
v_pk_fma_f32 v[166:167], v[158:159], v[142:143], v[166:167] neg_lo:[1,0,0] neg_hi:[1,0,0]
v_pk_fma_f32 v[174:175], v[150:151], v[142:143], v[174:175]
v_cvt_pk_bf16_f32 v176, v160, v161
buffer_load_dwordx4 a[116:119], v2, s[12:15], s36 offen offset:3072 sc1
v_cvt_pk_bf16_f32 v177, v162, v163
v_cvt_pk_bf16_f32 v178, v164, v165
v_cvt_pk_bf16_f32 v179, v166, v167
v_cvt_pk_bf16_f32 v180, v168, v169
v_cvt_pk_bf16_f32 v181, v170, v171
v_cvt_pk_bf16_f32 v182, v172, v173
v_cvt_pk_bf16_f32 v183, v174, v175
v_mfma_f32_16x16x32_bf16 v[144:147], v[176:179], v[64:67], 0
s_nop 0
v_mfma_f32_16x16x32_bf16 v[152:155], v[180:183], v[64:67], 0
v_mfma_f32_16x16x32_bf16 v[148:151], v[176:179], v[72:75], 0
v_mfma_f32_16x16x32_bf16 v[156:159], v[180:183], v[72:75], 0
v_mfma_f32_16x16x32_bf16 v[144:147], v[180:183], v[88:91], v[144:147]
v_mfma_f32_16x16x32_bf16 v[152:155], v[176:179], v[68:71], v[152:155]
v_mfma_f32_16x16x32_bf16 v[148:151], v[180:183], v[92:95], v[148:151]
v_mfma_f32_16x16x32_bf16 v[156:159], v[176:179], v[76:79], v[156:159]
s_nop 4
v_pk_mul_f32 v[160:161], v[144:145], v[48:49]
v_pk_mul_f32 v[168:169], v[152:153], v[48:49]
v_pk_mul_f32 v[162:163], v[146:147], v[50:51]
v_pk_mul_f32 v[170:171], v[154:155], v[50:51]
v_pk_fma_f32 v[160:161], v[152:153], v[52:53], v[160:161] neg_lo:[1,0,0] neg_hi:[1,0,0]
v_pk_fma_f32 v[168:169], v[144:145], v[52:53], v[168:169]
v_pk_fma_f32 v[162:163], v[154:155], v[54:55], v[162:163] neg_lo:[1,0,0] neg_hi:[1,0,0]
v_pk_fma_f32 v[170:171], v[146:147], v[54:55], v[170:171]
s_add_u32 s36, s37, 4096
buffer_load_dwordx4 a[8:11], v2, s[12:15], s36 offen offset:0 sc1
v_pk_mul_f32 v[164:165], v[148:149], v[56:57]
v_pk_mul_f32 v[172:173], v[156:157], v[56:57]
v_pk_mul_f32 v[166:167], v[150:151], v[58:59]
v_pk_mul_f32 v[174:175], v[158:159], v[58:59]
v_pk_fma_f32 v[164:165], v[156:157], v[60:61], v[164:165] neg_lo:[1,0,0] neg_hi:[1,0,0]
v_pk_fma_f32 v[172:173], v[148:149], v[60:61], v[172:173]
v_pk_fma_f32 v[166:167], v[158:159], v[62:63], v[166:167] neg_lo:[1,0,0] neg_hi:[1,0,0]
v_pk_fma_f32 v[174:175], v[150:151], v[62:63], v[174:175]
v_cvt_pk_bf16_f32 v176, v160, v161
v_cvt_pk_bf16_f32 v177, v162, v163
v_cvt_pk_bf16_f32 v178, v164, v165
v_cvt_pk_bf16_f32 v179, v166, v167
v_cvt_pk_bf16_f32 v180, v168, v169
v_cvt_pk_bf16_f32 v181, v170, v171
v_cvt_pk_bf16_f32 v182, v172, v173
v_cvt_pk_bf16_f32 v183, v174, v175
ds_write_b64 v10, v[176:177] offset:0
ds_write_b64 v10, v[178:179] offset:2560
ds_write_b64 v10, v[180:181] offset:5120
ds_write_b64 v10, v[182:183] offset:7680
s_waitcnt lgkmcnt(0)
s_barrier
ds_read_b128 v[96:99], v11 offset:0
ds_read_b128 v[104:107], v11 offset:2560
ds_read_b128 v[112:115], v11 offset:5120
ds_read_b128 v[120:123], v11 offset:7680
ds_read_b128 v[100:103], v11 offset:64
buffer_load_dwordx4 a[120:123], v2, s[12:15], s36 offen offset:1024 sc1
ds_read_b128 v[108:111], v11 offset:2624
ds_read_b128 v[116:119], v11 offset:5184
ds_read_b128 v[124:127], v11 offset:7744
s_waitcnt lgkmcnt(7)
v_mfma_f32_16x16x32_bf16 v[144:147], v[16:19], v[96:99], 0
s_waitcnt lgkmcnt(5)
v_mfma_f32_16x16x32_bf16 v[152:155], v[16:19], v[112:115], 0
v_mfma_f32_16x16x32_bf16 v[148:151], v[16:19], v[104:107], 0
s_waitcnt lgkmcnt(4)
v_mfma_f32_16x16x32_bf16 v[156:159], v[16:19], v[120:123], 0
v_mfma_f32_16x16x32_bf16 v[144:147], v[80:83], v[112:115], v[144:147]
v_mfma_f32_16x16x32_bf16 v[152:155], v[20:23], v[96:99], v[152:155]
v_mfma_f32_16x16x32_bf16 v[148:151], v[80:83], v[120:123], v[148:151]
v_mfma_f32_16x16x32_bf16 v[156:159], v[20:23], v[104:107], v[156:159]
s_waitcnt lgkmcnt(3)
v_mfma_f32_16x16x32_bf16 v[144:147], v[24:27], v[100:103], v[144:147]
s_waitcnt lgkmcnt(1)
v_mfma_f32_16x16x32_bf16 v[152:155], v[24:27], v[116:119], v[152:155]
v_mfma_f32_16x16x32_bf16 v[148:151], v[24:27], v[108:111], v[148:151]
s_waitcnt lgkmcnt(0)
v_mfma_f32_16x16x32_bf16 v[156:159], v[24:27], v[124:127], v[156:159]
buffer_load_dwordx4 a[12:15], v2, s[12:15], s36 offen offset:2048 sc1
v_mfma_f32_16x16x32_bf16 v[144:147], v[84:87], v[116:119], v[144:147]
v_mfma_f32_16x16x32_bf16 v[152:155], v[28:31], v[100:103], v[152:155]
v_mfma_f32_16x16x32_bf16 v[148:151], v[84:87], v[124:127], v[148:151]
v_mfma_f32_16x16x32_bf16 v[156:159], v[28:31], v[108:111], v[156:159]
s_nop 4
v_cvt_pk_bf16_f32 v160, v144, v145
v_cvt_pk_bf16_f32 v161, v146, v147
buffer_store_dwordx2 v[160:161], v12, s[20:23], s4 offen offset:0 sc1
v_cvt_pk_bf16_f32 v162, v152, v153
v_cvt_pk_bf16_f32 v163, v154, v155
buffer_store_dwordx2 v[162:163], v12, s[20:23], s4 offen offset:128 sc1
v_cvt_pk_bf16_f32 v164, v148, v149
v_cvt_pk_bf16_f32 v165, v150, v151
buffer_store_dwordx2 v[164:165], v12, s[20:23], s4 offen offset:256 sc1
v_cvt_pk_bf16_f32 v166, v156, v157
v_cvt_pk_bf16_f32 v167, v158, v159
buffer_store_dwordx2 v[166:167], v12, s[20:23], s4 offen offset:384 sc1
buffer_load_dwordx4 a[124:127], v2, s[12:15], s36 offen offset:3072 sc1
s_add_u32 s36, s37, 8192
buffer_load_dwordx4 a[16:19], v2, s[12:15], s36 offen offset:0 sc1
buffer_load_dwordx4 a[128:131], v2, s[12:15], s36 offen offset:1024 sc1
s_waitcnt vmcnt(3)
s_barrier
s_cmp_lg_u32 s62, 0
s_cbranch_scc1 w0_23
s_and_b32 s4, s2, 15
s_lshl_b32 s4, s4, 8
s_add_u32 s101, s4, 28672
v_mov_b32 v14, 1
s_mov_b64 exec, 1
buffer_atomic_add v14, off, s[12:15], s101 sc0 sc1
s_mov_b64 exec, -1
w0_23:
s_cmp_lg_u32 s2, 0
s_cbranch_scc1 L_p3
s_cmp_lg_u32 s62, 0
s_cbranch_scc1 w0_24
s_waitcnt vmcnt(0)
v_readfirstlane_b32 s3, v14
s_nop 0
s_cmp_lg_u32 s3, 15
s_cbranch_scc1 bl_25
s_mov_b64 exec, 1
s_add_u32 s3, s101, 40960
buffer_store_dword v14, off, s[12:15], s3 sc1
s_mov_b64 exec, -1
bl_25:
w0_24:
s_branch L_exit
L_p3:
s_lshl_b32 s4, s62, 4
v_add_u32 v10, s4, v5
v_mul_u32_u24 v10, 912, v10
v_mul_u32_u24 v11, 224, v6
v_add_u32 v10, v10, v11
v_add_u32 v255, 49152, v10
ds_read_b128 v[168:171], v255 offset:0
ds_read_b128 v[172:175], v255 offset:16
ds_read_b128 v[176:179], v255 offset:32
ds_read_b128 v[180:183], v255 offset:48
ds_read_b128 v[184:187], v255 offset:64
ds_read_b128 v[188:191], v255 offset:80
ds_read_b128 v[192:195], v255 offset:96
ds_read_b128 v[196:199], v255 offset:112
ds_read_b128 v[200:203], v255 offset:128
buffer_load_dwordx4 a[20:23], v2, s[12:15], s36 offen offset:2048 sc1
ds_read_b128 v[204:207], v255 offset:144
ds_read_b128 v[208:211], v255 offset:160
ds_read_b128 v[212:215], v255 offset:176
ds_read_b128 v[216:219], v255 offset:192
ds_read_b128 v[220:223], v255 offset:208
s_waitcnt lgkmcnt(13)
v_lshlrev_b32 v16, 16, v168
v_and_b32 v17, s99, v168
s_waitcnt lgkmcnt(12)
v_lshlrev_b32 v18, 16, v175
v_and_b32 v19, s99, v175
buffer_load_dwordx4 a[132:135], v2, s[12:15], s36 offen offset:3072 sc1
s_waitcnt lgkmcnt(10)
v_lshlrev_b32 v20, 16, v182
v_and_b32 v21, s99, v182
s_waitcnt lgkmcnt(8)
v_lshlrev_b32 v22, 16, v189
v_and_b32 v23, s99, v189
s_waitcnt lgkmcnt(6)
v_lshlrev_b32 v24, 16, v196
v_and_b32 v25, s99, v196
s_waitcnt lgkmcnt(5)
v_lshlrev_b32 v26, 16, v203
v_and_b32 v27, s99, v203
s_add_u32 s36, s37, 12288
buffer_load_dwordx4 a[24:27], v2, s[12:15], s36 offen offset:0 sc1
s_waitcnt lgkmcnt(3)
v_lshlrev_b32 v28, 16, v210
v_and_b32 v29, s99, v210
s_waitcnt lgkmcnt(1)
v_lshlrev_b32 v30, 16, v217
v_and_b32 v31, s99, v217
v_lshlrev_b32 v32, 16, v169
v_and_b32 v33, s99, v169
v_lshlrev_b32 v34, 16, v176
v_and_b32 v35, s99, v176
buffer_load_dwordx4 a[136:139], v2, s[12:15], s36 offen offset:1024 sc1
v_lshlrev_b32 v36, 16, v183
v_and_b32 v37, s99, v183
v_lshlrev_b32 v38, 16, v190
v_and_b32 v39, s99, v190
v_lshlrev_b32 v40, 16, v197
v_and_b32 v41, s99, v197
v_lshlrev_b32 v42, 16, v204
v_and_b32 v43, s99, v204
buffer_load_dwordx4 a[28:31], v2, s[12:15], s36 offen offset:2048 sc1
v_lshlrev_b32 v44, 16, v211
v_and_b32 v45, s99, v211
v_lshlrev_b32 v46, 16, v218
v_and_b32 v47, s99, v218
v_lshlrev_b32 v48, 16, v170
v_and_b32 v49, s99, v170
v_lshlrev_b32 v50, 16, v177
v_and_b32 v51, s99, v177
buffer_load_dwordx4 a[140:143], v2, s[12:15], s36 offen offset:3072 sc1
v_lshlrev_b32 v52, 16, v184
v_and_b32 v53, s99, v184
v_lshlrev_b32 v54, 16, v191
v_and_b32 v55, s99, v191
v_lshlrev_b32 v56, 16, v198
v_and_b32 v57, s99, v198
v_lshlrev_b32 v58, 16, v205
v_and_b32 v59, s99, v205
s_add_u32 s36, s37, 16384
buffer_load_dwordx4 a[32:35], v2, s[12:15], s36 offen offset:0 sc1
v_lshlrev_b32 v60, 16, v212
v_and_b32 v61, s99, v212
v_lshlrev_b32 v62, 16, v219
v_and_b32 v63, s99, v219
v_lshlrev_b32 v64, 16, v171
v_and_b32 v65, s99, v171
v_lshlrev_b32 v66, 16, v178
v_and_b32 v67, s99, v178
s_cmp_lg_u32 s62, 0
s_cbranch_scc1 w0_26
s_waitcnt vmcnt(7)
v_readfirstlane_b32 s3, v14
s_nop 0
s_cmp_lg_u32 s3, 15
s_cbranch_scc1 bl_27
s_mov_b64 exec, 1
s_add_u32 s3, s101, 40960
buffer_store_dword v14, off, s[12:15], s3 sc1
s_mov_b64 exec, -1
bl_27:
w0_26:
v_lshlrev_b32 v68, 16, v185
v_and_b32 v69, s99, v185
buffer_load_dwordx4 a[144:147], v2, s[12:15], s36 offen offset:1024 sc1
v_lshlrev_b32 v70, 16, v192
v_and_b32 v71, s99, v192
v_lshlrev_b32 v72, 16, v199
v_and_b32 v73, s99, v199
v_lshlrev_b32 v74, 16, v206
v_and_b32 v75, s99, v206
v_lshlrev_b32 v76, 16, v213
v_and_b32 v77, s99, v213
buffer_load_dwordx4 a[36:39], v2, s[12:15], s36 offen offset:2048 sc1
s_waitcnt lgkmcnt(0)
v_lshlrev_b32 v78, 16, v220
v_and_b32 v79, s99, v220
v_lshlrev_b32 v80, 16, v172
v_and_b32 v81, s99, v172
v_lshlrev_b32 v82, 16, v179
v_and_b32 v83, s99, v179
v_lshlrev_b32 v84, 16, v186
v_and_b32 v85, s99, v186
buffer_load_dwordx4 a[148:151], v2, s[12:15], s36 offen offset:3072 sc1
v_lshlrev_b32 v86, 16, v193
v_and_b32 v87, s99, v193
v_lshlrev_b32 v88, 16, v200
v_and_b32 v89, s99, v200
v_lshlrev_b32 v90, 16, v207
v_and_b32 v91, s99, v207
v_lshlrev_b32 v92, 16, v214
v_and_b32 v93, s99, v214
s_add_u32 s36, s37, 20480
buffer_load_dwordx4 a[40:43], v2, s[12:15], s36 offen offset:0 sc1
v_lshlrev_b32 v94, 16, v221
v_and_b32 v95, s99, v221
v_lshlrev_b32 v96, 16, v173
v_and_b32 v97, s99, v173
v_lshlrev_b32 v98, 16, v180
v_and_b32 v99, s99, v180
v_lshlrev_b32 v100, 16, v187
v_and_b32 v101, s99, v187
buffer_load_dwordx4 a[152:155], v2, s[12:15], s36 offen offset:1024 sc1
v_lshlrev_b32 v102, 16, v194
v_and_b32 v103, s99, v194
v_lshlrev_b32 v104, 16, v201
v_and_b32 v105, s99, v201
v_lshlrev_b32 v106, 16, v208
v_and_b32 v107, s99, v208
v_lshlrev_b32 v108, 16, v215
v_and_b32 v109, s99, v215
buffer_load_dwordx4 a[44:47], v2, s[12:15], s36 offen offset:2048 sc1
v_lshlrev_b32 v110, 16, v222
v_and_b32 v111, s99, v222
v_lshlrev_b32 v112, 16, v174
v_and_b32 v113, s99, v174
v_lshlrev_b32 v114, 16, v181
v_and_b32 v115, s99, v181
v_lshlrev_b32 v116, 16, v188
v_and_b32 v117, s99, v188
buffer_load_dwordx4 a[156:159], v2, s[12:15], s36 offen offset:3072 sc1
v_lshlrev_b32 v118, 16, v195
v_and_b32 v119, s99, v195
v_lshlrev_b32 v120, 16, v202
v_and_b32 v121, s99, v202
v_lshlrev_b32 v122, 16, v209
v_and_b32 v123, s99, v209
v_lshlrev_b32 v124, 16, v216
v_and_b32 v125, s99, v216
s_add_u32 s36, s37, 24576
buffer_load_dwordx4 a[48:51], v2, s[12:15], s36 offen offset:0 sc1
v_lshlrev_b32 v126, 16, v223
v_and_b32 v127, s99, v223
v_lshrrev_b32 v7, 4, v1
v_and_b32 v8, 1, v7
s_and_b32 s4, s62, 1
s_lshl_b32 s4, s4, 1
v_add_u32 v10, s4, v8
v_lshlrev_b32 v10, 1, v10
v_and_b32 v11, 7, v1
v_xor_b32 v10, v10, v11
v_lshlrev_b32 v10, 4, v10
buffer_load_dwordx4 a[160:163], v2, s[12:15], s36 offen offset:1024 sc1
v_bfe_u32 v11, v1, 3, 1
v_lshl_add_u32 v10, v11, 7, v10
v_lshl_add_u32 v10, v8, 18, v10
s_lshl_b32 s4, s62, 19
s_lshl_b32 s5, s96, 8
s_add_u32 s4, s4, s5
v_add_u32 v10, s4, v10
v_cmp_gt_u32 vcc, 32, v1
v_mov_b32 v11, 131072
v_mov_b32 v12, 4294959104
v_mov_b32 v13, 8192
v_cndmask_b32 v11, v11, 0, vcc
v_cndmask_b32 v12, v12, v13, vcc
buffer_load_dwordx4 a[52:55], v2, s[12:15], s36 offen offset:2048 sc1
v_add_u32 v128, v10, v11
v_add_u32 v10, v128, v11
v_add_u32 v129, v10, v12
v_add_u32 v130, v129, v12
v_add_u32 v131, v130, v12
v_add_u32 v132, v131, v12
v_add_u32 v133, v132, v12
v_add_u32 v134, v133, v12
buffer_load_dwordx4 a[164:167], v2, s[12:15], s36 offen offset:3072 sc1
v_add_u32 v135, v134, v12
v_add_u32 v136, v135, v12
v_add_u32 v137, v136, v12
v_add_u32 v138, v137, v12
v_add_u32 v139, v138, v12
v_add_u32 v140, v139, v12
v_add_u32 v141, v140, v12
v_add_u32 v142, v141, v12
s_add_u32 s36, s37, 28672
buffer_load_dwordx4 a[56:59], v2, s[12:15], s36 offen offset:0 sc1
v_add_u32 v143, v142, v12
v_lshrrev_b32 v7, 2, v5
v_lshrrev_b32 v8, 1, v7
v_and_b32 v10, 1, v6
v_lshl_or_b32 v8, v10, 1, v8
v_xor_b32 v8, s62, v8
v_bfe_u32 v10, v5, 1, 1
v_lshl_or_b32 v8, v8, 1, v10
v_lshlrev_b32 v8, 4, v8
buffer_load_dwordx4 a[168:171], v2, s[12:15], s36 offen offset:1024 sc1
v_and_b32 v10, 1, v5
v_lshl_or_b32 v8, v10, 3, v8
v_lshl_or_b32 v8, v7, 7, v8
v_lshl_or_b32 v8, v6, 10, v8
v_add_u32 v3, 49152, v8
s_lshl_b32 s85, s62, 10
s_add_u32 s85, s85, 49152
ds_read_b128 a[224:227], v2 offset:0
buffer_load_dwordx4 a[60:63], v2, s[12:15], s36 offen offset:2048 sc1
ds_read_b128 a[228:231], v2 offset:1024
ds_read_b128 a[232:235], v2 offset:2048
ds_read_b128 a[236:239], v2 offset:3072
ds_read_b128 a[240:243], v2 offset:4096
ds_read_b128 a[244:247], v2 offset:5120
ds_read_b128 a[248:251], v2 offset:6144
ds_read_b128 a[252:255], v2 offset:7168
buffer_load_dwordx4 a[172:175], v2, s[12:15], s36 offen offset:3072 sc1
s_add_u32 s36, s37, 32768
buffer_load_dwordx4 a[64:67], v2, s[12:15], s36 offen offset:0 sc1
buffer_load_dwordx4 a[176:179], v2, s[12:15], s36 offen offset:1024 sc1
buffer_load_dwordx4 a[68:71], v2, s[12:15], s36 offen offset:2048 sc1
buffer_load_dwordx4 a[180:183], v2, s[12:15], s36 offen offset:3072 sc1
s_add_u32 s36, s37, 36864
buffer_load_dwordx4 a[72:75], v2, s[12:15], s36 offen offset:0 sc1
buffer_load_dwordx4 a[184:187], v2, s[12:15], s36 offen offset:1024 sc1
s_cmp_lg_u32 s62, 0
s_cbranch_scc1 w0_28
v_lshlrev_b32 v13, 8, v1
s_mov_b32 s4, 69632
s_mov_b64 exec, 0xffff
s_mov_b32 s3, 0
poll_29:
buffer_load_dword v14, v13, s[12:15], s4 offen sc1
s_waitcnt vmcnt(0)
v_cmp_gt_u32 vcc, 1, v14
s_nop 0
s_cbranch_vccz pollok_30
s_add_u32 s3, s3, 1
s_cmp_lt_u32 s3, 131072
s_cbranch_scc1 poll_29
pollok_30:
s_mov_b64 exec, -1
w0_28:
s_waitcnt lgkmcnt(0)
s_barrier
s_add_u32 m0, s85, 0
s_nop 0
buffer_load_dwordx4 v128, s[20:23], 0 offen sc1 lds
s_add_u32 m0, s85, 4096
s_nop 0
buffer_load_dwordx4 v129, s[20:23], 0 offen sc1 lds
s_add_u32 m0, s85, 8192
s_nop 0
buffer_load_dwordx4 v130, s[20:23], 0 offen sc1 lds
s_add_u32 m0, s85, 12288
s_nop 0
buffer_load_dwordx4 v131, s[20:23], 0 offen sc1 lds
s_add_u32 m0, s85, 16384
s_nop 0
buffer_load_dwordx4 v132, s[20:23], 0 offen sc1 lds
s_add_u32 m0, s85, 20480
s_nop 0
buffer_load_dwordx4 v133, s[20:23], 0 offen sc1 lds
s_add_u32 m0, s85, 24576
s_nop 0
buffer_load_dwordx4 v134, s[20:23], 0 offen sc1 lds
s_add_u32 m0, s85, 28672
s_nop 0
buffer_load_dwordx4 v135, s[20:23], 0 offen sc1 lds
s_add_u32 m0, s85, 32768
s_nop 0
buffer_load_dwordx4 v136, s[20:23], 0 offen sc1 lds
s_add_u32 m0, s85, 36864
s_nop 0
buffer_load_dwordx4 v137, s[20:23], 0 offen sc1 lds
s_add_u32 m0, s85, 40960
s_nop 0
buffer_load_dwordx4 v138, s[20:23], 0 offen sc1 lds
s_add_u32 m0, s85, 45056
s_nop 0
buffer_load_dwordx4 v139, s[20:23], 0 offen sc1 lds
s_add_u32 m0, s85, 49152
s_nop 0
buffer_load_dwordx4 v140, s[20:23], 0 offen sc1 lds
s_add_u32 m0, s85, 53248
s_nop 0
buffer_load_dwordx4 v141, s[20:23], 0 offen sc1 lds
s_add_u32 m0, s85, 57344
s_nop 0
buffer_load_dwordx4 v142, s[20:23], 0 offen sc1 lds
s_add_u32 m0, s85, 61440
s_nop 0
buffer_load_dwordx4 v143, s[20:23], 0 offen sc1 lds
v_lshlrev_b32 v9, 5, v1
s_mov_b32 s4, 12288
buffer_load_dwordx4 v[248:251], v9, s[12:15], s4 offen sc1
buffer_load_dwordx3 v[252:254], v9, s[12:15], s4 offen offset:16 sc1
s_and_b32 s4, s62, 1
s_mul_i32 s4, s4, 768
s_lshr_b32 s5, s62, 1
s_lshl_b32 s6, s5, 11
s_add_u32 s6, s6, s4
s_add_u32 m0, s6, 40960
s_lshl_b32 s5, s5, 11
s_sub_u32 s5, 16384, s5
s_add_u32 s4, s4, s5
buffer_load_dwordx4 v2, s[12:15], s4 offen sc1 lds
v_lshlrev_b32 v9, 2, v1
s_lshl_b32 s4, s63, 8
s_add_u32 s4, s4, 8960
s_mov_b32 m0, 47104
s_nop 0
buffer_load_dword v9, s[12:15], s4 offen sc1 lds
v_mul_u32_u24 v9, 448, v6
v_add_u32 v9, 40960, v9
s_lshl_b32 s4, s62, 4
v_add_u32 v10, s4, v5
v_and_b32 v11, 31, v10
v_lshlrev_b32 v11, 4, v11
v_lshrrev_b32 v12, 5, v10
v_lshl_add_u32 v11, v12, 12, v11
v_add_u32 v4, 114688, v11
v_mov_b32 v10, v255
s_and_b32 s5, s62, 1
s_lshl_b32 s5, s5, 8
v_xor_b32 v8, s5, v2
s_lshr_b32 s4, s62, 1
s_lshl_b32 s4, s4, 10
v_add_u32 v7, s4, v8
s_xor_b32 s4, s4, 1024
v_add_u32 v8, s4, v8
s_add_u32 s4, s63, 7
s_lshl_b32 s4, s4, 2
s_add_u32 s4, s4, s62
s_mul_i32 s4, s4, 57344
s_add_u32 s4, s4, 8388608
s_mul_i32 s5, s96, 229376
s_lshl_b32 s6, s62, 13
s_add_u32 s5, s5, s6
s_add_u32 s5, s5, 12582912
s_add_u32 s6, s63, 0
s_cmp_ge_u32 s6, 7
s_cselect_b32 s7, 7, 0
s_sub_u32 s6, s6, s7
s_lshl_b32 s7, s6, 13
s_add_u32 s64, s7, s4
s_lshl_b32 s7, s6, 15
s_add_u32 s72, s7, s5
s_add_u32 s6, s63, 1
s_cmp_ge_u32 s6, 7
s_cselect_b32 s7, 7, 0
s_sub_u32 s6, s6, s7
s_lshl_b32 s7, s6, 13
s_add_u32 s65, s7, s4
s_lshl_b32 s7, s6, 15
s_add_u32 s73, s7, s5
s_add_u32 s6, s63, 2
s_cmp_ge_u32 s6, 7
s_cselect_b32 s7, 7, 0
s_sub_u32 s6, s6, s7
s_lshl_b32 s7, s6, 13
s_add_u32 s66, s7, s4
s_lshl_b32 s7, s6, 15
s_add_u32 s74, s7, s5
s_add_u32 s6, s63, 3
s_cmp_ge_u32 s6, 7
s_cselect_b32 s7, 7, 0
s_sub_u32 s6, s6, s7
s_lshl_b32 s7, s6, 13
s_add_u32 s67, s7, s4
s_lshl_b32 s7, s6, 15
s_add_u32 s75, s7, s5
s_add_u32 s6, s63, 4
s_cmp_ge_u32 s6, 7
s_cselect_b32 s7, 7, 0
s_sub_u32 s6, s6, s7
s_lshl_b32 s7, s6, 13
s_add_u32 s68, s7, s4
s_lshl_b32 s7, s6, 15
s_add_u32 s76, s7, s5
s_add_u32 s6, s63, 5
s_cmp_ge_u32 s6, 7
s_cselect_b32 s7, 7, 0
s_sub_u32 s6, s6, s7
s_lshl_b32 s7, s6, 13
s_add_u32 s69, s7, s4
s_lshl_b32 s7, s6, 15
s_add_u32 s77, s7, s5
s_add_u32 s6, s63, 6
s_cmp_ge_u32 s6, 7
s_cselect_b32 s7, 7, 0
s_sub_u32 s6, s6, s7
s_lshl_b32 s7, s6, 13
s_add_u32 s70, s7, s4
s_lshl_b32 s7, s6, 15
s_add_u32 s78, s7, s5
s_mul_i32 s81, s62, 10240
s_add_u32 s80, s81, 122880
s_add_u32 s79, s72, 4096
s_waitcnt vmcnt(12)
s_barrier
ds_read_b64_tr_b16 v[144:145], v3 offset:0
ds_read_b64_tr_b16 v[146:147], v3 offset:512
ds_read_b64_tr_b16 v[148:149], v3 offset:4096
ds_read_b64_tr_b16 v[150:151], v3 offset:4608
ds_read_b64_tr_b16 v[152:153], v3 offset:8192
ds_read_b64_tr_b16 v[154:155], v3 offset:8704
ds_read_b64_tr_b16 v[156:157], v3 offset:12288
ds_read_b64_tr_b16 v[158:159], v3 offset:12800
s_waitcnt lgkmcnt(6)
v_mfma_f32_16x16x32_bf16 v[220:223], a[224:227], v[144:147], 0
v_mfma_f32_16x16x32_bf16 v[224:227], a[228:231], v[144:147], 0
s_waitcnt lgkmcnt(4)
v_mfma_f32_16x16x32_bf16 v[228:231], a[232:235], v[148:151], 0
v_mfma_f32_16x16x32_bf16 v[232:235], a[236:239], v[148:151], 0
ds_read_b64_tr_b16 v[144:145], v3 offset:16384
ds_read_b64_tr_b16 v[146:147], v3 offset:16896
ds_read_b64_tr_b16 v[148:149], v3 offset:20480
ds_read_b64_tr_b16 v[150:151], v3 offset:20992
ds_read_b128 a[224:227], v2 offset:8192
ds_read_b128 a[228:231], v2 offset:9216
ds_read_b128 a[232:235], v2 offset:10240
ds_read_b128 a[236:239], v2 offset:11264
buffer_load_dwordx4 a[76:79], v2, s[12:15], s36 offen offset:2048 sc1
s_waitcnt lgkmcnt(10)
v_mfma_f32_16x16x32_bf16 v[236:239], a[240:243], v[152:155], 0
v_mfma_f32_16x16x32_bf16 v[240:243], a[244:247], v[152:155], 0
s_waitcnt lgkmcnt(8)
v_mfma_f32_16x16x32_bf16 v[244:247], a[248:251], v[156:159], 0
v_mfma_f32_16x16x32_bf16 v[188:191], a[252:255], v[156:159], 0
ds_read_b64_tr_b16 v[152:153], v3 offset:24576
ds_read_b64_tr_b16 v[154:155], v3 offset:25088
ds_read_b64_tr_b16 v[156:157], v3 offset:28672
ds_read_b64_tr_b16 v[158:159], v3 offset:29184
ds_read_b128 a[240:243], v2 offset:12288
ds_read_b128 a[244:247], v2 offset:13312
ds_read_b128 a[248:251], v2 offset:14336
buffer_load_dwordx4 a[188:191], v2, s[12:15], s36 offen offset:3072 sc1
ds_read_b128 a[252:255], v2 offset:15360
v_cvt_pk_bf16_f32 v192, v220, v228
v_cvt_pk_bf16_f32 v196, v221, v229
v_cvt_pk_bf16_f32 v200, v222, v230
v_cvt_pk_bf16_f32 v204, v223, v231
v_cvt_pk_bf16_f32 v208, v224, v232
v_cvt_pk_bf16_f32 v212, v225, v233
v_cvt_pk_bf16_f32 v216, v226, v234
s_waitcnt vmcnt(6)
s_barrier
s_waitcnt lgkmcnt(11)
v_mfma_f32_16x16x32_bf16 v[220:223], a[224:227], v[144:147], 0
s_add_u32 s36, s37, 40960
buffer_load_dwordx4 a[80:83], v2, s[12:15], s36 offen offset:0 sc1
s_waitcnt lgkmcnt(10)
v_mfma_f32_16x16x32_bf16 v[224:227], a[228:231], v[144:147], 0
s_waitcnt lgkmcnt(9)
v_mfma_f32_16x16x32_bf16 v[228:231], a[232:235], v[148:151], 0
s_waitcnt lgkmcnt(8)
v_mfma_f32_16x16x32_bf16 v[232:235], a[236:239], v[148:151], 0
ds_read_b64_tr_b16 v[144:145], v3 offset:32768
ds_read_b64_tr_b16 v[146:147], v3 offset:33280
ds_read_b64_tr_b16 v[148:149], v3 offset:36864
ds_read_b64_tr_b16 v[150:151], v3 offset:37376
ds_read_b128 a[224:227], v2 offset:16384
ds_read_b128 a[228:231], v2 offset:17408
ds_read_b128 a[232:235], v2 offset:18432
ds_read_b128 a[236:239], v2 offset:19456
v_cvt_pk_bf16_f32 v193, v236, v244
buffer_load_dwordx4 a[192:195], v2, s[12:15], s36 offen offset:1024 sc1
v_cvt_pk_bf16_f32 v197, v237, v245
v_cvt_pk_bf16_f32 v201, v238, v246
v_cvt_pk_bf16_f32 v205, v239, v247
v_cvt_pk_bf16_f32 v209, v240, v188
v_cvt_pk_bf16_f32 v213, v241, v189
v_cvt_pk_bf16_f32 v217, v242, v190
s_waitcnt lgkmcnt(11)
v_mfma_f32_16x16x32_bf16 v[236:239], a[240:243], v[152:155], 0
s_waitcnt lgkmcnt(10)
v_mfma_f32_16x16x32_bf16 v[240:243], a[244:247], v[152:155], 0
s_waitcnt lgkmcnt(9)
v_mfma_f32_16x16x32_bf16 v[244:247], a[248:251], v[156:159], 0
s_waitcnt lgkmcnt(8)
v_mfma_f32_16x16x32_bf16 v[188:191], a[252:255], v[156:159], 0
ds_read_b64_tr_b16 v[152:153], v3 offset:40960
ds_read_b64_tr_b16 v[154:155], v3 offset:41472
buffer_load_dwordx4 a[84:87], v2, s[12:15], s36 offen offset:2048 sc1
ds_read_b64_tr_b16 v[156:157], v3 offset:45056
ds_read_b64_tr_b16 v[158:159], v3 offset:45568
ds_read_b128 a[240:243], v2 offset:20480
ds_read_b128 a[244:247], v2 offset:21504
ds_read_b128 a[248:251], v2 offset:22528
ds_read_b128 a[252:255], v2 offset:23552
v_cvt_pk_bf16_f32 v194, v220, v228
v_cvt_pk_bf16_f32 v198, v221, v229
v_cvt_pk_bf16_f32 v202, v222, v230
v_cvt_pk_bf16_f32 v206, v223, v231
v_cvt_pk_bf16_f32 v210, v224, v232
v_cvt_pk_bf16_f32 v214, v225, v233
v_cvt_pk_bf16_f32 v218, v226, v234
s_waitcnt lgkmcnt(11)
v_mfma_f32_16x16x32_bf16 v[220:223], a[224:227], v[144:147], 0
s_waitcnt lgkmcnt(10)
v_mfma_f32_16x16x32_bf16 v[224:227], a[228:231], v[144:147], 0
buffer_load_dwordx4 a[196:199], v2, s[12:15], s36 offen offset:3072 sc1
s_waitcnt lgkmcnt(9)
v_mfma_f32_16x16x32_bf16 v[228:231], a[232:235], v[148:151], 0
s_waitcnt lgkmcnt(8)
v_mfma_f32_16x16x32_bf16 v[232:235], a[236:239], v[148:151], 0
ds_read_b64_tr_b16 v[144:145], v3 offset:49152
ds_read_b64_tr_b16 v[146:147], v3 offset:49664
ds_read_b64_tr_b16 v[148:149], v3 offset:53248
ds_read_b64_tr_b16 v[150:151], v3 offset:53760
ds_read_b128 a[224:227], v2 offset:24576
ds_read_b128 a[228:231], v2 offset:25600
ds_read_b128 a[232:235], v2 offset:26624
ds_read_b128 a[236:239], v2 offset:27648
v_cvt_pk_bf16_f32 v195, v236, v244
v_cvt_pk_bf16_f32 v199, v237, v245
v_cvt_pk_bf16_f32 v203, v238, v246
v_cvt_pk_bf16_f32 v207, v239, v247
v_cvt_pk_bf16_f32 v211, v240, v188
s_add_u32 s36, s37, 45056
buffer_load_dwordx4 a[88:91], v2, s[12:15], s36 offen offset:0 sc1
v_cvt_pk_bf16_f32 v215, v241, v189
v_cvt_pk_bf16_f32 v219, v242, v190
s_waitcnt lgkmcnt(11)
v_mfma_f32_16x16x32_bf16 v[236:239], a[240:243], v[152:155], 0
s_waitcnt lgkmcnt(10)
v_mfma_f32_16x16x32_bf16 v[240:243], a[244:247], v[152:155], 0
s_waitcnt lgkmcnt(9)
v_mfma_f32_16x16x32_bf16 v[244:247], a[248:251], v[156:159], 0
s_waitcnt lgkmcnt(8)
v_mfma_f32_16x16x32_bf16 v[188:191], a[252:255], v[156:159], 0
ds_read_b64_tr_b16 v[152:153], v3 offset:57344
ds_read_b64_tr_b16 v[154:155], v3 offset:57856
ds_read_b64_tr_b16 v[156:157], v3 offset:61440
ds_read_b64_tr_b16 v[158:159], v3 offset:61952
buffer_load_dwordx4 a[200:203], v2, s[12:15], s36 offen offset:1024 sc1
ds_read_b128 a[240:243], v2 offset:28672
ds_read_b128 a[244:247], v2 offset:29696
ds_read_b128 a[248:251], v2 offset:30720
ds_read_b128 a[252:255], v2 offset:31744
v_cvt_pk_bf16_f32 v160, v220, v228
v_cvt_pk_bf16_f32 v164, v221, v229
v_cvt_pk_bf16_f32 v168, v222, v230
v_cvt_pk_bf16_f32 v172, v223, v231
v_cvt_pk_bf16_f32 v176, v224, v232
v_cvt_pk_bf16_f32 v180, v225, v233
v_cvt_pk_bf16_f32 v184, v226, v234
s_waitcnt lgkmcnt(11)
v_mfma_f32_16x16x32_bf16 v[220:223], a[224:227], v[144:147], 0
s_waitcnt lgkmcnt(10)
v_mfma_f32_16x16x32_bf16 v[224:227], a[228:231], v[144:147], 0
s_waitcnt lgkmcnt(9)
v_mfma_f32_16x16x32_bf16 v[228:231], a[232:235], v[148:151], 0
buffer_load_dwordx4 a[92:95], v2, s[12:15], s36 offen offset:2048 sc1
s_waitcnt lgkmcnt(8)
v_mfma_f32_16x16x32_bf16 v[232:235], a[236:239], v[148:151], 0
ds_read_b128 a[224:227], v2 offset:32768
ds_read_b128 a[228:231], v2 offset:33792
ds_read_b128 a[232:235], v2 offset:34816
ds_read_b128 a[236:239], v2 offset:35840
v_cvt_pk_bf16_f32 v161, v236, v244
v_cvt_pk_bf16_f32 v165, v237, v245
v_cvt_pk_bf16_f32 v169, v238, v246
v_cvt_pk_bf16_f32 v173, v239, v247
v_cvt_pk_bf16_f32 v177, v240, v188
v_cvt_pk_bf16_f32 v181, v241, v189
v_cvt_pk_bf16_f32 v185, v242, v190
s_waitcnt lgkmcnt(7)
v_mfma_f32_16x16x32_bf16 v[236:239], a[240:243], v[152:155], 0
s_waitcnt lgkmcnt(6)
v_mfma_f32_16x16x32_bf16 v[240:243], a[244:247], v[152:155], 0
buffer_load_dwordx4 a[204:207], v2, s[12:15], s36 offen offset:3072 sc1
s_waitcnt lgkmcnt(5)
v_mfma_f32_16x16x32_bf16 v[244:247], a[248:251], v[156:159], 0
s_waitcnt lgkmcnt(4)
v_mfma_f32_16x16x32_bf16 v[188:191], a[252:255], v[156:159], 0
ds_read_b128 a[240:243], v2 offset:36864
ds_read_b128 a[244:247], v2 offset:37888
ds_read_b128 a[248:251], v2 offset:38912
ds_read_b128 a[252:255], v2 offset:39936
v_cvt_pk_bf16_f32 v162, v220, v228
v_cvt_pk_bf16_f32 v166, v221, v229
v_cvt_pk_bf16_f32 v170, v222, v230
v_cvt_pk_bf16_f32 v174, v223, v231
v_cvt_pk_bf16_f32 v178, v224, v232
v_cvt_pk_bf16_f32 v182, v225, v233
v_cvt_pk_bf16_f32 v186, v226, v234
v_cvt_pk_bf16_f32 v163, v236, v244
v_cvt_pk_bf16_f32 v167, v237, v245
s_add_u32 s36, s37, 49152
buffer_load_dwordx4 a[96:99], v2, s[12:15], s36 offen offset:0 sc1
v_cvt_pk_bf16_f32 v171, v238, v246
v_cvt_pk_bf16_f32 v175, v239, v247
v_cvt_pk_bf16_f32 v179, v240, v188
v_cvt_pk_bf16_f32 v183, v241, v189
v_cvt_pk_bf16_f32 v187, v242, v190
s_waitcnt vmcnt(11)
s_waitcnt lgkmcnt(0)
s_barrier
v_mfma_f32_16x16x32_bf16 v[220:223], a[224:227], v[192:195], 0
v_mfma_f32_16x16x32_bf16 v[224:227], a[232:235], v[192:195], 0
buffer_load_dwordx4 a[208:211], v2, s[12:15], s36 offen offset:1024 sc1
v_mfma_f32_16x16x32_bf16 v[228:231], a[240:243], v[192:195], 0
v_mfma_f32_16x16x32_bf16 v[232:235], a[248:251], v[192:195], 0
v_mfma_f32_16x16x32_bf16 v[220:223], a[228:231], v[160:163], v[220:223]
v_mfma_f32_16x16x32_bf16 v[224:227], a[236:239], v[160:163], v[224:227]
v_mfma_f32_16x16x32_bf16 v[228:231], a[244:247], v[160:163], v[228:231]
v_mfma_f32_16x16x32_bf16 v[232:235], a[252:255], v[160:163], v[232:235]
buffer_load_dwordx4 a[100:103], v2, s[12:15], s36 offen offset:2048 sc1
v_mfma_f32_16x16x32_bf16 v[236:239], a[224:227], v[196:199], 0
s_nop 2
v_fmac_f32_dpp v16, v248, v220 row_newbcast:0 row_mask:0xf bank_mask:0xf
v_fmac_f32_dpp v17, v248, v221 row_newbcast:1 row_mask:0xf bank_mask:0xf
v_mfma_f32_16x16x32_bf16 v[240:243], a[232:235], v[196:199], 0
v_fmac_f32_dpp v18, v248, v222 row_newbcast:2 row_mask:0xf bank_mask:0xf
v_fmac_f32_dpp v19, v248, v223 row_newbcast:3 row_mask:0xf bank_mask:0xf
v_mfma_f32_16x16x32_bf16 v[244:247], a[240:243], v[196:199], 0
v_fmac_f32_dpp v20, v248, v224 row_newbcast:4 row_mask:0xf bank_mask:0xf
v_fmac_f32_dpp v21, v248, v225 row_newbcast:5 row_mask:0xf bank_mask:0xf
v_mfma_f32_16x16x32_bf16 v[188:191], a[248:251], v[196:199], 0
v_fmac_f32_dpp v22, v248, v226 row_newbcast:6 row_mask:0xf bank_mask:0xf
buffer_load_dwordx4 a[212:215], v2, s[12:15], s36 offen offset:3072 sc1
v_fmac_f32_dpp v23, v248, v227 row_newbcast:7 row_mask:0xf bank_mask:0xf
v_mfma_f32_16x16x32_bf16 v[236:239], a[228:231], v[164:167], v[236:239]
v_fmac_f32_dpp v24, v248, v228 row_newbcast:8 row_mask:0xf bank_mask:0xf
v_fmac_f32_dpp v25, v248, v229 row_newbcast:9 row_mask:0xf bank_mask:0xf
v_mfma_f32_16x16x32_bf16 v[240:243], a[236:239], v[164:167], v[240:243]
v_fmac_f32_dpp v26, v248, v230 row_newbcast:10 row_mask:0xf bank_mask:0xf
v_fmac_f32_dpp v27, v248, v231 row_newbcast:11 row_mask:0xf bank_mask:0xf
v_mfma_f32_16x16x32_bf16 v[244:247], a[244:247], v[164:167], v[244:247]
v_fmac_f32_dpp v28, v248, v232 row_newbcast:12 row_mask:0xf bank_mask:0xf
v_fmac_f32_dpp v29, v248, v233 row_newbcast:13 row_mask:0xf bank_mask:0xf
v_mfma_f32_16x16x32_bf16 v[188:191], a[252:255], v[164:167], v[188:191]
s_add_u32 s36, s37, 53248
buffer_load_dwordx4 a[104:107], v2, s[12:15], s36 offen offset:0 sc1
v_fmac_f32_dpp v30, v248, v234 row_newbcast:14 row_mask:0xf bank_mask:0xf
v_fmac_f32_dpp v31, v248, v235 row_newbcast:15 row_mask:0xf bank_mask:0xf
v_mfma_f32_16x16x32_bf16 v[220:223], a[224:227], v[200:203], 0
v_fmac_f32_dpp v32, v249, v236 row_newbcast:0 row_mask:0xf bank_mask:0xf
v_fmac_f32_dpp v33, v249, v237 row_newbcast:1 row_mask:0xf bank_mask:0xf
v_mfma_f32_16x16x32_bf16 v[224:227], a[232:235], v[200:203], 0
v_fmac_f32_dpp v34, v249, v238 row_newbcast:2 row_mask:0xf bank_mask:0xf
v_fmac_f32_dpp v35, v249, v239 row_newbcast:3 row_mask:0xf bank_mask:0xf
v_mfma_f32_16x16x32_bf16 v[228:231], a[240:243], v[200:203], 0
v_fmac_f32_dpp v36, v249, v240 row_newbcast:4 row_mask:0xf bank_mask:0xf
v_fmac_f32_dpp v37, v249, v241 row_newbcast:5 row_mask:0xf bank_mask:0xf
v_mfma_f32_16x16x32_bf16 v[232:235], a[248:251], v[200:203], 0
buffer_load_dwordx4 a[216:219], v2, s[12:15], s36 offen offset:1024 sc1
v_fmac_f32_dpp v38, v249, v242 row_newbcast:6 row_mask:0xf bank_mask:0xf
v_fmac_f32_dpp v39, v249, v243 row_newbcast:7 row_mask:0xf bank_mask:0xf
v_mfma_f32_16x16x32_bf16 v[220:223], a[228:231], v[168:171], v[220:223]
v_fmac_f32_dpp v40, v249, v244 row_newbcast:8 row_mask:0xf bank_mask:0xf
v_fmac_f32_dpp v41, v249, v245 row_newbcast:9 row_mask:0xf bank_mask:0xf
v_mfma_f32_16x16x32_bf16 v[224:227], a[236:239], v[168:171], v[224:227]
v_fmac_f32_dpp v42, v249, v246 row_newbcast:10 row_mask:0xf bank_mask:0xf
v_fmac_f32_dpp v43, v249, v247 row_newbcast:11 row_mask:0xf bank_mask:0xf
v_mfma_f32_16x16x32_bf16 v[228:231], a[244:247], v[168:171], v[228:231]
v_fmac_f32_dpp v44, v249, v188 row_newbcast:12 row_mask:0xf bank_mask:0xf
v_fmac_f32_dpp v45, v249, v189 row_newbcast:13 row_mask:0xf bank_mask:0xf
v_mfma_f32_16x16x32_bf16 v[232:235], a[252:255], v[168:171], v[232:235]
buffer_load_dwordx4 a[108:111], v2, s[12:15], s36 offen offset:2048 sc1
v_fmac_f32_dpp v46, v249, v190 row_newbcast:14 row_mask:0xf bank_mask:0xf
v_fmac_f32_dpp v47, v249, v191 row_newbcast:15 row_mask:0xf bank_mask:0xf
v_mfma_f32_16x16x32_bf16 v[236:239], a[224:227], v[204:207], 0
v_fmac_f32_dpp v48, v250, v220 row_newbcast:0 row_mask:0xf bank_mask:0xf
v_fmac_f32_dpp v49, v250, v221 row_newbcast:1 row_mask:0xf bank_mask:0xf
v_mfma_f32_16x16x32_bf16 v[240:243], a[232:235], v[204:207], 0
v_fmac_f32_dpp v50, v250, v222 row_newbcast:2 row_mask:0xf bank_mask:0xf
v_fmac_f32_dpp v51, v250, v223 row_newbcast:3 row_mask:0xf bank_mask:0xf
v_mfma_f32_16x16x32_bf16 v[244:247], a[240:243], v[204:207], 0
v_fmac_f32_dpp v52, v250, v224 row_newbcast:4 row_mask:0xf bank_mask:0xf
v_fmac_f32_dpp v53, v250, v225 row_newbcast:5 row_mask:0xf bank_mask:0xf
v_mfma_f32_16x16x32_bf16 v[188:191], a[248:251], v[204:207], 0
buffer_load_dwordx4 a[220:223], v2, s[12:15], s36 offen offset:3072 sc1
v_fmac_f32_dpp v54, v250, v226 row_newbcast:6 row_mask:0xf bank_mask:0xf
v_fmac_f32_dpp v55, v250, v227 row_newbcast:7 row_mask:0xf bank_mask:0xf
v_mfma_f32_16x16x32_bf16 v[236:239], a[228:231], v[172:175], v[236:239]
v_fmac_f32_dpp v56, v250, v228 row_newbcast:8 row_mask:0xf bank_mask:0xf
v_fmac_f32_dpp v57, v250, v229 row_newbcast:9 row_mask:0xf bank_mask:0xf
v_mfma_f32_16x16x32_bf16 v[240:243], a[236:239], v[172:175], v[240:243]
v_fmac_f32_dpp v58, v250, v230 row_newbcast:10 row_mask:0xf bank_mask:0xf
v_fmac_f32_dpp v59, v250, v231 row_newbcast:11 row_mask:0xf bank_mask:0xf
v_mfma_f32_16x16x32_bf16 v[244:247], a[244:247], v[172:175], v[244:247]
v_fmac_f32_dpp v60, v250, v232 row_newbcast:12 row_mask:0xf bank_mask:0xf
v_fmac_f32_dpp v61, v250, v233 row_newbcast:13 row_mask:0xf bank_mask:0xf
v_mfma_f32_16x16x32_bf16 v[188:191], a[252:255], v[172:175], v[188:191]
s_add_u32 m0, s80, 0
s_nop 0
buffer_load_dwordx4 v7, s[12:15], s65 offen offset:0 sc1 lds
v_fmac_f32_dpp v62, v250, v234 row_newbcast:14 row_mask:0xf bank_mask:0xf
v_fmac_f32_dpp v63, v250, v235 row_newbcast:15 row_mask:0xf bank_mask:0xf
v_mfma_f32_16x16x32_bf16 v[220:223], a[224:227], v[208:211], 0
v_fmac_f32_dpp v64, v251, v236 row_newbcast:0 row_mask:0xf bank_mask:0xf
v_fmac_f32_dpp v65, v251, v237 row_newbcast:1 row_mask:0xf bank_mask:0xf
v_mfma_f32_16x16x32_bf16 v[224:227], a[232:235], v[208:211], 0
v_fmac_f32_dpp v66, v251, v238 row_newbcast:2 row_mask:0xf bank_mask:0xf
v_fmac_f32_dpp v67, v251, v239 row_newbcast:3 row_mask:0xf bank_mask:0xf
v_mfma_f32_16x16x32_bf16 v[228:231], a[240:243], v[208:211], 0
v_fmac_f32_dpp v68, v251, v240 row_newbcast:4 row_mask:0xf bank_mask:0xf
v_fmac_f32_dpp v69, v251, v241 row_newbcast:5 row_mask:0xf bank_mask:0xf
v_mfma_f32_16x16x32_bf16 v[232:235], a[248:251], v[208:211], 0
s_add_u32 m0, s80, 1024
s_nop 0
buffer_load_dwordx4 v8, s[12:15], s65 offen offset:0 sc1 lds
v_fmac_f32_dpp v70, v251, v242 row_newbcast:6 row_mask:0xf bank_mask:0xf
v_fmac_f32_dpp v71, v251, v243 row_newbcast:7 row_mask:0xf bank_mask:0xf
v_mfma_f32_16x16x32_bf16 v[220:223], a[228:231], v[176:179], v[220:223]
v_fmac_f32_dpp v72, v251, v244 row_newbcast:8 row_mask:0xf bank_mask:0xf
v_fmac_f32_dpp v73, v251, v245 row_newbcast:9 row_mask:0xf bank_mask:0xf
v_mfma_f32_16x16x32_bf16 v[224:227], a[236:239], v[176:179], v[224:227]
v_fmac_f32_dpp v74, v251, v246 row_newbcast:10 row_mask:0xf bank_mask:0xf
v_fmac_f32_dpp v75, v251, v247 row_newbcast:11 row_mask:0xf bank_mask:0xf
v_mfma_f32_16x16x32_bf16 v[228:231], a[244:247], v[176:179], v[228:231]
v_fmac_f32_dpp v76, v251, v188 row_newbcast:12 row_mask:0xf bank_mask:0xf
v_fmac_f32_dpp v77, v251, v189 row_newbcast:13 row_mask:0xf bank_mask:0xf
v_mfma_f32_16x16x32_bf16 v[232:235], a[252:255], v[176:179], v[232:235]
s_add_u32 m0, s80, 0
s_nop 0
buffer_load_dwordx4 v7, s[12:15], s65 offen offset:2048 sc1 lds
v_fmac_f32_dpp v78, v251, v190 row_newbcast:14 row_mask:0xf bank_mask:0xf
v_fmac_f32_dpp v79, v251, v191 row_newbcast:15 row_mask:0xf bank_mask:0xf
v_mfma_f32_16x16x32_bf16 v[236:239], a[224:227], v[212:215], 0
v_fmac_f32_dpp v80, v252, v220 row_newbcast:0 row_mask:0xf bank_mask:0xf
v_fmac_f32_dpp v81, v252, v221 row_newbcast:1 row_mask:0xf bank_mask:0xf
v_mfma_f32_16x16x32_bf16 v[240:243], a[232:235], v[212:215], 0
v_fmac_f32_dpp v82, v252, v222 row_newbcast:2 row_mask:0xf bank_mask:0xf
v_fmac_f32_dpp v83, v252, v223 row_newbcast:3 row_mask:0xf bank_mask:0xf
v_mfma_f32_16x16x32_bf16 v[244:247], a[240:243], v[212:215], 0
v_fmac_f32_dpp v84, v252, v224 row_newbcast:4 row_mask:0xf bank_mask:0xf
v_fmac_f32_dpp v85, v252, v225 row_newbcast:5 row_mask:0xf bank_mask:0xf
v_mfma_f32_16x16x32_bf16 v[188:191], a[248:251], v[212:215], 0
s_add_u32 m0, s80, 1024
s_nop 0
buffer_load_dwordx4 v8, s[12:15], s65 offen offset:2048 sc1 lds
v_fmac_f32_dpp v86, v252, v226 row_newbcast:6 row_mask:0xf bank_mask:0xf
v_fmac_f32_dpp v87, v252, v227 row_newbcast:7 row_mask:0xf bank_mask:0xf
v_mfma_f32_16x16x32_bf16 v[236:239], a[228:231], v[180:183], v[236:239]
v_fmac_f32_dpp v88, v252, v228 row_newbcast:8 row_mask:0xf bank_mask:0xf
v_fmac_f32_dpp v89, v252, v229 row_newbcast:9 row_mask:0xf bank_mask:0xf
v_mfma_f32_16x16x32_bf16 v[240:243], a[236:239], v[180:183], v[240:243]
v_fmac_f32_dpp v90, v252, v230 row_newbcast:10 row_mask:0xf bank_mask:0xf
v_fmac_f32_dpp v91, v252, v231 row_newbcast:11 row_mask:0xf bank_mask:0xf
v_mfma_f32_16x16x32_bf16 v[244:247], a[244:247], v[180:183], v[244:247]
v_fmac_f32_dpp v92, v252, v232 row_newbcast:12 row_mask:0xf bank_mask:0xf
v_fmac_f32_dpp v93, v252, v233 row_newbcast:13 row_mask:0xf bank_mask:0xf
v_mfma_f32_16x16x32_bf16 v[188:191], a[252:255], v[180:183], v[188:191]
s_add_u32 m0, s80, 4096
s_nop 0
buffer_load_dwordx4 v7, s[12:15], s66 offen offset:0 sc1 lds
v_fmac_f32_dpp v94, v252, v234 row_newbcast:14 row_mask:0xf bank_mask:0xf
v_fmac_f32_dpp v95, v252, v235 row_newbcast:15 row_mask:0xf bank_mask:0xf
v_mfma_f32_16x16x32_bf16 v[220:223], a[224:227], v[216:219], 0
v_fmac_f32_dpp v96, v253, v236 row_newbcast:0 row_mask:0xf bank_mask:0xf
v_fmac_f32_dpp v97, v253, v237 row_newbcast:1 row_mask:0xf bank_mask:0xf
v_mfma_f32_16x16x32_bf16 v[224:227], a[232:235], v[216:219], 0
v_fmac_f32_dpp v98, v253, v238 row_newbcast:2 row_mask:0xf bank_mask:0xf
v_fmac_f32_dpp v99, v253, v239 row_newbcast:3 row_mask:0xf bank_mask:0xf
v_mfma_f32_16x16x32_bf16 v[228:231], a[240:243], v[216:219], 0
v_fmac_f32_dpp v100, v253, v240 row_newbcast:4 row_mask:0xf bank_mask:0xf
v_fmac_f32_dpp v101, v253, v241 row_newbcast:5 row_mask:0xf bank_mask:0xf
v_mfma_f32_16x16x32_bf16 v[232:235], a[248:251], v[216:219], 0
s_add_u32 m0, s80, 5120
s_nop 0
buffer_load_dwordx4 v8, s[12:15], s66 offen offset:0 sc1 lds
v_fmac_f32_dpp v102, v253, v242 row_newbcast:6 row_mask:0xf bank_mask:0xf
v_fmac_f32_dpp v103, v253, v243 row_newbcast:7 row_mask:0xf bank_mask:0xf
v_mfma_f32_16x16x32_bf16 v[220:223], a[228:231], v[184:187], v[220:223]
v_fmac_f32_dpp v104, v253, v244 row_newbcast:8 row_mask:0xf bank_mask:0xf
v_fmac_f32_dpp v105, v253, v245 row_newbcast:9 row_mask:0xf bank_mask:0xf
v_mfma_f32_16x16x32_bf16 v[224:227], a[236:239], v[184:187], v[224:227]
v_fmac_f32_dpp v106, v253, v246 row_newbcast:10 row_mask:0xf bank_mask:0xf
v_fmac_f32_dpp v107, v253, v247 row_newbcast:11 row_mask:0xf bank_mask:0xf
v_mfma_f32_16x16x32_bf16 v[228:231], a[244:247], v[184:187], v[228:231]
v_fmac_f32_dpp v108, v253, v188 row_newbcast:12 row_mask:0xf bank_mask:0xf
v_fmac_f32_dpp v109, v253, v189 row_newbcast:13 row_mask:0xf bank_mask:0xf
v_mfma_f32_16x16x32_bf16 v[232:235], a[252:255], v[184:187], v[232:235]
s_add_u32 m0, s80, 4096
s_nop 0
buffer_load_dwordx4 v7, s[12:15], s66 offen offset:2048 sc1 lds
v_fmac_f32_dpp v110, v253, v190 row_newbcast:14 row_mask:0xf bank_mask:0xf
v_fmac_f32_dpp v111, v253, v191 row_newbcast:15 row_mask:0xf bank_mask:0xf
ds_read_b128 v[128:131], v9 offset:0
ds_read_b128 v[144:147], v9 offset:2048
ds_read_b128 v[132:135], v9 offset:16
ds_read_b128 v[148:151], v9 offset:2064
ds_read_b128 v[136:139], v9 offset:32
ds_read_b128 v[152:155], v9 offset:2080
ds_read_b128 v[140:143], v9 offset:48
ds_read_b128 v[156:159], v9 offset:2096
v_fmac_f32_dpp v112, v254, v220 row_newbcast:0 row_mask:0xf bank_mask:0xf
v_fmac_f32_dpp v113, v254, v221 row_newbcast:1 row_mask:0xf bank_mask:0xf
v_fmac_f32_dpp v114, v254, v222 row_newbcast:2 row_mask:0xf bank_mask:0xf
v_fmac_f32_dpp v115, v254, v223 row_newbcast:3 row_mask:0xf bank_mask:0xf
v_fmac_f32_dpp v116, v254, v224 row_newbcast:4 row_mask:0xf bank_mask:0xf
v_fmac_f32_dpp v117, v254, v225 row_newbcast:5 row_mask:0xf bank_mask:0xf
v_fmac_f32_dpp v118, v254, v226 row_newbcast:6 row_mask:0xf bank_mask:0xf
v_fmac_f32_dpp v119, v254, v227 row_newbcast:7 row_mask:0xf bank_mask:0xf
s_add_u32 m0, s80, 5120
s_nop 0
buffer_load_dwordx4 v8, s[12:15], s66 offen offset:2048 sc1 lds
v_fmac_f32_dpp v120, v254, v228 row_newbcast:8 row_mask:0xf bank_mask:0xf
v_fmac_f32_dpp v121, v254, v229 row_newbcast:9 row_mask:0xf bank_mask:0xf
v_fmac_f32_dpp v122, v254, v230 row_newbcast:10 row_mask:0xf bank_mask:0xf
v_fmac_f32_dpp v123, v254, v231 row_newbcast:11 row_mask:0xf bank_mask:0xf
v_fmac_f32_dpp v124, v254, v232 row_newbcast:12 row_mask:0xf bank_mask:0xf
v_fmac_f32_dpp v125, v254, v233 row_newbcast:13 row_mask:0xf bank_mask:0xf
v_fmac_f32_dpp v126, v254, v234 row_newbcast:14 row_mask:0xf bank_mask:0xf
v_fmac_f32_dpp v127, v254, v235 row_newbcast:15 row_mask:0xf bank_mask:0xf
v_accvgpr_write_b32 a252, -1
v_accvgpr_write_b32 a253, -1
v_accvgpr_write_b32 a254, -1
v_accvgpr_write_b32 a255, -1
v_pk_add_f32 v[192:193], v[16:17], v[18:19]
v_pk_mul_f32 v[194:195], v[16:17], v[16:17]
v_pk_fma_f32 v[194:195], v[18:19], v[18:19], v[194:195]
v_pk_add_f32 v[192:193], v[192:193], v[20:21]
v_pk_fma_f32 v[194:195], v[20:21], v[20:21], v[194:195]
v_pk_add_f32 v[192:193], v[192:193], v[22:23]
v_pk_fma_f32 v[194:195], v[22:23], v[22:23], v[194:195]
buffer_store_dwordx4 a[252:255], v2, s[12:15], s72 offen offset:0 sc1
v_pk_add_f32 v[192:193], v[192:193], v[24:25]
v_pk_fma_f32 v[194:195], v[24:25], v[24:25], v[194:195]
v_pk_add_f32 v[192:193], v[192:193], v[26:27]
v_pk_fma_f32 v[194:195], v[26:27], v[26:27], v[194:195]
v_pk_add_f32 v[192:193], v[192:193], v[28:29]
v_pk_fma_f32 v[194:195], v[28:29], v[28:29], v[194:195]
v_pk_add_f32 v[192:193], v[192:193], v[30:31]
v_pk_fma_f32 v[194:195], v[30:31], v[30:31], v[194:195]
v_pk_add_f32 v[192:193], v[192:193], v[32:33]
v_pk_fma_f32 v[194:195], v[32:33], v[32:33], v[194:195]
v_pk_add_f32 v[192:193], v[192:193], v[34:35]
v_pk_fma_f32 v[194:195], v[34:35], v[34:35], v[194:195]
v_pk_add_f32 v[192:193], v[192:193], v[36:37]
v_pk_fma_f32 v[194:195], v[36:37], v[36:37], v[194:195]
v_pk_add_f32 v[192:193], v[192:193], v[38:39]
v_pk_fma_f32 v[194:195], v[38:39], v[38:39], v[194:195]
v_pk_add_f32 v[192:193], v[192:193], v[40:41]
v_pk_fma_f32 v[194:195], v[40:41], v[40:41], v[194:195]
v_pk_add_f32 v[192:193], v[192:193], v[42:43]
v_pk_fma_f32 v[194:195], v[42:43], v[42:43], v[194:195]
buffer_store_dwordx4 a[252:255], v2, s[12:15], s72 offen offset:1024 sc1
v_pk_add_f32 v[192:193], v[192:193], v[44:45]
v_pk_fma_f32 v[194:195], v[44:45], v[44:45], v[194:195]
v_pk_add_f32 v[192:193], v[192:193], v[46:47]
v_pk_fma_f32 v[194:195], v[46:47], v[46:47], v[194:195]
v_pk_add_f32 v[192:193], v[192:193], v[48:49]
v_pk_fma_f32 v[194:195], v[48:49], v[48:49], v[194:195]
v_pk_add_f32 v[192:193], v[192:193], v[50:51]
v_pk_fma_f32 v[194:195], v[50:51], v[50:51], v[194:195]
v_pk_add_f32 v[192:193], v[192:193], v[52:53]
v_pk_fma_f32 v[194:195], v[52:53], v[52:53], v[194:195]
v_pk_add_f32 v[192:193], v[192:193], v[54:55]
v_pk_fma_f32 v[194:195], v[54:55], v[54:55], v[194:195]
v_pk_add_f32 v[192:193], v[192:193], v[56:57]
v_pk_fma_f32 v[194:195], v[56:57], v[56:57], v[194:195]
v_pk_add_f32 v[192:193], v[192:193], v[58:59]
v_pk_fma_f32 v[194:195], v[58:59], v[58:59], v[194:195]
v_pk_add_f32 v[192:193], v[192:193], v[60:61]
v_pk_fma_f32 v[194:195], v[60:61], v[60:61], v[194:195]
v_pk_add_f32 v[192:193], v[192:193], v[62:63]
v_pk_fma_f32 v[194:195], v[62:63], v[62:63], v[194:195]
buffer_store_dwordx4 a[252:255], v2, s[12:15], s72 offen offset:2048 sc1
v_pk_add_f32 v[192:193], v[192:193], v[64:65]
v_pk_fma_f32 v[194:195], v[64:65], v[64:65], v[194:195]
v_pk_add_f32 v[192:193], v[192:193], v[66:67]
v_pk_fma_f32 v[194:195], v[66:67], v[66:67], v[194:195]
v_pk_add_f32 v[192:193], v[192:193], v[68:69]
v_pk_fma_f32 v[194:195], v[68:69], v[68:69], v[194:195]
v_pk_add_f32 v[192:193], v[192:193], v[70:71]
v_pk_fma_f32 v[194:195], v[70:71], v[70:71], v[194:195]
v_pk_add_f32 v[192:193], v[192:193], v[72:73]
v_pk_fma_f32 v[194:195], v[72:73], v[72:73], v[194:195]
v_pk_add_f32 v[192:193], v[192:193], v[74:75]
v_pk_fma_f32 v[194:195], v[74:75], v[74:75], v[194:195]
v_pk_add_f32 v[192:193], v[192:193], v[76:77]
v_pk_fma_f32 v[194:195], v[76:77], v[76:77], v[194:195]
v_pk_add_f32 v[192:193], v[192:193], v[78:79]
v_pk_fma_f32 v[194:195], v[78:79], v[78:79], v[194:195]
v_pk_add_f32 v[192:193], v[192:193], v[80:81]
v_pk_fma_f32 v[194:195], v[80:81], v[80:81], v[194:195]
v_pk_add_f32 v[192:193], v[192:193], v[82:83]
v_pk_fma_f32 v[194:195], v[82:83], v[82:83], v[194:195]
buffer_store_dwordx4 a[252:255], v2, s[12:15], s72 offen offset:3072 sc1
v_pk_add_f32 v[192:193], v[192:193], v[84:85]
v_pk_fma_f32 v[194:195], v[84:85], v[84:85], v[194:195]
v_pk_add_f32 v[192:193], v[192:193], v[86:87]
v_pk_fma_f32 v[194:195], v[86:87], v[86:87], v[194:195]
v_pk_add_f32 v[192:193], v[192:193], v[88:89]
v_pk_fma_f32 v[194:195], v[88:89], v[88:89], v[194:195]
v_pk_add_f32 v[192:193], v[192:193], v[90:91]
v_pk_fma_f32 v[194:195], v[90:91], v[90:91], v[194:195]
v_pk_add_f32 v[192:193], v[192:193], v[92:93]
v_pk_fma_f32 v[194:195], v[92:93], v[92:93], v[194:195]
v_pk_add_f32 v[192:193], v[192:193], v[94:95]
v_pk_fma_f32 v[194:195], v[94:95], v[94:95], v[194:195]
v_pk_add_f32 v[192:193], v[192:193], v[96:97]
v_pk_fma_f32 v[194:195], v[96:97], v[96:97], v[194:195]
v_pk_add_f32 v[192:193], v[192:193], v[98:99]
v_pk_fma_f32 v[194:195], v[98:99], v[98:99], v[194:195]
v_pk_add_f32 v[192:193], v[192:193], v[100:101]
v_pk_fma_f32 v[194:195], v[100:101], v[100:101], v[194:195]
v_pk_add_f32 v[192:193], v[192:193], v[102:103]
v_pk_fma_f32 v[194:195], v[102:103], v[102:103], v[194:195]
buffer_store_dwordx4 a[252:255], v2, s[12:15], s79 offen offset:0 sc1
v_pk_add_f32 v[192:193], v[192:193], v[104:105]
v_pk_fma_f32 v[194:195], v[104:105], v[104:105], v[194:195]
v_pk_add_f32 v[192:193], v[192:193], v[106:107]
v_pk_fma_f32 v[194:195], v[106:107], v[106:107], v[194:195]
v_pk_add_f32 v[192:193], v[192:193], v[108:109]
v_pk_fma_f32 v[194:195], v[108:109], v[108:109], v[194:195]
v_pk_add_f32 v[192:193], v[192:193], v[110:111]
v_pk_fma_f32 v[194:195], v[110:111], v[110:111], v[194:195]
v_pk_add_f32 v[192:193], v[192:193], v[112:113]
v_pk_fma_f32 v[194:195], v[112:113], v[112:113], v[194:195]
v_pk_add_f32 v[192:193], v[192:193], v[114:115]
v_pk_fma_f32 v[194:195], v[114:115], v[114:115], v[194:195]
v_pk_add_f32 v[192:193], v[192:193], v[116:117]
v_pk_fma_f32 v[194:195], v[116:117], v[116:117], v[194:195]
v_pk_add_f32 v[192:193], v[192:193], v[118:119]
v_pk_fma_f32 v[194:195], v[118:119], v[118:119], v[194:195]
v_pk_add_f32 v[192:193], v[192:193], v[120:121]
v_pk_fma_f32 v[194:195], v[120:121], v[120:121], v[194:195]
v_pk_add_f32 v[192:193], v[192:193], v[122:123]
v_pk_fma_f32 v[194:195], v[122:123], v[122:123], v[194:195]
buffer_store_dwordx4 a[252:255], v2, s[12:15], s79 offen offset:1024 sc1
v_pk_add_f32 v[192:193], v[192:193], v[124:125]
v_pk_fma_f32 v[194:195], v[124:125], v[124:125], v[194:195]
v_pk_add_f32 v[192:193], v[192:193], v[126:127]
v_pk_fma_f32 v[194:195], v[126:127], v[126:127], v[194:195]
ds_read_b128 v[160:163], v9 offset:64
ds_read_b128 v[176:179], v9 offset:2112
ds_read_b128 v[164:167], v9 offset:80
ds_read_b128 v[180:183], v9 offset:2128
ds_read_b128 v[168:171], v9 offset:96
ds_read_b128 v[184:187], v9 offset:2144
ds_read_b128 v[172:175], v9 offset:112
ds_read_b128 v[188:191], v9 offset:2160
v_add_f32 v192, v192, v193
v_add_f32 v194, v194, v195
s_nop 1
v_permlane32_swap_b32 v192, v194
v_add_f32 v192, v192, v194
v_mov_b32 v194, v192
s_nop 1
v_permlane16_swap_b32 v192, v194
v_add_f32 v192, v192, v194
v_mul_f32 v192, 0x3b124925, v192
v_mov_b32 v194, v192
s_nop 1
v_permlane32_swap_b32 v192, v194
buffer_store_dwordx4 a[252:255], v2, s[12:15], s79 offen offset:2048 sc1
v_fma_f32 v194, -v192, v192, v194
v_max_f32 v194, 0, v194
v_add_f32 v194, 0x3727c5ac, v194
v_rsq_f32 v194, v194
s_nop 0
v_mul_f32 v195, -v192, v194
v_pk_fma_f32 v[220:221], v[16:17], v[194:195], v[194:195] op_sel:[0,0,1] op_sel_hi:[1,0,1]
v_pk_fma_f32 v[222:223], v[18:19], v[194:195], v[194:195] op_sel:[0,0,1] op_sel_hi:[1,0,1]
v_pk_fma_f32 v[224:225], v[20:21], v[194:195], v[194:195] op_sel:[0,0,1] op_sel_hi:[1,0,1]
v_pk_fma_f32 v[226:227], v[22:23], v[194:195], v[194:195] op_sel:[0,0,1] op_sel_hi:[1,0,1]
v_pk_fma_f32 v[228:229], v[24:25], v[194:195], v[194:195] op_sel:[0,0,1] op_sel_hi:[1,0,1]
v_pk_fma_f32 v[230:231], v[26:27], v[194:195], v[194:195] op_sel:[0,0,1] op_sel_hi:[1,0,1]
v_pk_fma_f32 v[232:233], v[28:29], v[194:195], v[194:195] op_sel:[0,0,1] op_sel_hi:[1,0,1]
v_pk_fma_f32 v[234:235], v[30:31], v[194:195], v[194:195] op_sel:[0,0,1] op_sel_hi:[1,0,1]
s_waitcnt lgkmcnt(14)
v_pk_fma_f32 v[220:221], v[220:221], v[128:129], v[144:145]
v_pk_fma_f32 v[222:223], v[222:223], v[130:131], v[146:147]
s_waitcnt lgkmcnt(12)
v_pk_fma_f32 v[224:225], v[224:225], v[132:133], v[148:149]
v_pk_fma_f32 v[226:227], v[226:227], v[134:135], v[150:151]
s_waitcnt lgkmcnt(10)
v_pk_fma_f32 v[228:229], v[228:229], v[136:137], v[152:153]
v_pk_fma_f32 v[230:231], v[230:231], v[138:139], v[154:155]
buffer_store_dwordx4 a[252:255], v2, s[12:15], s79 offen offset:3072 sc1
s_waitcnt lgkmcnt(8)
v_pk_fma_f32 v[232:233], v[232:233], v[140:141], v[156:157]
v_pk_fma_f32 v[234:235], v[234:235], v[142:143], v[158:159]
ds_read_b128 v[128:131], v9 offset:128
ds_read_b128 v[144:147], v9 offset:2176
ds_read_b128 v[132:135], v9 offset:144
ds_read_b128 v[148:151], v9 offset:2192
ds_read_b128 v[136:139], v9 offset:160
ds_read_b128 v[152:155], v9 offset:2208
ds_read_b128 v[140:143], v9 offset:176
ds_read_b128 v[156:159], v9 offset:2224
v_cvt_pk_bf16_f32 v200, v220, v221
v_cvt_pk_bf16_f32 v201, v222, v223
v_cvt_pk_bf16_f32 v202, v224, v225
v_cvt_pk_bf16_f32 v203, v226, v227
v_cvt_pk_bf16_f32 v204, v228, v229
v_cvt_pk_bf16_f32 v205, v230, v231
v_cvt_pk_bf16_f32 v206, v232, v233
v_cvt_pk_bf16_f32 v207, v234, v235
ds_write_b128 v10, v[200:203] offset:0
ds_write_b128 v10, v[204:207] offset:16
s_add_u32 m0, s80, 8192
s_nop 0
buffer_load_dwordx4 v7, s[12:15], s67 offen offset:0 sc1 lds
v_pk_fma_f32 v[236:237], v[32:33], v[194:195], v[194:195] op_sel:[0,0,1] op_sel_hi:[1,0,1]
v_pk_fma_f32 v[238:239], v[34:35], v[194:195], v[194:195] op_sel:[0,0,1] op_sel_hi:[1,0,1]
v_pk_fma_f32 v[240:241], v[36:37], v[194:195], v[194:195] op_sel:[0,0,1] op_sel_hi:[1,0,1]
v_pk_fma_f32 v[242:243], v[38:39], v[194:195], v[194:195] op_sel:[0,0,1] op_sel_hi:[1,0,1]
v_pk_fma_f32 v[244:245], v[40:41], v[194:195], v[194:195] op_sel:[0,0,1] op_sel_hi:[1,0,1]
v_pk_fma_f32 v[246:247], v[42:43], v[194:195], v[194:195] op_sel:[0,0,1] op_sel_hi:[1,0,1]
v_pk_fma_f32 v[248:249], v[44:45], v[194:195], v[194:195] op_sel:[0,0,1] op_sel_hi:[1,0,1]
v_pk_fma_f32 v[250:251], v[46:47], v[194:195], v[194:195] op_sel:[0,0,1] op_sel_hi:[1,0,1]
s_waitcnt lgkmcnt(15)
v_pk_fma_f32 v[236:237], v[236:237], v[160:161], v[176:177]
v_pk_fma_f32 v[238:239], v[238:239], v[162:163], v[178:179]
s_waitcnt lgkmcnt(14)
v_pk_fma_f32 v[240:241], v[240:241], v[164:165], v[180:181]
v_pk_fma_f32 v[242:243], v[242:243], v[166:167], v[182:183]
s_waitcnt lgkmcnt(12)
v_pk_fma_f32 v[244:245], v[244:245], v[168:169], v[184:185]
v_pk_fma_f32 v[246:247], v[246:247], v[170:171], v[186:187]
s_waitcnt lgkmcnt(10)
v_pk_fma_f32 v[248:249], v[248:249], v[172:173], v[188:189]
v_pk_fma_f32 v[250:251], v[250:251], v[174:175], v[190:191]
ds_read_b128 v[160:163], v9 offset:192
ds_read_b128 v[176:179], v9 offset:2240
s_add_u32 m0, s80, 9216
s_nop 0
buffer_load_dwordx4 v8, s[12:15], s67 offen offset:0 sc1 lds
ds_read_b128 v[164:167], v9 offset:208
ds_read_b128 v[180:183], v9 offset:2256
ds_read_b128 v[168:171], v9 offset:224
ds_read_b128 v[184:187], v9 offset:2272
ds_read_b128 v[172:175], v9 offset:240
ds_read_b128 v[188:191], v9 offset:2288
v_cvt_pk_bf16_f32 v208, v236, v237
v_cvt_pk_bf16_f32 v209, v238, v239
v_cvt_pk_bf16_f32 v210, v240, v241
v_cvt_pk_bf16_f32 v211, v242, v243
v_cvt_pk_bf16_f32 v212, v244, v245
v_cvt_pk_bf16_f32 v213, v246, v247
v_cvt_pk_bf16_f32 v214, v248, v249
v_cvt_pk_bf16_f32 v215, v250, v251
ds_write_b128 v10, v[208:211] offset:32
ds_write_b128 v10, v[212:215] offset:48
s_add_u32 s3, s67, 2048
s_add_u32 m0, s81, 0
s_nop 0
buffer_load_dwordx4 v7, s[12:15], s3 offen offset:0 sc1 lds
v_pk_fma_f32 v[220:221], v[48:49], v[194:195], v[194:195] op_sel:[0,0,1] op_sel_hi:[1,0,1]
v_pk_fma_f32 v[222:223], v[50:51], v[194:195], v[194:195] op_sel:[0,0,1] op_sel_hi:[1,0,1]
v_pk_fma_f32 v[224:225], v[52:53], v[194:195], v[194:195] op_sel:[0,0,1] op_sel_hi:[1,0,1]
v_pk_fma_f32 v[226:227], v[54:55], v[194:195], v[194:195] op_sel:[0,0,1] op_sel_hi:[1,0,1]
v_pk_fma_f32 v[228:229], v[56:57], v[194:195], v[194:195] op_sel:[0,0,1] op_sel_hi:[1,0,1]
v_pk_fma_f32 v[230:231], v[58:59], v[194:195], v[194:195] op_sel:[0,0,1] op_sel_hi:[1,0,1]
v_pk_fma_f32 v[232:233], v[60:61], v[194:195], v[194:195] op_sel:[0,0,1] op_sel_hi:[1,0,1]
v_pk_fma_f32 v[234:235], v[62:63], v[194:195], v[194:195] op_sel:[0,0,1] op_sel_hi:[1,0,1]
s_waitcnt lgkmcnt(15)
v_pk_fma_f32 v[220:221], v[220:221], v[128:129], v[144:145]
v_pk_fma_f32 v[222:223], v[222:223], v[130:131], v[146:147]
v_pk_fma_f32 v[224:225], v[224:225], v[132:133], v[148:149]
v_pk_fma_f32 v[226:227], v[226:227], v[134:135], v[150:151]
s_waitcnt lgkmcnt(14)
v_pk_fma_f32 v[228:229], v[228:229], v[136:137], v[152:153]
v_pk_fma_f32 v[230:231], v[230:231], v[138:139], v[154:155]
s_waitcnt lgkmcnt(12)
v_pk_fma_f32 v[232:233], v[232:233], v[140:141], v[156:157]
v_pk_fma_f32 v[234:235], v[234:235], v[142:143], v[158:159]
ds_read_b128 v[128:131], v9 offset:256
ds_read_b128 v[144:147], v9 offset:2304
s_add_u32 s3, s67, 2048
s_add_u32 m0, s81, 1024
s_nop 0
buffer_load_dwordx4 v8, s[12:15], s3 offen offset:0 sc1 lds
ds_read_b128 v[132:135], v9 offset:272
ds_read_b128 v[148:151], v9 offset:2320
ds_read_b128 v[136:139], v9 offset:288
ds_read_b128 v[152:155], v9 offset:2336
ds_read_b128 v[140:143], v9 offset:304
ds_read_b128 v[156:159], v9 offset:2352
v_cvt_pk_bf16_f32 v200, v220, v221
v_cvt_pk_bf16_f32 v201, v222, v223
v_cvt_pk_bf16_f32 v202, v224, v225
v_cvt_pk_bf16_f32 v203, v226, v227
v_cvt_pk_bf16_f32 v204, v228, v229
v_cvt_pk_bf16_f32 v205, v230, v231
v_cvt_pk_bf16_f32 v206, v232, v233
v_cvt_pk_bf16_f32 v207, v234, v235
ds_write_b128 v10, v[200:203] offset:64
ds_write_b128 v10, v[204:207] offset:80
s_add_u32 m0, s81, 2048
s_nop 0
buffer_load_dwordx4 v7, s[12:15], s68 offen offset:0 sc1 lds
v_pk_fma_f32 v[236:237], v[64:65], v[194:195], v[194:195] op_sel:[0,0,1] op_sel_hi:[1,0,1]
v_pk_fma_f32 v[238:239], v[66:67], v[194:195], v[194:195] op_sel:[0,0,1] op_sel_hi:[1,0,1]
v_pk_fma_f32 v[240:241], v[68:69], v[194:195], v[194:195] op_sel:[0,0,1] op_sel_hi:[1,0,1]
v_pk_fma_f32 v[242:243], v[70:71], v[194:195], v[194:195] op_sel:[0,0,1] op_sel_hi:[1,0,1]
v_pk_fma_f32 v[244:245], v[72:73], v[194:195], v[194:195] op_sel:[0,0,1] op_sel_hi:[1,0,1]
v_pk_fma_f32 v[246:247], v[74:75], v[194:195], v[194:195] op_sel:[0,0,1] op_sel_hi:[1,0,1]
v_pk_fma_f32 v[248:249], v[76:77], v[194:195], v[194:195] op_sel:[0,0,1] op_sel_hi:[1,0,1]
v_pk_fma_f32 v[250:251], v[78:79], v[194:195], v[194:195] op_sel:[0,0,1] op_sel_hi:[1,0,1]
s_waitcnt lgkmcnt(15)
v_pk_fma_f32 v[236:237], v[236:237], v[160:161], v[176:177]
v_pk_fma_f32 v[238:239], v[238:239], v[162:163], v[178:179]
v_pk_fma_f32 v[240:241], v[240:241], v[164:165], v[180:181]
v_pk_fma_f32 v[242:243], v[242:243], v[166:167], v[182:183]
s_waitcnt lgkmcnt(14)
v_pk_fma_f32 v[244:245], v[244:245], v[168:169], v[184:185]
v_pk_fma_f32 v[246:247], v[246:247], v[170:171], v[186:187]
s_waitcnt lgkmcnt(12)
v_pk_fma_f32 v[248:249], v[248:249], v[172:173], v[188:189]
v_pk_fma_f32 v[250:251], v[250:251], v[174:175], v[190:191]
ds_read_b128 v[160:163], v9 offset:320
ds_read_b128 v[176:179], v9 offset:2368
s_add_u32 m0, s81, 3072
s_nop 0
buffer_load_dwordx4 v8, s[12:15], s68 offen offset:0 sc1 lds
ds_read_b128 v[164:167], v9 offset:336
ds_read_b128 v[180:183], v9 offset:2384
ds_read_b128 v[168:171], v9 offset:352
ds_read_b128 v[184:187], v9 offset:2400
ds_read_b128 v[172:175], v9 offset:368
ds_read_b128 v[188:191], v9 offset:2416
v_cvt_pk_bf16_f32 v208, v236, v237
v_cvt_pk_bf16_f32 v209, v238, v239
v_cvt_pk_bf16_f32 v210, v240, v241
v_cvt_pk_bf16_f32 v211, v242, v243
v_cvt_pk_bf16_f32 v212, v244, v245
v_cvt_pk_bf16_f32 v213, v246, v247
v_cvt_pk_bf16_f32 v214, v248, v249
v_cvt_pk_bf16_f32 v215, v250, v251
ds_write_b128 v10, v[208:211] offset:96
ds_write_b128 v10, v[212:215] offset:112
s_add_u32 m0, s81, 2048
s_nop 0
buffer_load_dwordx4 v7, s[12:15], s68 offen offset:2048 sc1 lds
v_pk_fma_f32 v[220:221], v[80:81], v[194:195], v[194:195] op_sel:[0,0,1] op_sel_hi:[1,0,1]
v_pk_fma_f32 v[222:223], v[82:83], v[194:195], v[194:195] op_sel:[0,0,1] op_sel_hi:[1,0,1]
v_pk_fma_f32 v[224:225], v[84:85], v[194:195], v[194:195] op_sel:[0,0,1] op_sel_hi:[1,0,1]
v_pk_fma_f32 v[226:227], v[86:87], v[194:195], v[194:195] op_sel:[0,0,1] op_sel_hi:[1,0,1]
v_pk_fma_f32 v[228:229], v[88:89], v[194:195], v[194:195] op_sel:[0,0,1] op_sel_hi:[1,0,1]
v_pk_fma_f32 v[230:231], v[90:91], v[194:195], v[194:195] op_sel:[0,0,1] op_sel_hi:[1,0,1]
v_pk_fma_f32 v[232:233], v[92:93], v[194:195], v[194:195] op_sel:[0,0,1] op_sel_hi:[1,0,1]
v_pk_fma_f32 v[234:235], v[94:95], v[194:195], v[194:195] op_sel:[0,0,1] op_sel_hi:[1,0,1]
s_waitcnt lgkmcnt(15)
v_pk_fma_f32 v[220:221], v[220:221], v[128:129], v[144:145]
v_pk_fma_f32 v[222:223], v[222:223], v[130:131], v[146:147]
v_pk_fma_f32 v[224:225], v[224:225], v[132:133], v[148:149]
v_pk_fma_f32 v[226:227], v[226:227], v[134:135], v[150:151]
s_waitcnt lgkmcnt(14)
v_pk_fma_f32 v[228:229], v[228:229], v[136:137], v[152:153]
v_pk_fma_f32 v[230:231], v[230:231], v[138:139], v[154:155]
s_waitcnt lgkmcnt(12)
v_pk_fma_f32 v[232:233], v[232:233], v[140:141], v[156:157]
v_pk_fma_f32 v[234:235], v[234:235], v[142:143], v[158:159]
ds_read_b128 v[128:131], v9 offset:384
ds_read_b128 v[144:147], v9 offset:2432
s_add_u32 m0, s81, 3072
s_nop 0
buffer_load_dwordx4 v8, s[12:15], s68 offen offset:2048 sc1 lds
ds_read_b128 v[132:135], v9 offset:400
ds_read_b128 v[148:151], v9 offset:2448
ds_read_b128 v[136:139], v9 offset:416
ds_read_b128 v[152:155], v9 offset:2464
ds_read_b128 v[140:143], v9 offset:432
ds_read_b128 v[156:159], v9 offset:2480
v_cvt_pk_bf16_f32 v200, v220, v221
v_cvt_pk_bf16_f32 v201, v222, v223
v_cvt_pk_bf16_f32 v202, v224, v225
v_cvt_pk_bf16_f32 v203, v226, v227
v_cvt_pk_bf16_f32 v204, v228, v229
v_cvt_pk_bf16_f32 v205, v230, v231
v_cvt_pk_bf16_f32 v206, v232, v233
v_cvt_pk_bf16_f32 v207, v234, v235
ds_write_b128 v10, v[200:203] offset:128
ds_write_b128 v10, v[204:207] offset:144
s_add_u32 m0, s81, 6144
s_nop 0
buffer_load_dwordx4 v7, s[12:15], s69 offen offset:0 sc1 lds
v_pk_fma_f32 v[236:237], v[96:97], v[194:195], v[194:195] op_sel:[0,0,1] op_sel_hi:[1,0,1]
v_pk_fma_f32 v[238:239], v[98:99], v[194:195], v[194:195] op_sel:[0,0,1] op_sel_hi:[1,0,1]
v_pk_fma_f32 v[240:241], v[100:101], v[194:195], v[194:195] op_sel:[0,0,1] op_sel_hi:[1,0,1]
v_pk_fma_f32 v[242:243], v[102:103], v[194:195], v[194:195] op_sel:[0,0,1] op_sel_hi:[1,0,1]
v_pk_fma_f32 v[244:245], v[104:105], v[194:195], v[194:195] op_sel:[0,0,1] op_sel_hi:[1,0,1]
v_pk_fma_f32 v[246:247], v[106:107], v[194:195], v[194:195] op_sel:[0,0,1] op_sel_hi:[1,0,1]
v_pk_fma_f32 v[248:249], v[108:109], v[194:195], v[194:195] op_sel:[0,0,1] op_sel_hi:[1,0,1]
v_pk_fma_f32 v[250:251], v[110:111], v[194:195], v[194:195] op_sel:[0,0,1] op_sel_hi:[1,0,1]
s_waitcnt lgkmcnt(15)
v_pk_fma_f32 v[236:237], v[236:237], v[160:161], v[176:177]
v_pk_fma_f32 v[238:239], v[238:239], v[162:163], v[178:179]
v_pk_fma_f32 v[240:241], v[240:241], v[164:165], v[180:181]
v_pk_fma_f32 v[242:243], v[242:243], v[166:167], v[182:183]
s_waitcnt lgkmcnt(14)
v_pk_fma_f32 v[244:245], v[244:245], v[168:169], v[184:185]
v_pk_fma_f32 v[246:247], v[246:247], v[170:171], v[186:187]
s_waitcnt lgkmcnt(12)
v_pk_fma_f32 v[248:249], v[248:249], v[172:173], v[188:189]
v_pk_fma_f32 v[250:251], v[250:251], v[174:175], v[190:191]
v_cvt_pk_bf16_f32 v208, v236, v237
v_cvt_pk_bf16_f32 v209, v238, v239
s_add_u32 m0, s81, 7168
s_nop 0
buffer_load_dwordx4 v8, s[12:15], s69 offen offset:0 sc1 lds
v_cvt_pk_bf16_f32 v210, v240, v241
v_cvt_pk_bf16_f32 v211, v242, v243
v_cvt_pk_bf16_f32 v212, v244, v245
v_cvt_pk_bf16_f32 v213, v246, v247
v_cvt_pk_bf16_f32 v214, v248, v249
v_cvt_pk_bf16_f32 v215, v250, v251
ds_write_b128 v10, v[208:211] offset:160
ds_write_b128 v10, v[212:215] offset:176
v_pk_fma_f32 v[220:221], v[112:113], v[194:195], v[194:195] op_sel:[0,0,1] op_sel_hi:[1,0,1]
v_pk_fma_f32 v[222:223], v[114:115], v[194:195], v[194:195] op_sel:[0,0,1] op_sel_hi:[1,0,1]
s_add_u32 m0, s81, 6144
s_nop 0
buffer_load_dwordx4 v7, s[12:15], s69 offen offset:2048 sc1 lds
v_pk_fma_f32 v[224:225], v[116:117], v[194:195], v[194:195] op_sel:[0,0,1] op_sel_hi:[1,0,1]
v_pk_fma_f32 v[226:227], v[118:119], v[194:195], v[194:195] op_sel:[0,0,1] op_sel_hi:[1,0,1]
v_pk_fma_f32 v[228:229], v[120:121], v[194:195], v[194:195] op_sel:[0,0,1] op_sel_hi:[1,0,1]
v_pk_fma_f32 v[230:231], v[122:123], v[194:195], v[194:195] op_sel:[0,0,1] op_sel_hi:[1,0,1]
v_pk_fma_f32 v[232:233], v[124:125], v[194:195], v[194:195] op_sel:[0,0,1] op_sel_hi:[1,0,1]
v_pk_fma_f32 v[234:235], v[126:127], v[194:195], v[194:195] op_sel:[0,0,1] op_sel_hi:[1,0,1]
s_waitcnt lgkmcnt(10)
v_pk_fma_f32 v[220:221], v[220:221], v[128:129], v[144:145]
v_pk_fma_f32 v[222:223], v[222:223], v[130:131], v[146:147]
s_waitcnt lgkmcnt(8)
v_pk_fma_f32 v[224:225], v[224:225], v[132:133], v[148:149]
v_pk_fma_f32 v[226:227], v[226:227], v[134:135], v[150:151]
s_waitcnt lgkmcnt(6)
v_pk_fma_f32 v[228:229], v[228:229], v[136:137], v[152:153]
v_pk_fma_f32 v[230:231], v[230:231], v[138:139], v[154:155]
s_waitcnt lgkmcnt(4)
v_pk_fma_f32 v[232:233], v[232:233], v[140:141], v[156:157]
v_pk_fma_f32 v[234:235], v[234:235], v[142:143], v[158:159]
v_cvt_pk_bf16_f32 v200, v220, v221
v_cvt_pk_bf16_f32 v201, v222, v223
v_cvt_pk_bf16_f32 v202, v224, v225
v_cvt_pk_bf16_f32 v203, v226, v227
s_add_u32 m0, s81, 7168
s_nop 0
buffer_load_dwordx4 v8, s[12:15], s69 offen offset:2048 sc1 lds
v_cvt_pk_bf16_f32 v204, v228, v229
v_cvt_pk_bf16_f32 v205, v230, v231
v_cvt_pk_bf16_f32 v206, v232, v233
v_cvt_pk_bf16_f32 v207, v234, v235
ds_write_b128 v10, v[200:203] offset:192
ds_write_b128 v10, v[204:207] offset:208
v_and_b32 v3, 31, v1
v_mul_u32_u24 v3, 912, v3
v_lshrrev_b32 v9, 5, v1
v_lshl_add_u32 v3, v9, 4, v3
v_add_u32 v9, 49152, v3
v_mov_b32 v12, 1
s_lshl_b32 s4, s96, 2
s_add_u32 s4, s4, s62
s_mul_i32 s4, s4, 896
s_add_u32 s4, s4, 262144
s_lshl_b32 s5, s63, 7
s_add_u32 s83, s4, s5
v_min_u32 v13, 6, v1
v_lshl_add_u32 v13, v13, 7, s4
s_waitcnt lgkmcnt(0)
s_barrier
ds_read_b128 v[192:195], v9 offset:0
ds_read_b128 v[196:199], v9 offset:32
ds_read_b128 v[200:203], v9 offset:64
ds_read_b128 v[204:207], v9 offset:96
s_add_u32 s87, s73, 4096
s_add_u32 s88, s74, 4096
s_add_u32 s89, s75, 4096
s_add_u32 s90, s76, 4096
s_add_u32 s91, s77, 4096
s_add_u32 s92, s78, 4096
v_add_u32 v10, s80, v2
v_add_u32 v11, s81, v2
s_cmp_eq_u32 s63, 1
s_cbranch_scc1 t0v_32
s_cmp_eq_u32 s63, 2
s_cbranch_scc1 t0v_33
s_cmp_eq_u32 s63, 3
s_cbranch_scc1 t0v_34
s_cmp_eq_u32 s63, 4
s_cbranch_scc1 t0v_35
s_cmp_eq_u32 s63, 5
s_cbranch_scc1 t0v_36
s_cmp_eq_u32 s63, 6
s_cbranch_scc1 t0v_37
t0v_31:
s_waitcnt lgkmcnt(2)
v_mfma_f32_32x32x16_bf16 v[128:143], a[0:3], v[192:195], 0
buffer_load_dwordx4 a[224:227], v7, s[12:15], s64 offen offset:0 sc1
v_mfma_f32_32x32x16_bf16 v[144:159], a[112:115], v[192:195], 0
ds_read_b128 v[208:211], v9 offset:128
v_cvt_pk_bf16_f32 v240, v16, v17
v_cvt_pk_bf16_f32 v241, v32, v33
v_cvt_pk_bf16_f32 v242, v48, v49
v_cvt_pk_bf16_f32 v243, v64, v65
v_mfma_f32_32x32x16_bf16 v[128:143], a[4:7], v[196:199], v[128:143]
buffer_load_dwordx4 a[228:231], v8, s[12:15], s64 offen offset:0 sc1
s_mov_b32 exec_hi, 0
s_mov_b32 exec_lo, 0xffff
ds_write_b128 v4, v[240:243] offset:0
s_mov_b64 exec, -1
v_mfma_f32_32x32x16_bf16 v[144:159], a[116:119], v[196:199], v[144:159]
ds_read_b128 v[212:215], v9 offset:160
v_cvt_pk_bf16_f32 v244, v80, v81
v_cvt_pk_bf16_f32 v245, v96, v97
v_cvt_pk_bf16_f32 v246, v112, v113
v_cvt_pk_bf16_f32 v247, v18, v19
s_waitcnt lgkmcnt(3)
v_mfma_f32_32x32x16_bf16 v[128:143], a[8:11], v[200:203], v[128:143]
buffer_load_dwordx4 a[232:235], v7, s[12:15], s64 offen offset:2048 sc1
v_mfma_f32_32x32x16_bf16 v[144:159], a[120:123], v[200:203], v[144:159]
ds_read_b128 v[192:195], v9 offset:192
s_mov_b32 exec_hi, 0
s_mov_b32 exec_lo, 0xffff
ds_write_b128 v4, v[244:247] offset:512
s_mov_b64 exec, -1
v_mfma_f32_32x32x16_bf16 v[128:143], a[12:15], v[204:207], v[128:143]
buffer_load_dwordx4 a[236:239], v8, s[12:15], s64 offen offset:2048 sc1
v_cvt_pk_bf16_f32 v240, v34, v35
v_cvt_pk_bf16_f32 v241, v50, v51
v_cvt_pk_bf16_f32 v242, v66, v67
v_cvt_pk_bf16_f32 v243, v82, v83
v_mfma_f32_32x32x16_bf16 v[144:159], a[124:127], v[204:207], v[144:159]
ds_read_b128 v[196:199], v9 offset:224
s_add_u32 s3, s64, 4096
buffer_load_dwordx4 a[240:243], v7, s[12:15], s3 offen offset:0 sc1
s_waitcnt lgkmcnt(3)
v_mfma_f32_32x32x16_bf16 v[128:143], a[16:19], v[208:211], v[128:143]
s_add_u32 s3, s64, 4096
buffer_load_dwordx4 a[244:247], v8, s[12:15], s3 offen offset:0 sc1
v_mfma_f32_32x32x16_bf16 v[144:159], a[128:131], v[208:211], v[144:159]
ds_read_b128 v[200:203], v9 offset:256
s_add_u32 s3, s64, 4096
buffer_load_dwordx4 a[248:251], v7, s[12:15], s3 offen offset:2048 sc1
v_mfma_f32_32x32x16_bf16 v[128:143], a[20:23], v[212:215], v[128:143]
s_add_u32 s3, s64, 4096
buffer_load_dwordx4 a[252:255], v8, s[12:15], s3 offen offset:2048 sc1
v_mfma_f32_32x32x16_bf16 v[144:159], a[132:135], v[212:215], v[144:159]
ds_read_b128 v[204:207], v9 offset:288
s_mov_b32 exec_hi, 0
s_mov_b32 exec_lo, 0xffff
ds_write_b128 v4, v[240:243] offset:1024
s_mov_b64 exec, -1
s_waitcnt lgkmcnt(3)
v_mfma_f32_32x32x16_bf16 v[128:143], a[24:27], v[192:195], v[128:143]
v_cvt_pk_bf16_f32 v244, v98, v99
v_cvt_pk_bf16_f32 v245, v114, v115
v_cvt_pk_bf16_f32 v246, v20, v21
v_cvt_pk_bf16_f32 v247, v36, v37
v_mfma_f32_32x32x16_bf16 v[144:159], a[136:139], v[192:195], v[144:159]
ds_read_b128 v[208:211], v9 offset:320
s_mov_b32 exec_hi, 0
s_mov_b32 exec_lo, 0xffff
ds_write_b128 v4, v[244:247] offset:1536
s_mov_b64 exec, -1
v_mfma_f32_32x32x16_bf16 v[128:143], a[28:31], v[196:199], v[128:143]
v_cvt_pk_bf16_f32 v240, v52, v53
v_cvt_pk_bf16_f32 v241, v68, v69
v_cvt_pk_bf16_f32 v242, v84, v85
v_cvt_pk_bf16_f32 v243, v100, v101
v_mfma_f32_32x32x16_bf16 v[144:159], a[140:143], v[196:199], v[144:159]
ds_read_b128 v[212:215], v9 offset:352
s_mov_b32 exec_hi, 0
s_mov_b32 exec_lo, 0xffff
ds_write_b128 v4, v[240:243] offset:2048
s_mov_b64 exec, -1
s_waitcnt lgkmcnt(5)
v_mfma_f32_32x32x16_bf16 v[128:143], a[32:35], v[200:203], v[128:143]
v_cvt_pk_bf16_f32 v244, v116, v117
v_cvt_pk_bf16_f32 v245, v22, v23
v_cvt_pk_bf16_f32 v246, v38, v39
v_cvt_pk_bf16_f32 v247, v54, v55
v_mfma_f32_32x32x16_bf16 v[144:159], a[144:147], v[200:203], v[144:159]
ds_read_b128 v[192:195], v9 offset:384
s_mov_b32 exec_hi, 0
s_mov_b32 exec_lo, 0xffff
ds_write_b128 v4, v[244:247] offset:2560
s_mov_b64 exec, -1
v_mfma_f32_32x32x16_bf16 v[128:143], a[36:39], v[204:207], v[128:143]
v_cvt_pk_bf16_f32 v240, v70, v71
v_cvt_pk_bf16_f32 v241, v86, v87
v_cvt_pk_bf16_f32 v242, v102, v103
v_cvt_pk_bf16_f32 v243, v118, v119
v_mfma_f32_32x32x16_bf16 v[144:159], a[148:151], v[204:207], v[144:159]
ds_read_b128 v[196:199], v9 offset:416
s_mov_b32 exec_hi, 0
s_mov_b32 exec_lo, 0xffff
ds_write_b128 v4, v[240:243] offset:3072
s_mov_b64 exec, -1
s_waitcnt lgkmcnt(5)
v_mfma_f32_32x32x16_bf16 v[128:143], a[40:43], v[208:211], v[128:143]
v_cvt_pk_bf16_f32 v244, v24, v25
v_cvt_pk_bf16_f32 v245, v40, v41
v_cvt_pk_bf16_f32 v246, v56, v57
v_cvt_pk_bf16_f32 v247, v72, v73
v_mfma_f32_32x32x16_bf16 v[144:159], a[152:155], v[208:211], v[144:159]
ds_read_b128 v[200:203], v9 offset:448
s_mov_b32 exec_hi, 0
s_mov_b32 exec_lo, 0xffff
ds_write_b128 v4, v[244:247] offset:3584
s_mov_b64 exec, -1
v_mfma_f32_32x32x16_bf16 v[128:143], a[44:47], v[212:215], v[128:143]
v_mfma_f32_32x32x16_bf16 v[144:159], a[156:159], v[212:215], v[144:159]
ds_read_b128 v[204:207], v9 offset:480
s_waitcnt lgkmcnt(4)
v_mfma_f32_32x32x16_bf16 v[128:143], a[48:51], v[192:195], v[128:143]
v_mfma_f32_32x32x16_bf16 v[144:159], a[160:163], v[192:195], v[144:159]
ds_read_b128 v[208:211], v9 offset:512
v_mfma_f32_32x32x16_bf16 v[128:143], a[52:55], v[196:199], v[128:143]
buffer_load_dwordx4 v[16:19], v7, s[12:15], s70 offen offset:0 sc1
v_mfma_f32_32x32x16_bf16 v[144:159], a[164:167], v[196:199], v[144:159]
ds_read_b128 v[212:215], v9 offset:544
s_waitcnt lgkmcnt(2)
v_mfma_f32_32x32x16_bf16 v[128:143], a[56:59], v[200:203], v[128:143]
ds_read_b128 v[192:195], v9 offset:576
buffer_load_dwordx4 v[20:23], v8, s[12:15], s70 offen offset:0 sc1
v_mfma_f32_32x32x16_bf16 v[128:143], a[60:63], v[204:207], v[128:143]
ds_read_b128 v[196:199], v9 offset:608
s_waitcnt lgkmcnt(2)
v_mfma_f32_32x32x16_bf16 v[128:143], a[64:67], v[208:211], v[128:143]
ds_read_b128 v[200:203], v9 offset:640
buffer_load_dwordx4 v[24:27], v7, s[12:15], s70 offen offset:2048 sc1
v_mfma_f32_32x32x16_bf16 v[128:143], a[68:71], v[212:215], v[128:143]
ds_read_b128 v[204:207], v9 offset:672
s_waitcnt lgkmcnt(2)
v_mfma_f32_32x32x16_bf16 v[128:143], a[72:75], v[192:195], v[128:143]
ds_read_b128 v[208:211], v9 offset:704
buffer_load_dwordx4 v[28:31], v8, s[12:15], s70 offen offset:2048 sc1
s_waitcnt vmcnt(57)
v_mfma_f32_32x32x16_bf16 v[128:143], a[76:79], v[196:199], v[128:143]
ds_read_b128 v[212:215], v9 offset:736
s_waitcnt lgkmcnt(2)
s_waitcnt vmcnt(55)
v_mfma_f32_32x32x16_bf16 v[128:143], a[80:83], v[200:203], v[128:143]
ds_read_b128 v[192:195], v9 offset:768
s_add_u32 s3, s65, 4096
buffer_load_dwordx4 v[32:35], v7, s[12:15], s3 offen offset:0 sc1
s_waitcnt vmcnt(54)
v_mfma_f32_32x32x16_bf16 v[128:143], a[84:87], v[204:207], v[128:143]
ds_read_b128 v[196:199], v9 offset:800
s_waitcnt lgkmcnt(2)
s_waitcnt vmcnt(52)
v_mfma_f32_32x32x16_bf16 v[128:143], a[88:91], v[208:211], v[128:143]
ds_read_b128 v[200:203], v9 offset:832
s_add_u32 s3, s65, 4096
buffer_load_dwordx4 v[36:39], v8, s[12:15], s3 offen offset:0 sc1
s_waitcnt vmcnt(51)
v_mfma_f32_32x32x16_bf16 v[128:143], a[92:95], v[212:215], v[128:143]
ds_read_b128 v[204:207], v9 offset:864
s_waitcnt lgkmcnt(2)
s_waitcnt vmcnt(49)
v_mfma_f32_32x32x16_bf16 v[128:143], a[96:99], v[192:195], v[128:143]
ds_read_b128 v[208:211], v9 offset:448
s_add_u32 s3, s65, 4096
buffer_load_dwordx4 v[40:43], v7, s[12:15], s3 offen offset:2048 sc1
s_waitcnt vmcnt(48)
v_mfma_f32_32x32x16_bf16 v[128:143], a[100:103], v[196:199], v[128:143]
ds_read_b128 v[212:215], v9 offset:480
s_waitcnt lgkmcnt(2)
s_waitcnt vmcnt(46)
v_mfma_f32_32x32x16_bf16 v[128:143], a[104:107], v[200:203], v[128:143]
ds_read_b128 v[192:195], v9 offset:512
s_add_u32 s3, s65, 4096
buffer_load_dwordx4 v[44:47], v8, s[12:15], s3 offen offset:2048 sc1
s_waitcnt vmcnt(45)
v_mfma_f32_32x32x16_bf16 v[128:143], a[108:111], v[204:207], v[128:143]
ds_read_b128 v[196:199], v9 offset:544
s_waitcnt lgkmcnt(2)
v_mfma_f32_32x32x16_bf16 v[144:159], a[168:171], v[208:211], v[144:159]
ds_read_b128 v[200:203], v9 offset:576
s_waitcnt vmcnt(28)
s_mov_b64 exec, 1
buffer_store_dword v12, off, s[12:15], s83 sc1
s_mov_b64 exec, -1
s_add_u32 s3, s66, 4096
buffer_load_dwordx4 v[48:51], v7, s[12:15], s3 offen offset:0 sc1
v_mfma_f32_32x32x16_bf16 v[144:159], a[172:175], v[212:215], v[144:159]
ds_read_b128 v[204:207], v9 offset:608
v_exp_f32 v216, v128
v_exp_f32 v217, v129
v_exp_f32 v218, v130
s_waitcnt lgkmcnt(2)
v_mfma_f32_32x32x16_bf16 v[144:159], a[176:179], v[192:195], v[144:159]
ds_read_b128 v[208:211], v9 offset:640
s_add_u32 s3, s66, 4096
buffer_load_dwordx4 v[52:55], v8, s[12:15], s3 offen offset:0 sc1
v_exp_f32 v219, v131
v_mfma_f32_32x32x16_bf16 v[144:159], a[180:183], v[196:199], v[144:159]
ds_read_b128 v[212:215], v9 offset:672
v_exp_f32 v220, v132
v_exp_f32 v221, v133
v_exp_f32 v222, v134
s_waitcnt lgkmcnt(2)
v_mfma_f32_32x32x16_bf16 v[144:159], a[184:187], v[200:203], v[144:159]
ds_read_b128 v[192:195], v9 offset:704
v_exp_f32 v223, v135
v_add_f32 v216, 1.0, v216
v_add_f32 v217, 1.0, v217
v_mfma_f32_32x32x16_bf16 v[144:159], a[188:191], v[204:207], v[144:159]
ds_read_b128 v[196:199], v9 offset:736
v_add_f32 v218, 1.0, v218
v_add_f32 v219, 1.0, v219
v_add_f32 v220, 1.0, v220
v_add_f32 v221, 1.0, v221
v_add_f32 v222, 1.0, v222
s_waitcnt lgkmcnt(2)
v_mfma_f32_32x32x16_bf16 v[144:159], a[192:195], v[208:211], v[144:159]
ds_read_b128 v[200:203], v9 offset:768
v_add_f32 v223, 1.0, v223
v_rcp_f32 v216, v216
v_rcp_f32 v217, v217
v_mfma_f32_32x32x16_bf16 v[144:159], a[196:199], v[212:215], v[144:159]
ds_read_b128 v[204:207], v9 offset:800
v_rcp_f32 v218, v218
v_rcp_f32 v219, v219
v_rcp_f32 v220, v220
s_waitcnt lgkmcnt(2)
v_mfma_f32_32x32x16_bf16 v[144:159], a[200:203], v[192:195], v[144:159]
ds_read_b128 v[208:211], v9 offset:832
v_rcp_f32 v221, v221
v_rcp_f32 v222, v222
v_mfma_f32_32x32x16_bf16 v[144:159], a[204:207], v[196:199], v[144:159]
ds_read_b128 v[212:215], v9 offset:864
v_rcp_f32 v223, v223
v_mul_f32 v216, v216, v128
v_mul_f32 v217, v217, v129
v_mul_f32 v218, v218, v130
s_waitcnt lgkmcnt(2)
v_mfma_f32_32x32x16_bf16 v[144:159], a[208:211], v[200:203], v[144:159]
ds_read_b128 v[192:195], v9 offset:29184
v_mul_f32 v219, v219, v131
v_mul_f32 v220, v220, v132
v_mul_f32 v221, v221, v133
v_mul_f32 v222, v222, v134
v_mfma_f32_32x32x16_bf16 v[144:159], a[212:215], v[204:207], v[144:159]
ds_read_b128 v[196:199], v9 offset:29216
v_mul_f32 v223, v223, v135
v_cvt_pk_bf16_f32 v96, v216, v217
v_cvt_pk_bf16_f32 v97, v218, v219
v_cvt_pk_bf16_f32 v98, v220, v221
v_cvt_pk_bf16_f32 v99, v222, v223
s_waitcnt lgkmcnt(2)
v_mfma_f32_32x32x16_bf16 v[144:159], a[216:219], v[208:211], v[144:159]
ds_read_b128 v[200:203], v9 offset:29248
buffer_store_dwordx4 v[96:99], v2, s[12:15], s72 offen offset:0 sc1
v_exp_f32 v224, v136
v_exp_f32 v225, v137
v_mfma_f32_32x32x16_bf16 v[144:159], a[220:223], v[212:215], v[144:159]
ds_read_b128 v[204:207], v9 offset:29280
v_exp_f32 v226, v138
v_exp_f32 v227, v139
v_exp_f32 v228, v140
s_branch t0e_38
t0v_32:
s_waitcnt lgkmcnt(2)
v_mfma_f32_32x32x16_bf16 v[128:143], a[0:3], v[192:195], 0
buffer_load_dwordx4 a[224:227], v7, s[12:15], s64 offen offset:0 sc1
s_nop 3
v_mfma_f32_32x32x16_bf16 v[144:159], a[112:115], v[192:195], 0
ds_read_b128 v[208:211], v9 offset:128
v_cvt_pk_bf16_f32 v240, v88, v89
v_cvt_pk_bf16_f32 v241, v104, v105
v_cvt_pk_bf16_f32 v242, v120, v121
v_cvt_pk_bf16_f32 v243, v26, v27
v_mfma_f32_32x32x16_bf16 v[128:143], a[4:7], v[196:199], v[128:143]
buffer_load_dwordx4 a[228:231], v8, s[12:15], s64 offen offset:0 sc1
s_mov_b32 exec_hi, 0
s_mov_b32 exec_lo, 0xffff
ds_write_b128 v4, v[240:243] offset:0
s_mov_b64 exec, -1
v_mfma_f32_32x32x16_bf16 v[144:159], a[116:119], v[196:199], v[144:159]
ds_read_b128 v[212:215], v9 offset:160
v_cvt_pk_bf16_f32 v244, v42, v43
v_cvt_pk_bf16_f32 v245, v58, v59
v_cvt_pk_bf16_f32 v246, v74, v75
v_cvt_pk_bf16_f32 v247, v90, v91
s_waitcnt lgkmcnt(3)
v_mfma_f32_32x32x16_bf16 v[128:143], a[8:11], v[200:203], v[128:143]
buffer_load_dwordx4 a[232:235], v7, s[12:15], s64 offen offset:2048 sc1
v_mfma_f32_32x32x16_bf16 v[144:159], a[120:123], v[200:203], v[144:159]
ds_read_b128 v[192:195], v9 offset:192
s_mov_b32 exec_hi, 0
s_mov_b32 exec_lo, 0xffff
ds_write_b128 v4, v[244:247] offset:512
s_mov_b64 exec, -1
v_mfma_f32_32x32x16_bf16 v[128:143], a[12:15], v[204:207], v[128:143]
buffer_load_dwordx4 a[236:239], v8, s[12:15], s64 offen offset:2048 sc1
v_cvt_pk_bf16_f32 v240, v106, v107
v_cvt_pk_bf16_f32 v241, v122, v123
v_cvt_pk_bf16_f32 v242, v28, v29
v_cvt_pk_bf16_f32 v243, v44, v45
v_mfma_f32_32x32x16_bf16 v[144:159], a[124:127], v[204:207], v[144:159]
ds_read_b128 v[196:199], v9 offset:224
s_add_u32 s3, s64, 4096
buffer_load_dwordx4 a[240:243], v7, s[12:15], s3 offen offset:0 sc1
s_waitcnt lgkmcnt(3)
v_mfma_f32_32x32x16_bf16 v[128:143], a[16:19], v[208:211], v[128:143]
s_add_u32 s3, s64, 4096
buffer_load_dwordx4 a[244:247], v8, s[12:15], s3 offen offset:0 sc1
v_mfma_f32_32x32x16_bf16 v[144:159], a[128:131], v[208:211], v[144:159]
ds_read_b128 v[200:203], v9 offset:256
s_add_u32 s3, s64, 4096
buffer_load_dwordx4 a[248:251], v7, s[12:15], s3 offen offset:2048 sc1
v_mfma_f32_32x32x16_bf16 v[128:143], a[20:23], v[212:215], v[128:143]
s_add_u32 s3, s64, 4096
buffer_load_dwordx4 a[252:255], v8, s[12:15], s3 offen offset:2048 sc1
v_mfma_f32_32x32x16_bf16 v[144:159], a[132:135], v[212:215], v[144:159]
ds_read_b128 v[204:207], v9 offset:288
s_mov_b32 exec_hi, 0
s_mov_b32 exec_lo, 0xffff
ds_write_b128 v4, v[240:243] offset:1024
s_mov_b64 exec, -1
s_waitcnt lgkmcnt(3)
v_mfma_f32_32x32x16_bf16 v[128:143], a[24:27], v[192:195], v[128:143]
v_cvt_pk_bf16_f32 v244, v60, v61
v_cvt_pk_bf16_f32 v245, v76, v77
v_cvt_pk_bf16_f32 v246, v92, v93
v_cvt_pk_bf16_f32 v247, v108, v109
v_mfma_f32_32x32x16_bf16 v[144:159], a[136:139], v[192:195], v[144:159]
ds_read_b128 v[208:211], v9 offset:320
s_mov_b32 exec_hi, 0
s_mov_b32 exec_lo, 0xffff
ds_write_b128 v4, v[244:247] offset:1536
s_mov_b64 exec, -1
v_mfma_f32_32x32x16_bf16 v[128:143], a[28:31], v[196:199], v[128:143]
v_cvt_pk_bf16_f32 v240, v124, v125
v_cvt_pk_bf16_f32 v241, v30, v31
v_cvt_pk_bf16_f32 v242, v46, v47
v_cvt_pk_bf16_f32 v243, v62, v63
v_mfma_f32_32x32x16_bf16 v[144:159], a[140:143], v[196:199], v[144:159]
ds_read_b128 v[212:215], v9 offset:352
s_mov_b32 exec_hi, 0
s_mov_b32 exec_lo, 0xffff
ds_write_b128 v4, v[240:243] offset:2048
s_mov_b64 exec, -1
s_waitcnt lgkmcnt(5)
v_mfma_f32_32x32x16_bf16 v[128:143], a[32:35], v[200:203], v[128:143]
v_cvt_pk_bf16_f32 v244, v78, v79
v_cvt_pk_bf16_f32 v245, v94, v95
v_cvt_pk_bf16_f32 v246, v110, v111
v_cvt_pk_bf16_f32 v247, v126, v127
v_mfma_f32_32x32x16_bf16 v[144:159], a[144:147], v[200:203], v[144:159]
ds_read_b128 v[192:195], v9 offset:384
s_mov_b32 exec_hi, 0
s_mov_b32 exec_lo, 0xffff
ds_write_b128 v4, v[244:247] offset:2560
s_mov_b64 exec, -1
v_mfma_f32_32x32x16_bf16 v[128:143], a[36:39], v[204:207], v[128:143]
v_cvt_pk_bf16_f32 v240, v16, v17
v_cvt_pk_bf16_f32 v241, v32, v33
v_cvt_pk_bf16_f32 v242, v48, v49
v_cvt_pk_bf16_f32 v243, v64, v65
v_mfma_f32_32x32x16_bf16 v[144:159], a[148:151], v[204:207], v[144:159]
ds_read_b128 v[196:199], v9 offset:416
s_mov_b32 exec_hi, 0
s_mov_b32 exec_lo, 0xffff0000
ds_write_b128 v4, v[240:243] offset:3072
s_mov_b64 exec, -1
s_waitcnt lgkmcnt(5)
v_mfma_f32_32x32x16_bf16 v[128:143], a[40:43], v[208:211], v[128:143]
v_cvt_pk_bf16_f32 v244, v80, v81
v_cvt_pk_bf16_f32 v245, v96, v97
v_cvt_pk_bf16_f32 v246, v112, v113
v_cvt_pk_bf16_f32 v247, v18, v19
v_mfma_f32_32x32x16_bf16 v[144:159], a[152:155], v[208:211], v[144:159]
ds_read_b128 v[200:203], v9 offset:448
s_mov_b32 exec_hi, 0
s_mov_b32 exec_lo, 0xffff0000
ds_write_b128 v4, v[244:247] offset:3584
s_mov_b64 exec, -1
v_mfma_f32_32x32x16_bf16 v[128:143], a[44:47], v[212:215], v[128:143]
v_mfma_f32_32x32x16_bf16 v[144:159], a[156:159], v[212:215], v[144:159]
ds_read_b128 v[204:207], v9 offset:480
s_waitcnt lgkmcnt(4)
v_mfma_f32_32x32x16_bf16 v[128:143], a[48:51], v[192:195], v[128:143]
v_mfma_f32_32x32x16_bf16 v[144:159], a[160:163], v[192:195], v[144:159]
ds_read_b128 v[208:211], v9 offset:512
v_mfma_f32_32x32x16_bf16 v[128:143], a[52:55], v[196:199], v[128:143]
buffer_load_dwordx4 v[16:19], v7, s[12:15], s70 offen offset:0 sc1
v_mfma_f32_32x32x16_bf16 v[144:159], a[164:167], v[196:199], v[144:159]
ds_read_b128 v[212:215], v9 offset:544
s_waitcnt lgkmcnt(2)
v_mfma_f32_32x32x16_bf16 v[128:143], a[56:59], v[200:203], v[128:143]
ds_read_b128 v[192:195], v9 offset:576
buffer_load_dwordx4 v[20:23], v8, s[12:15], s70 offen offset:0 sc1
v_mfma_f32_32x32x16_bf16 v[128:143], a[60:63], v[204:207], v[128:143]
ds_read_b128 v[196:199], v9 offset:608
s_waitcnt lgkmcnt(2)
v_mfma_f32_32x32x16_bf16 v[128:143], a[64:67], v[208:211], v[128:143]
ds_read_b128 v[200:203], v9 offset:640
buffer_load_dwordx4 v[24:27], v7, s[12:15], s70 offen offset:2048 sc1
v_mfma_f32_32x32x16_bf16 v[128:143], a[68:71], v[212:215], v[128:143]
ds_read_b128 v[204:207], v9 offset:672
s_waitcnt lgkmcnt(2)
v_mfma_f32_32x32x16_bf16 v[128:143], a[72:75], v[192:195], v[128:143]
ds_read_b128 v[208:211], v9 offset:704
buffer_load_dwordx4 v[28:31], v8, s[12:15], s70 offen offset:2048 sc1
s_waitcnt vmcnt(57)
v_mfma_f32_32x32x16_bf16 v[128:143], a[76:79], v[196:199], v[128:143]
ds_read_b128 v[212:215], v9 offset:736
s_waitcnt lgkmcnt(2)
s_waitcnt vmcnt(55)
v_mfma_f32_32x32x16_bf16 v[128:143], a[80:83], v[200:203], v[128:143]
ds_read_b128 v[192:195], v9 offset:768
s_add_u32 s3, s65, 4096
buffer_load_dwordx4 v[32:35], v7, s[12:15], s3 offen offset:0 sc1
s_waitcnt vmcnt(54)
v_mfma_f32_32x32x16_bf16 v[128:143], a[84:87], v[204:207], v[128:143]
ds_read_b128 v[196:199], v9 offset:800
s_waitcnt lgkmcnt(2)
s_waitcnt vmcnt(52)
v_mfma_f32_32x32x16_bf16 v[128:143], a[88:91], v[208:211], v[128:143]
ds_read_b128 v[200:203], v9 offset:832
s_add_u32 s3, s65, 4096
buffer_load_dwordx4 v[36:39], v8, s[12:15], s3 offen offset:0 sc1
s_waitcnt vmcnt(51)
v_mfma_f32_32x32x16_bf16 v[128:143], a[92:95], v[212:215], v[128:143]
ds_read_b128 v[204:207], v9 offset:864
s_waitcnt lgkmcnt(2)
s_waitcnt vmcnt(49)
v_mfma_f32_32x32x16_bf16 v[128:143], a[96:99], v[192:195], v[128:143]
ds_read_b128 v[208:211], v9 offset:448
s_add_u32 s3, s65, 4096
buffer_load_dwordx4 v[40:43], v7, s[12:15], s3 offen offset:2048 sc1
s_waitcnt vmcnt(48)
v_mfma_f32_32x32x16_bf16 v[128:143], a[100:103], v[196:199], v[128:143]
ds_read_b128 v[212:215], v9 offset:480
s_waitcnt lgkmcnt(2)
s_waitcnt vmcnt(46)
v_mfma_f32_32x32x16_bf16 v[128:143], a[104:107], v[200:203], v[128:143]
ds_read_b128 v[192:195], v9 offset:512
s_add_u32 s3, s65, 4096
buffer_load_dwordx4 v[44:47], v8, s[12:15], s3 offen offset:2048 sc1
s_waitcnt vmcnt(45)
v_mfma_f32_32x32x16_bf16 v[128:143], a[108:111], v[204:207], v[128:143]
ds_read_b128 v[196:199], v9 offset:544
s_waitcnt lgkmcnt(2)
v_mfma_f32_32x32x16_bf16 v[144:159], a[168:171], v[208:211], v[144:159]
ds_read_b128 v[200:203], v9 offset:576
s_waitcnt vmcnt(28)
s_mov_b64 exec, 1
buffer_store_dword v12, off, s[12:15], s83 sc1
s_mov_b64 exec, -1
s_add_u32 s3, s66, 4096
buffer_load_dwordx4 v[48:51], v7, s[12:15], s3 offen offset:0 sc1
v_mfma_f32_32x32x16_bf16 v[144:159], a[172:175], v[212:215], v[144:159]
ds_read_b128 v[204:207], v9 offset:608
v_exp_f32 v216, v128
v_exp_f32 v217, v129
v_exp_f32 v218, v130
s_waitcnt lgkmcnt(2)
v_mfma_f32_32x32x16_bf16 v[144:159], a[176:179], v[192:195], v[144:159]
ds_read_b128 v[208:211], v9 offset:640
s_add_u32 s3, s66, 4096
buffer_load_dwordx4 v[52:55], v8, s[12:15], s3 offen offset:0 sc1
v_exp_f32 v219, v131
v_mfma_f32_32x32x16_bf16 v[144:159], a[180:183], v[196:199], v[144:159]
ds_read_b128 v[212:215], v9 offset:672
v_exp_f32 v220, v132
v_exp_f32 v221, v133
v_exp_f32 v222, v134
s_waitcnt lgkmcnt(2)
v_mfma_f32_32x32x16_bf16 v[144:159], a[184:187], v[200:203], v[144:159]
ds_read_b128 v[192:195], v9 offset:704
v_exp_f32 v223, v135
v_add_f32 v216, 1.0, v216
v_add_f32 v217, 1.0, v217
v_mfma_f32_32x32x16_bf16 v[144:159], a[188:191], v[204:207], v[144:159]
ds_read_b128 v[196:199], v9 offset:736
v_add_f32 v218, 1.0, v218
v_add_f32 v219, 1.0, v219
v_add_f32 v220, 1.0, v220
v_add_f32 v221, 1.0, v221
v_add_f32 v222, 1.0, v222
s_waitcnt lgkmcnt(2)
v_mfma_f32_32x32x16_bf16 v[144:159], a[192:195], v[208:211], v[144:159]
ds_read_b128 v[200:203], v9 offset:768
v_add_f32 v223, 1.0, v223
v_rcp_f32 v216, v216
v_rcp_f32 v217, v217
v_mfma_f32_32x32x16_bf16 v[144:159], a[196:199], v[212:215], v[144:159]
ds_read_b128 v[204:207], v9 offset:800
v_rcp_f32 v218, v218
v_rcp_f32 v219, v219
v_rcp_f32 v220, v220
s_waitcnt lgkmcnt(2)
v_mfma_f32_32x32x16_bf16 v[144:159], a[200:203], v[192:195], v[144:159]
ds_read_b128 v[208:211], v9 offset:832
v_rcp_f32 v221, v221
v_rcp_f32 v222, v222
v_mfma_f32_32x32x16_bf16 v[144:159], a[204:207], v[196:199], v[144:159]
ds_read_b128 v[212:215], v9 offset:864
v_rcp_f32 v223, v223
v_mul_f32 v216, v216, v128
v_mul_f32 v217, v217, v129
v_mul_f32 v218, v218, v130
s_waitcnt lgkmcnt(2)
v_mfma_f32_32x32x16_bf16 v[144:159], a[208:211], v[200:203], v[144:159]
ds_read_b128 v[192:195], v9 offset:29184
v_mul_f32 v219, v219, v131
v_mul_f32 v220, v220, v132
v_mul_f32 v221, v221, v133
v_mul_f32 v222, v222, v134
v_mfma_f32_32x32x16_bf16 v[144:159], a[212:215], v[204:207], v[144:159]
ds_read_b128 v[196:199], v9 offset:29216
v_mul_f32 v223, v223, v135
v_cvt_pk_bf16_f32 v96, v216, v217
v_cvt_pk_bf16_f32 v97, v218, v219
v_cvt_pk_bf16_f32 v98, v220, v221
v_cvt_pk_bf16_f32 v99, v222, v223
s_waitcnt lgkmcnt(2)
v_mfma_f32_32x32x16_bf16 v[144:159], a[216:219], v[208:211], v[144:159]
ds_read_b128 v[200:203], v9 offset:29248
buffer_store_dwordx4 v[96:99], v2, s[12:15], s72 offen offset:0 sc1
v_exp_f32 v224, v136
v_exp_f32 v225, v137
v_mfma_f32_32x32x16_bf16 v[144:159], a[220:223], v[212:215], v[144:159]
ds_read_b128 v[204:207], v9 offset:29280
v_exp_f32 v226, v138
v_exp_f32 v227, v139
v_exp_f32 v228, v140
s_branch t0e_38
t0v_33:
s_waitcnt lgkmcnt(2)
v_mfma_f32_32x32x16_bf16 v[128:143], a[0:3], v[192:195], 0
buffer_load_dwordx4 a[224:227], v7, s[12:15], s64 offen offset:0 sc1
s_nop 3
v_mfma_f32_32x32x16_bf16 v[144:159], a[112:115], v[192:195], 0
ds_read_b128 v[208:211], v9 offset:128
v_cvt_pk_bf16_f32 v240, v34, v35
v_cvt_pk_bf16_f32 v241, v50, v51
v_cvt_pk_bf16_f32 v242, v66, v67
v_cvt_pk_bf16_f32 v243, v82, v83
v_mfma_f32_32x32x16_bf16 v[128:143], a[4:7], v[196:199], v[128:143]
buffer_load_dwordx4 a[228:231], v8, s[12:15], s64 offen offset:0 sc1
s_mov_b32 exec_hi, 0
s_mov_b32 exec_lo, 0xffff0000
ds_write_b128 v4, v[240:243] offset:0
s_mov_b64 exec, -1
v_mfma_f32_32x32x16_bf16 v[144:159], a[116:119], v[196:199], v[144:159]
ds_read_b128 v[212:215], v9 offset:160
v_cvt_pk_bf16_f32 v244, v98, v99
v_cvt_pk_bf16_f32 v245, v114, v115
v_cvt_pk_bf16_f32 v246, v20, v21
v_cvt_pk_bf16_f32 v247, v36, v37
s_waitcnt lgkmcnt(3)
v_mfma_f32_32x32x16_bf16 v[128:143], a[8:11], v[200:203], v[128:143]
buffer_load_dwordx4 a[232:235], v7, s[12:15], s64 offen offset:2048 sc1
v_mfma_f32_32x32x16_bf16 v[144:159], a[120:123], v[200:203], v[144:159]
ds_read_b128 v[192:195], v9 offset:192
s_mov_b32 exec_hi, 0
s_mov_b32 exec_lo, 0xffff0000
ds_write_b128 v4, v[244:247] offset:512
s_mov_b64 exec, -1
v_mfma_f32_32x32x16_bf16 v[128:143], a[12:15], v[204:207], v[128:143]
buffer_load_dwordx4 a[236:239], v8, s[12:15], s64 offen offset:2048 sc1
v_cvt_pk_bf16_f32 v240, v52, v53
v_cvt_pk_bf16_f32 v241, v68, v69
v_cvt_pk_bf16_f32 v242, v84, v85
v_cvt_pk_bf16_f32 v243, v100, v101
v_mfma_f32_32x32x16_bf16 v[144:159], a[124:127], v[204:207], v[144:159]
ds_read_b128 v[196:199], v9 offset:224
s_add_u32 s3, s64, 4096
buffer_load_dwordx4 a[240:243], v7, s[12:15], s3 offen offset:0 sc1
s_waitcnt lgkmcnt(3)
v_mfma_f32_32x32x16_bf16 v[128:143], a[16:19], v[208:211], v[128:143]
s_add_u32 s3, s64, 4096
buffer_load_dwordx4 a[244:247], v8, s[12:15], s3 offen offset:0 sc1
v_mfma_f32_32x32x16_bf16 v[144:159], a[128:131], v[208:211], v[144:159]
ds_read_b128 v[200:203], v9 offset:256
s_add_u32 s3, s64, 4096
buffer_load_dwordx4 a[248:251], v7, s[12:15], s3 offen offset:2048 sc1
v_mfma_f32_32x32x16_bf16 v[128:143], a[20:23], v[212:215], v[128:143]
s_add_u32 s3, s64, 4096
buffer_load_dwordx4 a[252:255], v8, s[12:15], s3 offen offset:2048 sc1
v_mfma_f32_32x32x16_bf16 v[144:159], a[132:135], v[212:215], v[144:159]
ds_read_b128 v[204:207], v9 offset:288
s_mov_b32 exec_hi, 0
s_mov_b32 exec_lo, 0xffff0000
ds_write_b128 v4, v[240:243] offset:1024
s_mov_b64 exec, -1
s_waitcnt lgkmcnt(3)
v_mfma_f32_32x32x16_bf16 v[128:143], a[24:27], v[192:195], v[128:143]
v_cvt_pk_bf16_f32 v244, v116, v117
v_cvt_pk_bf16_f32 v245, v22, v23
v_cvt_pk_bf16_f32 v246, v38, v39
v_cvt_pk_bf16_f32 v247, v54, v55
v_mfma_f32_32x32x16_bf16 v[144:159], a[136:139], v[192:195], v[144:159]
ds_read_b128 v[208:211], v9 offset:320
s_mov_b32 exec_hi, 0
s_mov_b32 exec_lo, 0xffff0000
ds_write_b128 v4, v[244:247] offset:1536
s_mov_b64 exec, -1
v_mfma_f32_32x32x16_bf16 v[128:143], a[28:31], v[196:199], v[128:143]
v_cvt_pk_bf16_f32 v240, v70, v71
v_cvt_pk_bf16_f32 v241, v86, v87
v_cvt_pk_bf16_f32 v242, v102, v103
v_cvt_pk_bf16_f32 v243, v118, v119
v_mfma_f32_32x32x16_bf16 v[144:159], a[140:143], v[196:199], v[144:159]
ds_read_b128 v[212:215], v9 offset:352
s_mov_b32 exec_hi, 0
s_mov_b32 exec_lo, 0xffff0000
ds_write_b128 v4, v[240:243] offset:2048
s_mov_b64 exec, -1
s_waitcnt lgkmcnt(5)
v_mfma_f32_32x32x16_bf16 v[128:143], a[32:35], v[200:203], v[128:143]
v_cvt_pk_bf16_f32 v244, v24, v25
v_cvt_pk_bf16_f32 v245, v40, v41
v_cvt_pk_bf16_f32 v246, v56, v57
v_cvt_pk_bf16_f32 v247, v72, v73
v_mfma_f32_32x32x16_bf16 v[144:159], a[144:147], v[200:203], v[144:159]
ds_read_b128 v[192:195], v9 offset:384
s_mov_b32 exec_hi, 0
s_mov_b32 exec_lo, 0xffff0000
ds_write_b128 v4, v[244:247] offset:2560
s_mov_b64 exec, -1
v_mfma_f32_32x32x16_bf16 v[128:143], a[36:39], v[204:207], v[128:143]
v_cvt_pk_bf16_f32 v240, v88, v89
v_cvt_pk_bf16_f32 v241, v104, v105
v_cvt_pk_bf16_f32 v242, v120, v121
v_cvt_pk_bf16_f32 v243, v26, v27
v_mfma_f32_32x32x16_bf16 v[144:159], a[148:151], v[204:207], v[144:159]
ds_read_b128 v[196:199], v9 offset:416
s_mov_b32 exec_hi, 0
s_mov_b32 exec_lo, 0xffff0000
ds_write_b128 v4, v[240:243] offset:3072
s_mov_b64 exec, -1
s_waitcnt lgkmcnt(5)
v_mfma_f32_32x32x16_bf16 v[128:143], a[40:43], v[208:211], v[128:143]
v_cvt_pk_bf16_f32 v244, v42, v43
v_cvt_pk_bf16_f32 v245, v58, v59
v_cvt_pk_bf16_f32 v246, v74, v75
v_cvt_pk_bf16_f32 v247, v90, v91
v_mfma_f32_32x32x16_bf16 v[144:159], a[152:155], v[208:211], v[144:159]
ds_read_b128 v[200:203], v9 offset:448
s_mov_b32 exec_hi, 0
s_mov_b32 exec_lo, 0xffff0000
ds_write_b128 v4, v[244:247] offset:3584
s_mov_b64 exec, -1
v_mfma_f32_32x32x16_bf16 v[128:143], a[44:47], v[212:215], v[128:143]
v_mfma_f32_32x32x16_bf16 v[144:159], a[156:159], v[212:215], v[144:159]
ds_read_b128 v[204:207], v9 offset:480
s_waitcnt lgkmcnt(4)
v_mfma_f32_32x32x16_bf16 v[128:143], a[48:51], v[192:195], v[128:143]
v_mfma_f32_32x32x16_bf16 v[144:159], a[160:163], v[192:195], v[144:159]
ds_read_b128 v[208:211], v9 offset:512
v_mfma_f32_32x32x16_bf16 v[128:143], a[52:55], v[196:199], v[128:143]
buffer_load_dwordx4 v[16:19], v7, s[12:15], s70 offen offset:0 sc1
v_mfma_f32_32x32x16_bf16 v[144:159], a[164:167], v[196:199], v[144:159]
ds_read_b128 v[212:215], v9 offset:544
s_waitcnt lgkmcnt(2)
v_mfma_f32_32x32x16_bf16 v[128:143], a[56:59], v[200:203], v[128:143]
ds_read_b128 v[192:195], v9 offset:576
buffer_load_dwordx4 v[20:23], v8, s[12:15], s70 offen offset:0 sc1
v_mfma_f32_32x32x16_bf16 v[128:143], a[60:63], v[204:207], v[128:143]
ds_read_b128 v[196:199], v9 offset:608
s_waitcnt lgkmcnt(2)
v_mfma_f32_32x32x16_bf16 v[128:143], a[64:67], v[208:211], v[128:143]
ds_read_b128 v[200:203], v9 offset:640
buffer_load_dwordx4 v[24:27], v7, s[12:15], s70 offen offset:2048 sc1
v_mfma_f32_32x32x16_bf16 v[128:143], a[68:71], v[212:215], v[128:143]
ds_read_b128 v[204:207], v9 offset:672
s_waitcnt lgkmcnt(2)
v_mfma_f32_32x32x16_bf16 v[128:143], a[72:75], v[192:195], v[128:143]
ds_read_b128 v[208:211], v9 offset:704
buffer_load_dwordx4 v[28:31], v8, s[12:15], s70 offen offset:2048 sc1
s_waitcnt vmcnt(57)
v_mfma_f32_32x32x16_bf16 v[128:143], a[76:79], v[196:199], v[128:143]
ds_read_b128 v[212:215], v9 offset:736
s_waitcnt lgkmcnt(2)
s_waitcnt vmcnt(55)
v_mfma_f32_32x32x16_bf16 v[128:143], a[80:83], v[200:203], v[128:143]
ds_read_b128 v[192:195], v9 offset:768
s_add_u32 s3, s65, 4096
buffer_load_dwordx4 v[32:35], v7, s[12:15], s3 offen offset:0 sc1
s_waitcnt vmcnt(54)
v_mfma_f32_32x32x16_bf16 v[128:143], a[84:87], v[204:207], v[128:143]
ds_read_b128 v[196:199], v9 offset:800
s_waitcnt lgkmcnt(2)
s_waitcnt vmcnt(52)
v_mfma_f32_32x32x16_bf16 v[128:143], a[88:91], v[208:211], v[128:143]
ds_read_b128 v[200:203], v9 offset:832
s_add_u32 s3, s65, 4096
buffer_load_dwordx4 v[36:39], v8, s[12:15], s3 offen offset:0 sc1
s_waitcnt vmcnt(51)
v_mfma_f32_32x32x16_bf16 v[128:143], a[92:95], v[212:215], v[128:143]
ds_read_b128 v[204:207], v9 offset:864
s_waitcnt lgkmcnt(2)
s_waitcnt vmcnt(49)
v_mfma_f32_32x32x16_bf16 v[128:143], a[96:99], v[192:195], v[128:143]
ds_read_b128 v[208:211], v9 offset:448
s_add_u32 s3, s65, 4096
buffer_load_dwordx4 v[40:43], v7, s[12:15], s3 offen offset:2048 sc1
s_waitcnt vmcnt(48)
v_mfma_f32_32x32x16_bf16 v[128:143], a[100:103], v[196:199], v[128:143]
ds_read_b128 v[212:215], v9 offset:480
s_waitcnt lgkmcnt(2)
s_waitcnt vmcnt(46)
v_mfma_f32_32x32x16_bf16 v[128:143], a[104:107], v[200:203], v[128:143]
ds_read_b128 v[192:195], v9 offset:512
s_add_u32 s3, s65, 4096
buffer_load_dwordx4 v[44:47], v8, s[12:15], s3 offen offset:2048 sc1
s_waitcnt vmcnt(45)
v_mfma_f32_32x32x16_bf16 v[128:143], a[108:111], v[204:207], v[128:143]
ds_read_b128 v[196:199], v9 offset:544
s_waitcnt lgkmcnt(2)
v_mfma_f32_32x32x16_bf16 v[144:159], a[168:171], v[208:211], v[144:159]
ds_read_b128 v[200:203], v9 offset:576
s_waitcnt vmcnt(28)
s_mov_b64 exec, 1
buffer_store_dword v12, off, s[12:15], s83 sc1
s_mov_b64 exec, -1
s_add_u32 s3, s66, 4096
buffer_load_dwordx4 v[48:51], v7, s[12:15], s3 offen offset:0 sc1
v_mfma_f32_32x32x16_bf16 v[144:159], a[172:175], v[212:215], v[144:159]
ds_read_b128 v[204:207], v9 offset:608
v_exp_f32 v216, v128
v_exp_f32 v217, v129
v_exp_f32 v218, v130
s_waitcnt lgkmcnt(2)
v_mfma_f32_32x32x16_bf16 v[144:159], a[176:179], v[192:195], v[144:159]
ds_read_b128 v[208:211], v9 offset:640
s_add_u32 s3, s66, 4096
buffer_load_dwordx4 v[52:55], v8, s[12:15], s3 offen offset:0 sc1
v_exp_f32 v219, v131
v_mfma_f32_32x32x16_bf16 v[144:159], a[180:183], v[196:199], v[144:159]
ds_read_b128 v[212:215], v9 offset:672
v_exp_f32 v220, v132
v_exp_f32 v221, v133
v_exp_f32 v222, v134
s_waitcnt lgkmcnt(2)
v_mfma_f32_32x32x16_bf16 v[144:159], a[184:187], v[200:203], v[144:159]
ds_read_b128 v[192:195], v9 offset:704
v_exp_f32 v223, v135
v_add_f32 v216, 1.0, v216
v_add_f32 v217, 1.0, v217
v_mfma_f32_32x32x16_bf16 v[144:159], a[188:191], v[204:207], v[144:159]
ds_read_b128 v[196:199], v9 offset:736
v_add_f32 v218, 1.0, v218
v_add_f32 v219, 1.0, v219
v_add_f32 v220, 1.0, v220
v_add_f32 v221, 1.0, v221
v_add_f32 v222, 1.0, v222
s_waitcnt lgkmcnt(2)
v_mfma_f32_32x32x16_bf16 v[144:159], a[192:195], v[208:211], v[144:159]
ds_read_b128 v[200:203], v9 offset:768
v_add_f32 v223, 1.0, v223
v_rcp_f32 v216, v216
v_rcp_f32 v217, v217
v_mfma_f32_32x32x16_bf16 v[144:159], a[196:199], v[212:215], v[144:159]
ds_read_b128 v[204:207], v9 offset:800
v_rcp_f32 v218, v218
v_rcp_f32 v219, v219
v_rcp_f32 v220, v220
s_waitcnt lgkmcnt(2)
v_mfma_f32_32x32x16_bf16 v[144:159], a[200:203], v[192:195], v[144:159]
ds_read_b128 v[208:211], v9 offset:832
v_rcp_f32 v221, v221
v_rcp_f32 v222, v222
v_mfma_f32_32x32x16_bf16 v[144:159], a[204:207], v[196:199], v[144:159]
ds_read_b128 v[212:215], v9 offset:864
v_rcp_f32 v223, v223
v_mul_f32 v216, v216, v128
v_mul_f32 v217, v217, v129
v_mul_f32 v218, v218, v130
s_waitcnt lgkmcnt(2)
v_mfma_f32_32x32x16_bf16 v[144:159], a[208:211], v[200:203], v[144:159]
ds_read_b128 v[192:195], v9 offset:29184
v_mul_f32 v219, v219, v131
v_mul_f32 v220, v220, v132
v_mul_f32 v221, v221, v133
v_mul_f32 v222, v222, v134
v_mfma_f32_32x32x16_bf16 v[144:159], a[212:215], v[204:207], v[144:159]
ds_read_b128 v[196:199], v9 offset:29216
v_mul_f32 v223, v223, v135
v_cvt_pk_bf16_f32 v96, v216, v217
v_cvt_pk_bf16_f32 v97, v218, v219
v_cvt_pk_bf16_f32 v98, v220, v221
v_cvt_pk_bf16_f32 v99, v222, v223
s_waitcnt lgkmcnt(2)
v_mfma_f32_32x32x16_bf16 v[144:159], a[216:219], v[208:211], v[144:159]
ds_read_b128 v[200:203], v9 offset:29248
buffer_store_dwordx4 v[96:99], v2, s[12:15], s72 offen offset:0 sc1
v_exp_f32 v224, v136
v_exp_f32 v225, v137
v_mfma_f32_32x32x16_bf16 v[144:159], a[220:223], v[212:215], v[144:159]
ds_read_b128 v[204:207], v9 offset:29280
v_exp_f32 v226, v138
v_exp_f32 v227, v139
v_exp_f32 v228, v140
s_branch t0e_38
t0v_34:
s_waitcnt lgkmcnt(2)
v_mfma_f32_32x32x16_bf16 v[128:143], a[0:3], v[192:195], 0
buffer_load_dwordx4 a[224:227], v7, s[12:15], s64 offen offset:0 sc1
s_nop 3
v_mfma_f32_32x32x16_bf16 v[144:159], a[112:115], v[192:195], 0
ds_read_b128 v[208:211], v9 offset:128
v_cvt_pk_bf16_f32 v240, v106, v107
v_cvt_pk_bf16_f32 v241, v122, v123
v_cvt_pk_bf16_f32 v242, v28, v29
v_cvt_pk_bf16_f32 v243, v44, v45
v_mfma_f32_32x32x16_bf16 v[128:143], a[4:7], v[196:199], v[128:143]
buffer_load_dwordx4 a[228:231], v8, s[12:15], s64 offen offset:0 sc1
s_mov_b32 exec_hi, 0
s_mov_b32 exec_lo, 0xffff0000
ds_write_b128 v4, v[240:243] offset:0
s_mov_b64 exec, -1
v_mfma_f32_32x32x16_bf16 v[144:159], a[116:119], v[196:199], v[144:159]
ds_read_b128 v[212:215], v9 offset:160
v_cvt_pk_bf16_f32 v244, v60, v61
v_cvt_pk_bf16_f32 v245, v76, v77
v_cvt_pk_bf16_f32 v246, v92, v93
v_cvt_pk_bf16_f32 v247, v108, v109
s_waitcnt lgkmcnt(3)
v_mfma_f32_32x32x16_bf16 v[128:143], a[8:11], v[200:203], v[128:143]
buffer_load_dwordx4 a[232:235], v7, s[12:15], s64 offen offset:2048 sc1
v_mfma_f32_32x32x16_bf16 v[144:159], a[120:123], v[200:203], v[144:159]
ds_read_b128 v[192:195], v9 offset:192
s_mov_b32 exec_hi, 0
s_mov_b32 exec_lo, 0xffff0000
ds_write_b128 v4, v[244:247] offset:512
s_mov_b64 exec, -1
v_mfma_f32_32x32x16_bf16 v[128:143], a[12:15], v[204:207], v[128:143]
buffer_load_dwordx4 a[236:239], v8, s[12:15], s64 offen offset:2048 sc1
v_cvt_pk_bf16_f32 v240, v124, v125
v_cvt_pk_bf16_f32 v241, v30, v31
v_cvt_pk_bf16_f32 v242, v46, v47
v_cvt_pk_bf16_f32 v243, v62, v63
v_mfma_f32_32x32x16_bf16 v[144:159], a[124:127], v[204:207], v[144:159]
ds_read_b128 v[196:199], v9 offset:224
s_add_u32 s3, s64, 4096
buffer_load_dwordx4 a[240:243], v7, s[12:15], s3 offen offset:0 sc1
s_waitcnt lgkmcnt(3)
v_mfma_f32_32x32x16_bf16 v[128:143], a[16:19], v[208:211], v[128:143]
s_add_u32 s3, s64, 4096
buffer_load_dwordx4 a[244:247], v8, s[12:15], s3 offen offset:0 sc1
v_mfma_f32_32x32x16_bf16 v[144:159], a[128:131], v[208:211], v[144:159]
ds_read_b128 v[200:203], v9 offset:256
s_add_u32 s3, s64, 4096
buffer_load_dwordx4 a[248:251], v7, s[12:15], s3 offen offset:2048 sc1
v_mfma_f32_32x32x16_bf16 v[128:143], a[20:23], v[212:215], v[128:143]
s_add_u32 s3, s64, 4096
buffer_load_dwordx4 a[252:255], v8, s[12:15], s3 offen offset:2048 sc1
v_mfma_f32_32x32x16_bf16 v[144:159], a[132:135], v[212:215], v[144:159]
ds_read_b128 v[204:207], v9 offset:288
s_mov_b32 exec_hi, 0
s_mov_b32 exec_lo, 0xffff0000
ds_write_b128 v4, v[240:243] offset:1024
s_mov_b64 exec, -1
s_waitcnt lgkmcnt(3)
v_mfma_f32_32x32x16_bf16 v[128:143], a[24:27], v[192:195], v[128:143]
v_cvt_pk_bf16_f32 v244, v78, v79
v_cvt_pk_bf16_f32 v245, v94, v95
v_cvt_pk_bf16_f32 v246, v110, v111
v_cvt_pk_bf16_f32 v247, v126, v127
v_mfma_f32_32x32x16_bf16 v[144:159], a[136:139], v[192:195], v[144:159]
ds_read_b128 v[208:211], v9 offset:320
s_mov_b32 exec_hi, 0
s_mov_b32 exec_lo, 0xffff0000
ds_write_b128 v4, v[244:247] offset:1536
s_mov_b64 exec, -1
v_mfma_f32_32x32x16_bf16 v[128:143], a[28:31], v[196:199], v[128:143]
v_cvt_pk_bf16_f32 v240, v16, v17
v_cvt_pk_bf16_f32 v241, v32, v33
v_cvt_pk_bf16_f32 v242, v48, v49
v_cvt_pk_bf16_f32 v243, v64, v65
v_mfma_f32_32x32x16_bf16 v[144:159], a[140:143], v[196:199], v[144:159]
ds_read_b128 v[212:215], v9 offset:352
s_mov_b32 exec_lo, 0
s_mov_b32 exec_hi, 0xffff
ds_write_b128 v4, v[240:243] offset:2048
s_mov_b64 exec, -1
s_waitcnt lgkmcnt(5)
v_mfma_f32_32x32x16_bf16 v[128:143], a[32:35], v[200:203], v[128:143]
v_cvt_pk_bf16_f32 v244, v80, v81
v_cvt_pk_bf16_f32 v245, v96, v97
v_cvt_pk_bf16_f32 v246, v112, v113
v_cvt_pk_bf16_f32 v247, v18, v19
v_mfma_f32_32x32x16_bf16 v[144:159], a[144:147], v[200:203], v[144:159]
ds_read_b128 v[192:195], v9 offset:384
s_mov_b32 exec_lo, 0
s_mov_b32 exec_hi, 0xffff
ds_write_b128 v4, v[244:247] offset:2560
s_mov_b64 exec, -1
v_mfma_f32_32x32x16_bf16 v[128:143], a[36:39], v[204:207], v[128:143]
v_cvt_pk_bf16_f32 v240, v34, v35
v_cvt_pk_bf16_f32 v241, v50, v51
v_cvt_pk_bf16_f32 v242, v66, v67
v_cvt_pk_bf16_f32 v243, v82, v83
v_mfma_f32_32x32x16_bf16 v[144:159], a[148:151], v[204:207], v[144:159]
ds_read_b128 v[196:199], v9 offset:416
s_mov_b32 exec_lo, 0
s_mov_b32 exec_hi, 0xffff
ds_write_b128 v4, v[240:243] offset:3072
s_mov_b64 exec, -1
s_waitcnt lgkmcnt(5)
v_mfma_f32_32x32x16_bf16 v[128:143], a[40:43], v[208:211], v[128:143]
v_cvt_pk_bf16_f32 v244, v98, v99
v_cvt_pk_bf16_f32 v245, v114, v115
v_cvt_pk_bf16_f32 v246, v20, v21
v_cvt_pk_bf16_f32 v247, v36, v37
v_mfma_f32_32x32x16_bf16 v[144:159], a[152:155], v[208:211], v[144:159]
ds_read_b128 v[200:203], v9 offset:448
s_mov_b32 exec_lo, 0
s_mov_b32 exec_hi, 0xffff
ds_write_b128 v4, v[244:247] offset:3584
s_mov_b64 exec, -1
v_mfma_f32_32x32x16_bf16 v[128:143], a[44:47], v[212:215], v[128:143]
v_mfma_f32_32x32x16_bf16 v[144:159], a[156:159], v[212:215], v[144:159]
ds_read_b128 v[204:207], v9 offset:480
s_waitcnt lgkmcnt(4)
v_mfma_f32_32x32x16_bf16 v[128:143], a[48:51], v[192:195], v[128:143]
v_mfma_f32_32x32x16_bf16 v[144:159], a[160:163], v[192:195], v[144:159]
ds_read_b128 v[208:211], v9 offset:512
v_mfma_f32_32x32x16_bf16 v[128:143], a[52:55], v[196:199], v[128:143]
buffer_load_dwordx4 v[16:19], v7, s[12:15], s70 offen offset:0 sc1
v_mfma_f32_32x32x16_bf16 v[144:159], a[164:167], v[196:199], v[144:159]
ds_read_b128 v[212:215], v9 offset:544
s_waitcnt lgkmcnt(2)
v_mfma_f32_32x32x16_bf16 v[128:143], a[56:59], v[200:203], v[128:143]
ds_read_b128 v[192:195], v9 offset:576
buffer_load_dwordx4 v[20:23], v8, s[12:15], s70 offen offset:0 sc1
v_mfma_f32_32x32x16_bf16 v[128:143], a[60:63], v[204:207], v[128:143]
ds_read_b128 v[196:199], v9 offset:608
s_waitcnt lgkmcnt(2)
v_mfma_f32_32x32x16_bf16 v[128:143], a[64:67], v[208:211], v[128:143]
ds_read_b128 v[200:203], v9 offset:640
buffer_load_dwordx4 v[24:27], v7, s[12:15], s70 offen offset:2048 sc1
v_mfma_f32_32x32x16_bf16 v[128:143], a[68:71], v[212:215], v[128:143]
ds_read_b128 v[204:207], v9 offset:672
s_waitcnt lgkmcnt(2)
v_mfma_f32_32x32x16_bf16 v[128:143], a[72:75], v[192:195], v[128:143]
ds_read_b128 v[208:211], v9 offset:704
buffer_load_dwordx4 v[28:31], v8, s[12:15], s70 offen offset:2048 sc1
s_waitcnt vmcnt(57)
v_mfma_f32_32x32x16_bf16 v[128:143], a[76:79], v[196:199], v[128:143]
ds_read_b128 v[212:215], v9 offset:736
s_waitcnt lgkmcnt(2)
s_waitcnt vmcnt(55)
v_mfma_f32_32x32x16_bf16 v[128:143], a[80:83], v[200:203], v[128:143]
ds_read_b128 v[192:195], v9 offset:768
s_add_u32 s3, s65, 4096
buffer_load_dwordx4 v[32:35], v7, s[12:15], s3 offen offset:0 sc1
s_waitcnt vmcnt(54)
v_mfma_f32_32x32x16_bf16 v[128:143], a[84:87], v[204:207], v[128:143]
ds_read_b128 v[196:199], v9 offset:800
s_waitcnt lgkmcnt(2)
s_waitcnt vmcnt(52)
v_mfma_f32_32x32x16_bf16 v[128:143], a[88:91], v[208:211], v[128:143]
ds_read_b128 v[200:203], v9 offset:832
s_add_u32 s3, s65, 4096
buffer_load_dwordx4 v[36:39], v8, s[12:15], s3 offen offset:0 sc1
s_waitcnt vmcnt(51)
v_mfma_f32_32x32x16_bf16 v[128:143], a[92:95], v[212:215], v[128:143]
ds_read_b128 v[204:207], v9 offset:864
s_waitcnt lgkmcnt(2)
s_waitcnt vmcnt(49)
v_mfma_f32_32x32x16_bf16 v[128:143], a[96:99], v[192:195], v[128:143]
ds_read_b128 v[208:211], v9 offset:448
s_add_u32 s3, s65, 4096
buffer_load_dwordx4 v[40:43], v7, s[12:15], s3 offen offset:2048 sc1
s_waitcnt vmcnt(48)
v_mfma_f32_32x32x16_bf16 v[128:143], a[100:103], v[196:199], v[128:143]
ds_read_b128 v[212:215], v9 offset:480
s_waitcnt lgkmcnt(2)
s_waitcnt vmcnt(46)
v_mfma_f32_32x32x16_bf16 v[128:143], a[104:107], v[200:203], v[128:143]
ds_read_b128 v[192:195], v9 offset:512
s_add_u32 s3, s65, 4096
buffer_load_dwordx4 v[44:47], v8, s[12:15], s3 offen offset:2048 sc1
s_waitcnt vmcnt(45)
v_mfma_f32_32x32x16_bf16 v[128:143], a[108:111], v[204:207], v[128:143]
ds_read_b128 v[196:199], v9 offset:544
s_waitcnt lgkmcnt(2)
v_mfma_f32_32x32x16_bf16 v[144:159], a[168:171], v[208:211], v[144:159]
ds_read_b128 v[200:203], v9 offset:576
s_waitcnt vmcnt(28)
s_mov_b64 exec, 1
buffer_store_dword v12, off, s[12:15], s83 sc1
s_mov_b64 exec, -1
s_add_u32 s3, s66, 4096
buffer_load_dwordx4 v[48:51], v7, s[12:15], s3 offen offset:0 sc1
v_mfma_f32_32x32x16_bf16 v[144:159], a[172:175], v[212:215], v[144:159]
ds_read_b128 v[204:207], v9 offset:608
v_exp_f32 v216, v128
v_exp_f32 v217, v129
v_exp_f32 v218, v130
s_waitcnt lgkmcnt(2)
v_mfma_f32_32x32x16_bf16 v[144:159], a[176:179], v[192:195], v[144:159]
ds_read_b128 v[208:211], v9 offset:640
s_add_u32 s3, s66, 4096
buffer_load_dwordx4 v[52:55], v8, s[12:15], s3 offen offset:0 sc1
v_exp_f32 v219, v131
v_mfma_f32_32x32x16_bf16 v[144:159], a[180:183], v[196:199], v[144:159]
ds_read_b128 v[212:215], v9 offset:672
v_exp_f32 v220, v132
v_exp_f32 v221, v133
v_exp_f32 v222, v134
s_waitcnt lgkmcnt(2)
v_mfma_f32_32x32x16_bf16 v[144:159], a[184:187], v[200:203], v[144:159]
ds_read_b128 v[192:195], v9 offset:704
v_exp_f32 v223, v135
v_add_f32 v216, 1.0, v216
v_add_f32 v217, 1.0, v217
v_mfma_f32_32x32x16_bf16 v[144:159], a[188:191], v[204:207], v[144:159]
ds_read_b128 v[196:199], v9 offset:736
v_add_f32 v218, 1.0, v218
v_add_f32 v219, 1.0, v219
v_add_f32 v220, 1.0, v220
v_add_f32 v221, 1.0, v221
v_add_f32 v222, 1.0, v222
s_waitcnt lgkmcnt(2)
v_mfma_f32_32x32x16_bf16 v[144:159], a[192:195], v[208:211], v[144:159]
ds_read_b128 v[200:203], v9 offset:768
v_add_f32 v223, 1.0, v223
v_rcp_f32 v216, v216
v_rcp_f32 v217, v217
v_mfma_f32_32x32x16_bf16 v[144:159], a[196:199], v[212:215], v[144:159]
ds_read_b128 v[204:207], v9 offset:800
v_rcp_f32 v218, v218
v_rcp_f32 v219, v219
v_rcp_f32 v220, v220
s_waitcnt lgkmcnt(2)
v_mfma_f32_32x32x16_bf16 v[144:159], a[200:203], v[192:195], v[144:159]
ds_read_b128 v[208:211], v9 offset:832
v_rcp_f32 v221, v221
v_rcp_f32 v222, v222
v_mfma_f32_32x32x16_bf16 v[144:159], a[204:207], v[196:199], v[144:159]
ds_read_b128 v[212:215], v9 offset:864
v_rcp_f32 v223, v223
v_mul_f32 v216, v216, v128
v_mul_f32 v217, v217, v129
v_mul_f32 v218, v218, v130
s_waitcnt lgkmcnt(2)
v_mfma_f32_32x32x16_bf16 v[144:159], a[208:211], v[200:203], v[144:159]
ds_read_b128 v[192:195], v9 offset:29184
v_mul_f32 v219, v219, v131
v_mul_f32 v220, v220, v132
v_mul_f32 v221, v221, v133
v_mul_f32 v222, v222, v134
v_mfma_f32_32x32x16_bf16 v[144:159], a[212:215], v[204:207], v[144:159]
ds_read_b128 v[196:199], v9 offset:29216
v_mul_f32 v223, v223, v135
v_cvt_pk_bf16_f32 v96, v216, v217
v_cvt_pk_bf16_f32 v97, v218, v219
v_cvt_pk_bf16_f32 v98, v220, v221
v_cvt_pk_bf16_f32 v99, v222, v223
s_waitcnt lgkmcnt(2)
v_mfma_f32_32x32x16_bf16 v[144:159], a[216:219], v[208:211], v[144:159]
ds_read_b128 v[200:203], v9 offset:29248
buffer_store_dwordx4 v[96:99], v2, s[12:15], s72 offen offset:0 sc1
v_exp_f32 v224, v136
v_exp_f32 v225, v137
v_mfma_f32_32x32x16_bf16 v[144:159], a[220:223], v[212:215], v[144:159]
ds_read_b128 v[204:207], v9 offset:29280
v_exp_f32 v226, v138
v_exp_f32 v227, v139
v_exp_f32 v228, v140
s_branch t0e_38
t0v_35:
s_waitcnt lgkmcnt(2)
v_mfma_f32_32x32x16_bf16 v[128:143], a[0:3], v[192:195], 0
buffer_load_dwordx4 a[224:227], v7, s[12:15], s64 offen offset:0 sc1
s_nop 3
v_mfma_f32_32x32x16_bf16 v[144:159], a[112:115], v[192:195], 0
ds_read_b128 v[208:211], v9 offset:128
v_cvt_pk_bf16_f32 v240, v52, v53
v_cvt_pk_bf16_f32 v241, v68, v69
v_cvt_pk_bf16_f32 v242, v84, v85
v_cvt_pk_bf16_f32 v243, v100, v101
v_mfma_f32_32x32x16_bf16 v[128:143], a[4:7], v[196:199], v[128:143]
buffer_load_dwordx4 a[228:231], v8, s[12:15], s64 offen offset:0 sc1
s_mov_b32 exec_lo, 0
s_mov_b32 exec_hi, 0xffff
ds_write_b128 v4, v[240:243] offset:0
s_mov_b64 exec, -1
v_mfma_f32_32x32x16_bf16 v[144:159], a[116:119], v[196:199], v[144:159]
ds_read_b128 v[212:215], v9 offset:160
v_cvt_pk_bf16_f32 v244, v116, v117
v_cvt_pk_bf16_f32 v245, v22, v23
v_cvt_pk_bf16_f32 v246, v38, v39
v_cvt_pk_bf16_f32 v247, v54, v55
s_waitcnt lgkmcnt(3)
v_mfma_f32_32x32x16_bf16 v[128:143], a[8:11], v[200:203], v[128:143]
buffer_load_dwordx4 a[232:235], v7, s[12:15], s64 offen offset:2048 sc1
v_mfma_f32_32x32x16_bf16 v[144:159], a[120:123], v[200:203], v[144:159]
ds_read_b128 v[192:195], v9 offset:192
s_mov_b32 exec_lo, 0
s_mov_b32 exec_hi, 0xffff
ds_write_b128 v4, v[244:247] offset:512
s_mov_b64 exec, -1
v_mfma_f32_32x32x16_bf16 v[128:143], a[12:15], v[204:207], v[128:143]
buffer_load_dwordx4 a[236:239], v8, s[12:15], s64 offen offset:2048 sc1
v_cvt_pk_bf16_f32 v240, v70, v71
v_cvt_pk_bf16_f32 v241, v86, v87
v_cvt_pk_bf16_f32 v242, v102, v103
v_cvt_pk_bf16_f32 v243, v118, v119
v_mfma_f32_32x32x16_bf16 v[144:159], a[124:127], v[204:207], v[144:159]
ds_read_b128 v[196:199], v9 offset:224
s_add_u32 s3, s64, 4096
buffer_load_dwordx4 a[240:243], v7, s[12:15], s3 offen offset:0 sc1
s_waitcnt lgkmcnt(3)
v_mfma_f32_32x32x16_bf16 v[128:143], a[16:19], v[208:211], v[128:143]
s_add_u32 s3, s64, 4096
buffer_load_dwordx4 a[244:247], v8, s[12:15], s3 offen offset:0 sc1
v_mfma_f32_32x32x16_bf16 v[144:159], a[128:131], v[208:211], v[144:159]
ds_read_b128 v[200:203], v9 offset:256
s_add_u32 s3, s64, 4096
buffer_load_dwordx4 a[248:251], v7, s[12:15], s3 offen offset:2048 sc1
v_mfma_f32_32x32x16_bf16 v[128:143], a[20:23], v[212:215], v[128:143]
s_add_u32 s3, s64, 4096
buffer_load_dwordx4 a[252:255], v8, s[12:15], s3 offen offset:2048 sc1
v_mfma_f32_32x32x16_bf16 v[144:159], a[132:135], v[212:215], v[144:159]
ds_read_b128 v[204:207], v9 offset:288
s_mov_b32 exec_lo, 0
s_mov_b32 exec_hi, 0xffff
ds_write_b128 v4, v[240:243] offset:1024
s_mov_b64 exec, -1
s_waitcnt lgkmcnt(3)
v_mfma_f32_32x32x16_bf16 v[128:143], a[24:27], v[192:195], v[128:143]
v_cvt_pk_bf16_f32 v244, v24, v25
v_cvt_pk_bf16_f32 v245, v40, v41
v_cvt_pk_bf16_f32 v246, v56, v57
v_cvt_pk_bf16_f32 v247, v72, v73
v_mfma_f32_32x32x16_bf16 v[144:159], a[136:139], v[192:195], v[144:159]
ds_read_b128 v[208:211], v9 offset:320
s_mov_b32 exec_lo, 0
s_mov_b32 exec_hi, 0xffff
ds_write_b128 v4, v[244:247] offset:1536
s_mov_b64 exec, -1
v_mfma_f32_32x32x16_bf16 v[128:143], a[28:31], v[196:199], v[128:143]
v_cvt_pk_bf16_f32 v240, v88, v89
v_cvt_pk_bf16_f32 v241, v104, v105
v_cvt_pk_bf16_f32 v242, v120, v121
v_cvt_pk_bf16_f32 v243, v26, v27
v_mfma_f32_32x32x16_bf16 v[144:159], a[140:143], v[196:199], v[144:159]
ds_read_b128 v[212:215], v9 offset:352
s_mov_b32 exec_lo, 0
s_mov_b32 exec_hi, 0xffff
ds_write_b128 v4, v[240:243] offset:2048
s_mov_b64 exec, -1
s_waitcnt lgkmcnt(5)
v_mfma_f32_32x32x16_bf16 v[128:143], a[32:35], v[200:203], v[128:143]
v_cvt_pk_bf16_f32 v244, v42, v43
v_cvt_pk_bf16_f32 v245, v58, v59
v_cvt_pk_bf16_f32 v246, v74, v75
v_cvt_pk_bf16_f32 v247, v90, v91
v_mfma_f32_32x32x16_bf16 v[144:159], a[144:147], v[200:203], v[144:159]
ds_read_b128 v[192:195], v9 offset:384
s_mov_b32 exec_lo, 0
s_mov_b32 exec_hi, 0xffff
ds_write_b128 v4, v[244:247] offset:2560
s_mov_b64 exec, -1
v_mfma_f32_32x32x16_bf16 v[128:143], a[36:39], v[204:207], v[128:143]
v_cvt_pk_bf16_f32 v240, v106, v107
v_cvt_pk_bf16_f32 v241, v122, v123
v_cvt_pk_bf16_f32 v242, v28, v29
v_cvt_pk_bf16_f32 v243, v44, v45
v_mfma_f32_32x32x16_bf16 v[144:159], a[148:151], v[204:207], v[144:159]
ds_read_b128 v[196:199], v9 offset:416
s_mov_b32 exec_lo, 0
s_mov_b32 exec_hi, 0xffff
ds_write_b128 v4, v[240:243] offset:3072
s_mov_b64 exec, -1
s_waitcnt lgkmcnt(5)
v_mfma_f32_32x32x16_bf16 v[128:143], a[40:43], v[208:211], v[128:143]
v_cvt_pk_bf16_f32 v244, v60, v61
v_cvt_pk_bf16_f32 v245, v76, v77
v_cvt_pk_bf16_f32 v246, v92, v93
v_cvt_pk_bf16_f32 v247, v108, v109
v_mfma_f32_32x32x16_bf16 v[144:159], a[152:155], v[208:211], v[144:159]
ds_read_b128 v[200:203], v9 offset:448
s_mov_b32 exec_lo, 0
s_mov_b32 exec_hi, 0xffff
ds_write_b128 v4, v[244:247] offset:3584
s_mov_b64 exec, -1
v_mfma_f32_32x32x16_bf16 v[128:143], a[44:47], v[212:215], v[128:143]
v_mfma_f32_32x32x16_bf16 v[144:159], a[156:159], v[212:215], v[144:159]
ds_read_b128 v[204:207], v9 offset:480
s_waitcnt lgkmcnt(4)
v_mfma_f32_32x32x16_bf16 v[128:143], a[48:51], v[192:195], v[128:143]
v_mfma_f32_32x32x16_bf16 v[144:159], a[160:163], v[192:195], v[144:159]
ds_read_b128 v[208:211], v9 offset:512
v_mfma_f32_32x32x16_bf16 v[128:143], a[52:55], v[196:199], v[128:143]
buffer_load_dwordx4 v[16:19], v7, s[12:15], s70 offen offset:0 sc1
v_mfma_f32_32x32x16_bf16 v[144:159], a[164:167], v[196:199], v[144:159]
ds_read_b128 v[212:215], v9 offset:544
s_waitcnt lgkmcnt(2)
v_mfma_f32_32x32x16_bf16 v[128:143], a[56:59], v[200:203], v[128:143]
ds_read_b128 v[192:195], v9 offset:576
buffer_load_dwordx4 v[20:23], v8, s[12:15], s70 offen offset:0 sc1
v_mfma_f32_32x32x16_bf16 v[128:143], a[60:63], v[204:207], v[128:143]
ds_read_b128 v[196:199], v9 offset:608
s_waitcnt lgkmcnt(2)
v_mfma_f32_32x32x16_bf16 v[128:143], a[64:67], v[208:211], v[128:143]
ds_read_b128 v[200:203], v9 offset:640
buffer_load_dwordx4 v[24:27], v7, s[12:15], s70 offen offset:2048 sc1
v_mfma_f32_32x32x16_bf16 v[128:143], a[68:71], v[212:215], v[128:143]
ds_read_b128 v[204:207], v9 offset:672
s_waitcnt lgkmcnt(2)
v_mfma_f32_32x32x16_bf16 v[128:143], a[72:75], v[192:195], v[128:143]
ds_read_b128 v[208:211], v9 offset:704
buffer_load_dwordx4 v[28:31], v8, s[12:15], s70 offen offset:2048 sc1
s_waitcnt vmcnt(57)
v_mfma_f32_32x32x16_bf16 v[128:143], a[76:79], v[196:199], v[128:143]
ds_read_b128 v[212:215], v9 offset:736
s_waitcnt lgkmcnt(2)
s_waitcnt vmcnt(55)
v_mfma_f32_32x32x16_bf16 v[128:143], a[80:83], v[200:203], v[128:143]
ds_read_b128 v[192:195], v9 offset:768
s_add_u32 s3, s65, 4096
buffer_load_dwordx4 v[32:35], v7, s[12:15], s3 offen offset:0 sc1
s_waitcnt vmcnt(54)
v_mfma_f32_32x32x16_bf16 v[128:143], a[84:87], v[204:207], v[128:143]
ds_read_b128 v[196:199], v9 offset:800
s_waitcnt lgkmcnt(2)
s_waitcnt vmcnt(52)
v_mfma_f32_32x32x16_bf16 v[128:143], a[88:91], v[208:211], v[128:143]
ds_read_b128 v[200:203], v9 offset:832
s_add_u32 s3, s65, 4096
buffer_load_dwordx4 v[36:39], v8, s[12:15], s3 offen offset:0 sc1
s_waitcnt vmcnt(51)
v_mfma_f32_32x32x16_bf16 v[128:143], a[92:95], v[212:215], v[128:143]
ds_read_b128 v[204:207], v9 offset:864
s_waitcnt lgkmcnt(2)
s_waitcnt vmcnt(49)
v_mfma_f32_32x32x16_bf16 v[128:143], a[96:99], v[192:195], v[128:143]
ds_read_b128 v[208:211], v9 offset:448
s_add_u32 s3, s65, 4096
buffer_load_dwordx4 v[40:43], v7, s[12:15], s3 offen offset:2048 sc1
s_waitcnt vmcnt(48)
v_mfma_f32_32x32x16_bf16 v[128:143], a[100:103], v[196:199], v[128:143]
ds_read_b128 v[212:215], v9 offset:480
s_waitcnt lgkmcnt(2)
s_waitcnt vmcnt(46)
v_mfma_f32_32x32x16_bf16 v[128:143], a[104:107], v[200:203], v[128:143]
ds_read_b128 v[192:195], v9 offset:512
s_add_u32 s3, s65, 4096
buffer_load_dwordx4 v[44:47], v8, s[12:15], s3 offen offset:2048 sc1
s_waitcnt vmcnt(45)
v_mfma_f32_32x32x16_bf16 v[128:143], a[108:111], v[204:207], v[128:143]
ds_read_b128 v[196:199], v9 offset:544
s_waitcnt lgkmcnt(2)
v_mfma_f32_32x32x16_bf16 v[144:159], a[168:171], v[208:211], v[144:159]
ds_read_b128 v[200:203], v9 offset:576
s_waitcnt vmcnt(28)
s_mov_b64 exec, 1
buffer_store_dword v12, off, s[12:15], s83 sc1
s_mov_b64 exec, -1
s_add_u32 s3, s66, 4096
buffer_load_dwordx4 v[48:51], v7, s[12:15], s3 offen offset:0 sc1
v_mfma_f32_32x32x16_bf16 v[144:159], a[172:175], v[212:215], v[144:159]
ds_read_b128 v[204:207], v9 offset:608
v_exp_f32 v216, v128
v_exp_f32 v217, v129
v_exp_f32 v218, v130
s_waitcnt lgkmcnt(2)
v_mfma_f32_32x32x16_bf16 v[144:159], a[176:179], v[192:195], v[144:159]
ds_read_b128 v[208:211], v9 offset:640
s_add_u32 s3, s66, 4096
buffer_load_dwordx4 v[52:55], v8, s[12:15], s3 offen offset:0 sc1
v_exp_f32 v219, v131
v_mfma_f32_32x32x16_bf16 v[144:159], a[180:183], v[196:199], v[144:159]
ds_read_b128 v[212:215], v9 offset:672
v_exp_f32 v220, v132
v_exp_f32 v221, v133
v_exp_f32 v222, v134
s_waitcnt lgkmcnt(2)
v_mfma_f32_32x32x16_bf16 v[144:159], a[184:187], v[200:203], v[144:159]
ds_read_b128 v[192:195], v9 offset:704
v_exp_f32 v223, v135
v_add_f32 v216, 1.0, v216
v_add_f32 v217, 1.0, v217
v_mfma_f32_32x32x16_bf16 v[144:159], a[188:191], v[204:207], v[144:159]
ds_read_b128 v[196:199], v9 offset:736
v_add_f32 v218, 1.0, v218
v_add_f32 v219, 1.0, v219
v_add_f32 v220, 1.0, v220
v_add_f32 v221, 1.0, v221
v_add_f32 v222, 1.0, v222
s_waitcnt lgkmcnt(2)
v_mfma_f32_32x32x16_bf16 v[144:159], a[192:195], v[208:211], v[144:159]
ds_read_b128 v[200:203], v9 offset:768
v_add_f32 v223, 1.0, v223
v_rcp_f32 v216, v216
v_rcp_f32 v217, v217
v_mfma_f32_32x32x16_bf16 v[144:159], a[196:199], v[212:215], v[144:159]
ds_read_b128 v[204:207], v9 offset:800
v_rcp_f32 v218, v218
v_rcp_f32 v219, v219
v_rcp_f32 v220, v220
s_waitcnt lgkmcnt(2)
v_mfma_f32_32x32x16_bf16 v[144:159], a[200:203], v[192:195], v[144:159]
ds_read_b128 v[208:211], v9 offset:832
v_rcp_f32 v221, v221
v_rcp_f32 v222, v222
v_mfma_f32_32x32x16_bf16 v[144:159], a[204:207], v[196:199], v[144:159]
ds_read_b128 v[212:215], v9 offset:864
v_rcp_f32 v223, v223
v_mul_f32 v216, v216, v128
v_mul_f32 v217, v217, v129
v_mul_f32 v218, v218, v130
s_waitcnt lgkmcnt(2)
v_mfma_f32_32x32x16_bf16 v[144:159], a[208:211], v[200:203], v[144:159]
ds_read_b128 v[192:195], v9 offset:29184
v_mul_f32 v219, v219, v131
v_mul_f32 v220, v220, v132
v_mul_f32 v221, v221, v133
v_mul_f32 v222, v222, v134
v_mfma_f32_32x32x16_bf16 v[144:159], a[212:215], v[204:207], v[144:159]
ds_read_b128 v[196:199], v9 offset:29216
v_mul_f32 v223, v223, v135
v_cvt_pk_bf16_f32 v96, v216, v217
v_cvt_pk_bf16_f32 v97, v218, v219
v_cvt_pk_bf16_f32 v98, v220, v221
v_cvt_pk_bf16_f32 v99, v222, v223
s_waitcnt lgkmcnt(2)
v_mfma_f32_32x32x16_bf16 v[144:159], a[216:219], v[208:211], v[144:159]
ds_read_b128 v[200:203], v9 offset:29248
buffer_store_dwordx4 v[96:99], v2, s[12:15], s72 offen offset:0 sc1
v_exp_f32 v224, v136
v_exp_f32 v225, v137
v_mfma_f32_32x32x16_bf16 v[144:159], a[220:223], v[212:215], v[144:159]
ds_read_b128 v[204:207], v9 offset:29280
v_exp_f32 v226, v138
v_exp_f32 v227, v139
v_exp_f32 v228, v140
s_branch t0e_38
t0v_36:
s_waitcnt lgkmcnt(2)
v_mfma_f32_32x32x16_bf16 v[128:143], a[0:3], v[192:195], 0
buffer_load_dwordx4 a[224:227], v7, s[12:15], s64 offen offset:0 sc1
s_nop 3
v_mfma_f32_32x32x16_bf16 v[144:159], a[112:115], v[192:195], 0
ds_read_b128 v[208:211], v9 offset:128
v_cvt_pk_bf16_f32 v240, v124, v125
v_cvt_pk_bf16_f32 v241, v30, v31
v_cvt_pk_bf16_f32 v242, v46, v47
v_cvt_pk_bf16_f32 v243, v62, v63
v_mfma_f32_32x32x16_bf16 v[128:143], a[4:7], v[196:199], v[128:143]
buffer_load_dwordx4 a[228:231], v8, s[12:15], s64 offen offset:0 sc1
s_mov_b32 exec_lo, 0
s_mov_b32 exec_hi, 0xffff
ds_write_b128 v4, v[240:243] offset:0
s_mov_b64 exec, -1
v_mfma_f32_32x32x16_bf16 v[144:159], a[116:119], v[196:199], v[144:159]
ds_read_b128 v[212:215], v9 offset:160
v_cvt_pk_bf16_f32 v244, v78, v79
v_cvt_pk_bf16_f32 v245, v94, v95
v_cvt_pk_bf16_f32 v246, v110, v111
v_cvt_pk_bf16_f32 v247, v126, v127
s_waitcnt lgkmcnt(3)
v_mfma_f32_32x32x16_bf16 v[128:143], a[8:11], v[200:203], v[128:143]
buffer_load_dwordx4 a[232:235], v7, s[12:15], s64 offen offset:2048 sc1
v_mfma_f32_32x32x16_bf16 v[144:159], a[120:123], v[200:203], v[144:159]
ds_read_b128 v[192:195], v9 offset:192
s_mov_b32 exec_lo, 0
s_mov_b32 exec_hi, 0xffff
ds_write_b128 v4, v[244:247] offset:512
s_mov_b64 exec, -1
v_mfma_f32_32x32x16_bf16 v[128:143], a[12:15], v[204:207], v[128:143]
buffer_load_dwordx4 a[236:239], v8, s[12:15], s64 offen offset:2048 sc1
v_cvt_pk_bf16_f32 v240, v16, v17
v_cvt_pk_bf16_f32 v241, v32, v33
v_cvt_pk_bf16_f32 v242, v48, v49
v_cvt_pk_bf16_f32 v243, v64, v65
v_mfma_f32_32x32x16_bf16 v[144:159], a[124:127], v[204:207], v[144:159]
ds_read_b128 v[196:199], v9 offset:224
s_add_u32 s3, s64, 4096
buffer_load_dwordx4 a[240:243], v7, s[12:15], s3 offen offset:0 sc1
s_waitcnt lgkmcnt(3)
v_mfma_f32_32x32x16_bf16 v[128:143], a[16:19], v[208:211], v[128:143]
s_add_u32 s3, s64, 4096
buffer_load_dwordx4 a[244:247], v8, s[12:15], s3 offen offset:0 sc1
v_mfma_f32_32x32x16_bf16 v[144:159], a[128:131], v[208:211], v[144:159]
ds_read_b128 v[200:203], v9 offset:256
s_add_u32 s3, s64, 4096
buffer_load_dwordx4 a[248:251], v7, s[12:15], s3 offen offset:2048 sc1
v_mfma_f32_32x32x16_bf16 v[128:143], a[20:23], v[212:215], v[128:143]
s_add_u32 s3, s64, 4096
buffer_load_dwordx4 a[252:255], v8, s[12:15], s3 offen offset:2048 sc1
v_mfma_f32_32x32x16_bf16 v[144:159], a[132:135], v[212:215], v[144:159]
ds_read_b128 v[204:207], v9 offset:288
s_mov_b32 exec_lo, 0
s_mov_b32 exec_hi, 0xffff0000
ds_write_b128 v4, v[240:243] offset:1024
s_mov_b64 exec, -1
s_waitcnt lgkmcnt(3)
v_mfma_f32_32x32x16_bf16 v[128:143], a[24:27], v[192:195], v[128:143]
v_cvt_pk_bf16_f32 v244, v80, v81
v_cvt_pk_bf16_f32 v245, v96, v97
v_cvt_pk_bf16_f32 v246, v112, v113
v_cvt_pk_bf16_f32 v247, v18, v19
v_mfma_f32_32x32x16_bf16 v[144:159], a[136:139], v[192:195], v[144:159]
ds_read_b128 v[208:211], v9 offset:320
s_mov_b32 exec_lo, 0
s_mov_b32 exec_hi, 0xffff0000
ds_write_b128 v4, v[244:247] offset:1536
s_mov_b64 exec, -1
v_mfma_f32_32x32x16_bf16 v[128:143], a[28:31], v[196:199], v[128:143]
v_cvt_pk_bf16_f32 v240, v34, v35
v_cvt_pk_bf16_f32 v241, v50, v51
v_cvt_pk_bf16_f32 v242, v66, v67
v_cvt_pk_bf16_f32 v243, v82, v83
v_mfma_f32_32x32x16_bf16 v[144:159], a[140:143], v[196:199], v[144:159]
ds_read_b128 v[212:215], v9 offset:352
s_mov_b32 exec_lo, 0
s_mov_b32 exec_hi, 0xffff0000
ds_write_b128 v4, v[240:243] offset:2048
s_mov_b64 exec, -1
s_waitcnt lgkmcnt(5)
v_mfma_f32_32x32x16_bf16 v[128:143], a[32:35], v[200:203], v[128:143]
v_cvt_pk_bf16_f32 v244, v98, v99
v_cvt_pk_bf16_f32 v245, v114, v115
v_cvt_pk_bf16_f32 v246, v20, v21
v_cvt_pk_bf16_f32 v247, v36, v37
v_mfma_f32_32x32x16_bf16 v[144:159], a[144:147], v[200:203], v[144:159]
ds_read_b128 v[192:195], v9 offset:384
s_mov_b32 exec_lo, 0
s_mov_b32 exec_hi, 0xffff0000
ds_write_b128 v4, v[244:247] offset:2560
s_mov_b64 exec, -1
v_mfma_f32_32x32x16_bf16 v[128:143], a[36:39], v[204:207], v[128:143]
v_cvt_pk_bf16_f32 v240, v52, v53
v_cvt_pk_bf16_f32 v241, v68, v69
v_cvt_pk_bf16_f32 v242, v84, v85
v_cvt_pk_bf16_f32 v243, v100, v101
v_mfma_f32_32x32x16_bf16 v[144:159], a[148:151], v[204:207], v[144:159]
ds_read_b128 v[196:199], v9 offset:416
s_mov_b32 exec_lo, 0
s_mov_b32 exec_hi, 0xffff0000
ds_write_b128 v4, v[240:243] offset:3072
s_mov_b64 exec, -1
s_waitcnt lgkmcnt(5)
v_mfma_f32_32x32x16_bf16 v[128:143], a[40:43], v[208:211], v[128:143]
v_cvt_pk_bf16_f32 v244, v116, v117
v_cvt_pk_bf16_f32 v245, v22, v23
v_cvt_pk_bf16_f32 v246, v38, v39
v_cvt_pk_bf16_f32 v247, v54, v55
v_mfma_f32_32x32x16_bf16 v[144:159], a[152:155], v[208:211], v[144:159]
ds_read_b128 v[200:203], v9 offset:448
s_mov_b32 exec_lo, 0
s_mov_b32 exec_hi, 0xffff0000
ds_write_b128 v4, v[244:247] offset:3584
s_mov_b64 exec, -1
v_mfma_f32_32x32x16_bf16 v[128:143], a[44:47], v[212:215], v[128:143]
v_mfma_f32_32x32x16_bf16 v[144:159], a[156:159], v[212:215], v[144:159]
ds_read_b128 v[204:207], v9 offset:480
s_waitcnt lgkmcnt(4)
v_mfma_f32_32x32x16_bf16 v[128:143], a[48:51], v[192:195], v[128:143]
v_mfma_f32_32x32x16_bf16 v[144:159], a[160:163], v[192:195], v[144:159]
ds_read_b128 v[208:211], v9 offset:512
v_mfma_f32_32x32x16_bf16 v[128:143], a[52:55], v[196:199], v[128:143]
buffer_load_dwordx4 v[16:19], v7, s[12:15], s70 offen offset:0 sc1
v_mfma_f32_32x32x16_bf16 v[144:159], a[164:167], v[196:199], v[144:159]
ds_read_b128 v[212:215], v9 offset:544
s_waitcnt lgkmcnt(2)
v_mfma_f32_32x32x16_bf16 v[128:143], a[56:59], v[200:203], v[128:143]
ds_read_b128 v[192:195], v9 offset:576
buffer_load_dwordx4 v[20:23], v8, s[12:15], s70 offen offset:0 sc1
v_mfma_f32_32x32x16_bf16 v[128:143], a[60:63], v[204:207], v[128:143]
ds_read_b128 v[196:199], v9 offset:608
s_waitcnt lgkmcnt(2)
v_mfma_f32_32x32x16_bf16 v[128:143], a[64:67], v[208:211], v[128:143]
ds_read_b128 v[200:203], v9 offset:640
buffer_load_dwordx4 v[24:27], v7, s[12:15], s70 offen offset:2048 sc1
v_mfma_f32_32x32x16_bf16 v[128:143], a[68:71], v[212:215], v[128:143]
ds_read_b128 v[204:207], v9 offset:672
s_waitcnt lgkmcnt(2)
v_mfma_f32_32x32x16_bf16 v[128:143], a[72:75], v[192:195], v[128:143]
ds_read_b128 v[208:211], v9 offset:704
buffer_load_dwordx4 v[28:31], v8, s[12:15], s70 offen offset:2048 sc1
s_waitcnt vmcnt(57)
v_mfma_f32_32x32x16_bf16 v[128:143], a[76:79], v[196:199], v[128:143]
ds_read_b128 v[212:215], v9 offset:736
s_waitcnt lgkmcnt(2)
s_waitcnt vmcnt(55)
v_mfma_f32_32x32x16_bf16 v[128:143], a[80:83], v[200:203], v[128:143]
ds_read_b128 v[192:195], v9 offset:768
s_add_u32 s3, s65, 4096
buffer_load_dwordx4 v[32:35], v7, s[12:15], s3 offen offset:0 sc1
s_waitcnt vmcnt(54)
v_mfma_f32_32x32x16_bf16 v[128:143], a[84:87], v[204:207], v[128:143]
ds_read_b128 v[196:199], v9 offset:800
s_waitcnt lgkmcnt(2)
s_waitcnt vmcnt(52)
v_mfma_f32_32x32x16_bf16 v[128:143], a[88:91], v[208:211], v[128:143]
ds_read_b128 v[200:203], v9 offset:832
s_add_u32 s3, s65, 4096
buffer_load_dwordx4 v[36:39], v8, s[12:15], s3 offen offset:0 sc1
s_waitcnt vmcnt(51)
v_mfma_f32_32x32x16_bf16 v[128:143], a[92:95], v[212:215], v[128:143]
ds_read_b128 v[204:207], v9 offset:864
s_waitcnt lgkmcnt(2)
s_waitcnt vmcnt(49)
v_mfma_f32_32x32x16_bf16 v[128:143], a[96:99], v[192:195], v[128:143]
ds_read_b128 v[208:211], v9 offset:448
s_add_u32 s3, s65, 4096
buffer_load_dwordx4 v[40:43], v7, s[12:15], s3 offen offset:2048 sc1
s_waitcnt vmcnt(48)
v_mfma_f32_32x32x16_bf16 v[128:143], a[100:103], v[196:199], v[128:143]
ds_read_b128 v[212:215], v9 offset:480
s_waitcnt lgkmcnt(2)
s_waitcnt vmcnt(46)
v_mfma_f32_32x32x16_bf16 v[128:143], a[104:107], v[200:203], v[128:143]
ds_read_b128 v[192:195], v9 offset:512
s_add_u32 s3, s65, 4096
buffer_load_dwordx4 v[44:47], v8, s[12:15], s3 offen offset:2048 sc1
s_waitcnt vmcnt(45)
v_mfma_f32_32x32x16_bf16 v[128:143], a[108:111], v[204:207], v[128:143]
ds_read_b128 v[196:199], v9 offset:544
s_waitcnt lgkmcnt(2)
v_mfma_f32_32x32x16_bf16 v[144:159], a[168:171], v[208:211], v[144:159]
ds_read_b128 v[200:203], v9 offset:576
s_waitcnt vmcnt(28)
s_mov_b64 exec, 1
buffer_store_dword v12, off, s[12:15], s83 sc1
s_mov_b64 exec, -1
s_add_u32 s3, s66, 4096
buffer_load_dwordx4 v[48:51], v7, s[12:15], s3 offen offset:0 sc1
v_mfma_f32_32x32x16_bf16 v[144:159], a[172:175], v[212:215], v[144:159]
ds_read_b128 v[204:207], v9 offset:608
v_exp_f32 v216, v128
v_exp_f32 v217, v129
v_exp_f32 v218, v130
s_waitcnt lgkmcnt(2)
v_mfma_f32_32x32x16_bf16 v[144:159], a[176:179], v[192:195], v[144:159]
ds_read_b128 v[208:211], v9 offset:640
s_add_u32 s3, s66, 4096
buffer_load_dwordx4 v[52:55], v8, s[12:15], s3 offen offset:0 sc1
v_exp_f32 v219, v131
v_mfma_f32_32x32x16_bf16 v[144:159], a[180:183], v[196:199], v[144:159]
ds_read_b128 v[212:215], v9 offset:672
v_exp_f32 v220, v132
v_exp_f32 v221, v133
v_exp_f32 v222, v134
s_waitcnt lgkmcnt(2)
v_mfma_f32_32x32x16_bf16 v[144:159], a[184:187], v[200:203], v[144:159]
ds_read_b128 v[192:195], v9 offset:704
v_exp_f32 v223, v135
v_add_f32 v216, 1.0, v216
v_add_f32 v217, 1.0, v217
v_mfma_f32_32x32x16_bf16 v[144:159], a[188:191], v[204:207], v[144:159]
ds_read_b128 v[196:199], v9 offset:736
v_add_f32 v218, 1.0, v218
v_add_f32 v219, 1.0, v219
v_add_f32 v220, 1.0, v220
v_add_f32 v221, 1.0, v221
v_add_f32 v222, 1.0, v222
s_waitcnt lgkmcnt(2)
v_mfma_f32_32x32x16_bf16 v[144:159], a[192:195], v[208:211], v[144:159]
ds_read_b128 v[200:203], v9 offset:768
v_add_f32 v223, 1.0, v223
v_rcp_f32 v216, v216
v_rcp_f32 v217, v217
v_mfma_f32_32x32x16_bf16 v[144:159], a[196:199], v[212:215], v[144:159]
ds_read_b128 v[204:207], v9 offset:800
v_rcp_f32 v218, v218
v_rcp_f32 v219, v219
v_rcp_f32 v220, v220
s_waitcnt lgkmcnt(2)
v_mfma_f32_32x32x16_bf16 v[144:159], a[200:203], v[192:195], v[144:159]
ds_read_b128 v[208:211], v9 offset:832
v_rcp_f32 v221, v221
v_rcp_f32 v222, v222
v_mfma_f32_32x32x16_bf16 v[144:159], a[204:207], v[196:199], v[144:159]
ds_read_b128 v[212:215], v9 offset:864
v_rcp_f32 v223, v223
v_mul_f32 v216, v216, v128
v_mul_f32 v217, v217, v129
v_mul_f32 v218, v218, v130
s_waitcnt lgkmcnt(2)
v_mfma_f32_32x32x16_bf16 v[144:159], a[208:211], v[200:203], v[144:159]
ds_read_b128 v[192:195], v9 offset:29184
v_mul_f32 v219, v219, v131
v_mul_f32 v220, v220, v132
v_mul_f32 v221, v221, v133
v_mul_f32 v222, v222, v134
v_mfma_f32_32x32x16_bf16 v[144:159], a[212:215], v[204:207], v[144:159]
ds_read_b128 v[196:199], v9 offset:29216
v_mul_f32 v223, v223, v135
v_cvt_pk_bf16_f32 v96, v216, v217
v_cvt_pk_bf16_f32 v97, v218, v219
v_cvt_pk_bf16_f32 v98, v220, v221
v_cvt_pk_bf16_f32 v99, v222, v223
s_waitcnt lgkmcnt(2)
v_mfma_f32_32x32x16_bf16 v[144:159], a[216:219], v[208:211], v[144:159]
ds_read_b128 v[200:203], v9 offset:29248
buffer_store_dwordx4 v[96:99], v2, s[12:15], s72 offen offset:0 sc1
v_exp_f32 v224, v136
v_exp_f32 v225, v137
v_mfma_f32_32x32x16_bf16 v[144:159], a[220:223], v[212:215], v[144:159]
ds_read_b128 v[204:207], v9 offset:29280
v_exp_f32 v226, v138
v_exp_f32 v227, v139
v_exp_f32 v228, v140
s_branch t0e_38
t0v_37:
s_waitcnt lgkmcnt(2)
v_mfma_f32_32x32x16_bf16 v[128:143], a[0:3], v[192:195], 0
buffer_load_dwordx4 a[224:227], v7, s[12:15], s64 offen offset:0 sc1
s_nop 3
v_mfma_f32_32x32x16_bf16 v[144:159], a[112:115], v[192:195], 0
ds_read_b128 v[208:211], v9 offset:128
v_cvt_pk_bf16_f32 v240, v70, v71
v_cvt_pk_bf16_f32 v241, v86, v87
v_cvt_pk_bf16_f32 v242, v102, v103
v_cvt_pk_bf16_f32 v243, v118, v119
v_mfma_f32_32x32x16_bf16 v[128:143], a[4:7], v[196:199], v[128:143]
buffer_load_dwordx4 a[228:231], v8, s[12:15], s64 offen offset:0 sc1
s_mov_b32 exec_lo, 0
s_mov_b32 exec_hi, 0xffff0000
ds_write_b128 v4, v[240:243] offset:0
s_mov_b64 exec, -1
v_mfma_f32_32x32x16_bf16 v[144:159], a[116:119], v[196:199], v[144:159]
ds_read_b128 v[212:215], v9 offset:160
v_cvt_pk_bf16_f32 v244, v24, v25
v_cvt_pk_bf16_f32 v245, v40, v41
v_cvt_pk_bf16_f32 v246, v56, v57
v_cvt_pk_bf16_f32 v247, v72, v73
s_waitcnt lgkmcnt(3)
v_mfma_f32_32x32x16_bf16 v[128:143], a[8:11], v[200:203], v[128:143]
buffer_load_dwordx4 a[232:235], v7, s[12:15], s64 offen offset:2048 sc1
v_mfma_f32_32x32x16_bf16 v[144:159], a[120:123], v[200:203], v[144:159]
ds_read_b128 v[192:195], v9 offset:192
s_mov_b32 exec_lo, 0
s_mov_b32 exec_hi, 0xffff0000
ds_write_b128 v4, v[244:247] offset:512
s_mov_b64 exec, -1
v_mfma_f32_32x32x16_bf16 v[128:143], a[12:15], v[204:207], v[128:143]
buffer_load_dwordx4 a[236:239], v8, s[12:15], s64 offen offset:2048 sc1
v_cvt_pk_bf16_f32 v240, v88, v89
v_cvt_pk_bf16_f32 v241, v104, v105
v_cvt_pk_bf16_f32 v242, v120, v121
v_cvt_pk_bf16_f32 v243, v26, v27
v_mfma_f32_32x32x16_bf16 v[144:159], a[124:127], v[204:207], v[144:159]
ds_read_b128 v[196:199], v9 offset:224
s_add_u32 s3, s64, 4096
buffer_load_dwordx4 a[240:243], v7, s[12:15], s3 offen offset:0 sc1
s_waitcnt lgkmcnt(3)
v_mfma_f32_32x32x16_bf16 v[128:143], a[16:19], v[208:211], v[128:143]
s_add_u32 s3, s64, 4096
buffer_load_dwordx4 a[244:247], v8, s[12:15], s3 offen offset:0 sc1
v_mfma_f32_32x32x16_bf16 v[144:159], a[128:131], v[208:211], v[144:159]
ds_read_b128 v[200:203], v9 offset:256
s_add_u32 s3, s64, 4096
buffer_load_dwordx4 a[248:251], v7, s[12:15], s3 offen offset:2048 sc1
v_mfma_f32_32x32x16_bf16 v[128:143], a[20:23], v[212:215], v[128:143]
s_add_u32 s3, s64, 4096
buffer_load_dwordx4 a[252:255], v8, s[12:15], s3 offen offset:2048 sc1
v_mfma_f32_32x32x16_bf16 v[144:159], a[132:135], v[212:215], v[144:159]
ds_read_b128 v[204:207], v9 offset:288
s_mov_b32 exec_lo, 0
s_mov_b32 exec_hi, 0xffff0000
ds_write_b128 v4, v[240:243] offset:1024
s_mov_b64 exec, -1
s_waitcnt lgkmcnt(3)
v_mfma_f32_32x32x16_bf16 v[128:143], a[24:27], v[192:195], v[128:143]
v_cvt_pk_bf16_f32 v244, v42, v43
v_cvt_pk_bf16_f32 v245, v58, v59
v_cvt_pk_bf16_f32 v246, v74, v75
v_cvt_pk_bf16_f32 v247, v90, v91
v_mfma_f32_32x32x16_bf16 v[144:159], a[136:139], v[192:195], v[144:159]
ds_read_b128 v[208:211], v9 offset:320
s_mov_b32 exec_lo, 0
s_mov_b32 exec_hi, 0xffff0000
ds_write_b128 v4, v[244:247] offset:1536
s_mov_b64 exec, -1
v_mfma_f32_32x32x16_bf16 v[128:143], a[28:31], v[196:199], v[128:143]
v_cvt_pk_bf16_f32 v240, v106, v107
v_cvt_pk_bf16_f32 v241, v122, v123
v_cvt_pk_bf16_f32 v242, v28, v29
v_cvt_pk_bf16_f32 v243, v44, v45
v_mfma_f32_32x32x16_bf16 v[144:159], a[140:143], v[196:199], v[144:159]
ds_read_b128 v[212:215], v9 offset:352
s_mov_b32 exec_lo, 0
s_mov_b32 exec_hi, 0xffff0000
ds_write_b128 v4, v[240:243] offset:2048
s_mov_b64 exec, -1
s_waitcnt lgkmcnt(5)
v_mfma_f32_32x32x16_bf16 v[128:143], a[32:35], v[200:203], v[128:143]
v_cvt_pk_bf16_f32 v244, v60, v61
v_cvt_pk_bf16_f32 v245, v76, v77
v_cvt_pk_bf16_f32 v246, v92, v93
v_cvt_pk_bf16_f32 v247, v108, v109
v_mfma_f32_32x32x16_bf16 v[144:159], a[144:147], v[200:203], v[144:159]
ds_read_b128 v[192:195], v9 offset:384
s_mov_b32 exec_lo, 0
s_mov_b32 exec_hi, 0xffff0000
ds_write_b128 v4, v[244:247] offset:2560
s_mov_b64 exec, -1
v_mfma_f32_32x32x16_bf16 v[128:143], a[36:39], v[204:207], v[128:143]
v_cvt_pk_bf16_f32 v240, v124, v125
v_cvt_pk_bf16_f32 v241, v30, v31
v_cvt_pk_bf16_f32 v242, v46, v47
v_cvt_pk_bf16_f32 v243, v62, v63
v_mfma_f32_32x32x16_bf16 v[144:159], a[148:151], v[204:207], v[144:159]
ds_read_b128 v[196:199], v9 offset:416
s_mov_b32 exec_lo, 0
s_mov_b32 exec_hi, 0xffff0000
ds_write_b128 v4, v[240:243] offset:3072
s_mov_b64 exec, -1
s_waitcnt lgkmcnt(5)
v_mfma_f32_32x32x16_bf16 v[128:143], a[40:43], v[208:211], v[128:143]
v_cvt_pk_bf16_f32 v244, v78, v79
v_cvt_pk_bf16_f32 v245, v94, v95
v_cvt_pk_bf16_f32 v246, v110, v111
v_cvt_pk_bf16_f32 v247, v126, v127
v_mfma_f32_32x32x16_bf16 v[144:159], a[152:155], v[208:211], v[144:159]
ds_read_b128 v[200:203], v9 offset:448
s_mov_b32 exec_lo, 0
s_mov_b32 exec_hi, 0xffff0000
ds_write_b128 v4, v[244:247] offset:3584
s_mov_b64 exec, -1
v_mfma_f32_32x32x16_bf16 v[128:143], a[44:47], v[212:215], v[128:143]
v_mfma_f32_32x32x16_bf16 v[144:159], a[156:159], v[212:215], v[144:159]
ds_read_b128 v[204:207], v9 offset:480
s_waitcnt lgkmcnt(4)
v_mfma_f32_32x32x16_bf16 v[128:143], a[48:51], v[192:195], v[128:143]
v_mfma_f32_32x32x16_bf16 v[144:159], a[160:163], v[192:195], v[144:159]
ds_read_b128 v[208:211], v9 offset:512
v_mfma_f32_32x32x16_bf16 v[128:143], a[52:55], v[196:199], v[128:143]
buffer_load_dwordx4 v[16:19], v7, s[12:15], s70 offen offset:0 sc1
v_mfma_f32_32x32x16_bf16 v[144:159], a[164:167], v[196:199], v[144:159]
ds_read_b128 v[212:215], v9 offset:544
s_waitcnt lgkmcnt(2)
v_mfma_f32_32x32x16_bf16 v[128:143], a[56:59], v[200:203], v[128:143]
ds_read_b128 v[192:195], v9 offset:576
buffer_load_dwordx4 v[20:23], v8, s[12:15], s70 offen offset:0 sc1
v_mfma_f32_32x32x16_bf16 v[128:143], a[60:63], v[204:207], v[128:143]
ds_read_b128 v[196:199], v9 offset:608
s_waitcnt lgkmcnt(2)
v_mfma_f32_32x32x16_bf16 v[128:143], a[64:67], v[208:211], v[128:143]
ds_read_b128 v[200:203], v9 offset:640
buffer_load_dwordx4 v[24:27], v7, s[12:15], s70 offen offset:2048 sc1
v_mfma_f32_32x32x16_bf16 v[128:143], a[68:71], v[212:215], v[128:143]
ds_read_b128 v[204:207], v9 offset:672
s_waitcnt lgkmcnt(2)
v_mfma_f32_32x32x16_bf16 v[128:143], a[72:75], v[192:195], v[128:143]
ds_read_b128 v[208:211], v9 offset:704
buffer_load_dwordx4 v[28:31], v8, s[12:15], s70 offen offset:2048 sc1
s_waitcnt vmcnt(57)
v_mfma_f32_32x32x16_bf16 v[128:143], a[76:79], v[196:199], v[128:143]
ds_read_b128 v[212:215], v9 offset:736
s_waitcnt lgkmcnt(2)
s_waitcnt vmcnt(55)
v_mfma_f32_32x32x16_bf16 v[128:143], a[80:83], v[200:203], v[128:143]
ds_read_b128 v[192:195], v9 offset:768
s_add_u32 s3, s65, 4096
buffer_load_dwordx4 v[32:35], v7, s[12:15], s3 offen offset:0 sc1
s_waitcnt vmcnt(54)
v_mfma_f32_32x32x16_bf16 v[128:143], a[84:87], v[204:207], v[128:143]
ds_read_b128 v[196:199], v9 offset:800
s_waitcnt lgkmcnt(2)
s_waitcnt vmcnt(52)
v_mfma_f32_32x32x16_bf16 v[128:143], a[88:91], v[208:211], v[128:143]
ds_read_b128 v[200:203], v9 offset:832
s_add_u32 s3, s65, 4096
buffer_load_dwordx4 v[36:39], v8, s[12:15], s3 offen offset:0 sc1
s_waitcnt vmcnt(51)
v_mfma_f32_32x32x16_bf16 v[128:143], a[92:95], v[212:215], v[128:143]
ds_read_b128 v[204:207], v9 offset:864
s_waitcnt lgkmcnt(2)
s_waitcnt vmcnt(49)
v_mfma_f32_32x32x16_bf16 v[128:143], a[96:99], v[192:195], v[128:143]
ds_read_b128 v[208:211], v9 offset:448
s_add_u32 s3, s65, 4096
buffer_load_dwordx4 v[40:43], v7, s[12:15], s3 offen offset:2048 sc1
s_waitcnt vmcnt(48)
v_mfma_f32_32x32x16_bf16 v[128:143], a[100:103], v[196:199], v[128:143]
ds_read_b128 v[212:215], v9 offset:480
s_waitcnt lgkmcnt(2)
s_waitcnt vmcnt(46)
v_mfma_f32_32x32x16_bf16 v[128:143], a[104:107], v[200:203], v[128:143]
ds_read_b128 v[192:195], v9 offset:512
s_add_u32 s3, s65, 4096
buffer_load_dwordx4 v[44:47], v8, s[12:15], s3 offen offset:2048 sc1
s_waitcnt vmcnt(45)
v_mfma_f32_32x32x16_bf16 v[128:143], a[108:111], v[204:207], v[128:143]
ds_read_b128 v[196:199], v9 offset:544
s_waitcnt lgkmcnt(2)
v_mfma_f32_32x32x16_bf16 v[144:159], a[168:171], v[208:211], v[144:159]
ds_read_b128 v[200:203], v9 offset:576
s_waitcnt vmcnt(28)
s_mov_b64 exec, 1
buffer_store_dword v12, off, s[12:15], s83 sc1
s_mov_b64 exec, -1
s_add_u32 s3, s66, 4096
buffer_load_dwordx4 v[48:51], v7, s[12:15], s3 offen offset:0 sc1
v_mfma_f32_32x32x16_bf16 v[144:159], a[172:175], v[212:215], v[144:159]
ds_read_b128 v[204:207], v9 offset:608
v_exp_f32 v216, v128
v_exp_f32 v217, v129
v_exp_f32 v218, v130
s_waitcnt lgkmcnt(2)
v_mfma_f32_32x32x16_bf16 v[144:159], a[176:179], v[192:195], v[144:159]
ds_read_b128 v[208:211], v9 offset:640
s_add_u32 s3, s66, 4096
buffer_load_dwordx4 v[52:55], v8, s[12:15], s3 offen offset:0 sc1
v_exp_f32 v219, v131
v_mfma_f32_32x32x16_bf16 v[144:159], a[180:183], v[196:199], v[144:159]
ds_read_b128 v[212:215], v9 offset:672
v_exp_f32 v220, v132
v_exp_f32 v221, v133
v_exp_f32 v222, v134
s_waitcnt lgkmcnt(2)
v_mfma_f32_32x32x16_bf16 v[144:159], a[184:187], v[200:203], v[144:159]
ds_read_b128 v[192:195], v9 offset:704
v_exp_f32 v223, v135
v_add_f32 v216, 1.0, v216
v_add_f32 v217, 1.0, v217
v_mfma_f32_32x32x16_bf16 v[144:159], a[188:191], v[204:207], v[144:159]
ds_read_b128 v[196:199], v9 offset:736
v_add_f32 v218, 1.0, v218
v_add_f32 v219, 1.0, v219
v_add_f32 v220, 1.0, v220
v_add_f32 v221, 1.0, v221
v_add_f32 v222, 1.0, v222
s_waitcnt lgkmcnt(2)
v_mfma_f32_32x32x16_bf16 v[144:159], a[192:195], v[208:211], v[144:159]
ds_read_b128 v[200:203], v9 offset:768
v_add_f32 v223, 1.0, v223
v_rcp_f32 v216, v216
v_rcp_f32 v217, v217
v_mfma_f32_32x32x16_bf16 v[144:159], a[196:199], v[212:215], v[144:159]
ds_read_b128 v[204:207], v9 offset:800
v_rcp_f32 v218, v218
v_rcp_f32 v219, v219
v_rcp_f32 v220, v220
s_waitcnt lgkmcnt(2)
v_mfma_f32_32x32x16_bf16 v[144:159], a[200:203], v[192:195], v[144:159]
ds_read_b128 v[208:211], v9 offset:832
v_rcp_f32 v221, v221
v_rcp_f32 v222, v222
v_mfma_f32_32x32x16_bf16 v[144:159], a[204:207], v[196:199], v[144:159]
ds_read_b128 v[212:215], v9 offset:864
v_rcp_f32 v223, v223
v_mul_f32 v216, v216, v128
v_mul_f32 v217, v217, v129
v_mul_f32 v218, v218, v130
s_waitcnt lgkmcnt(2)
v_mfma_f32_32x32x16_bf16 v[144:159], a[208:211], v[200:203], v[144:159]
ds_read_b128 v[192:195], v9 offset:29184
v_mul_f32 v219, v219, v131
v_mul_f32 v220, v220, v132
v_mul_f32 v221, v221, v133
v_mul_f32 v222, v222, v134
v_mfma_f32_32x32x16_bf16 v[144:159], a[212:215], v[204:207], v[144:159]
ds_read_b128 v[196:199], v9 offset:29216
v_mul_f32 v223, v223, v135
v_cvt_pk_bf16_f32 v96, v216, v217
v_cvt_pk_bf16_f32 v97, v218, v219
v_cvt_pk_bf16_f32 v98, v220, v221
v_cvt_pk_bf16_f32 v99, v222, v223
s_waitcnt lgkmcnt(2)
v_mfma_f32_32x32x16_bf16 v[144:159], a[216:219], v[208:211], v[144:159]
ds_read_b128 v[200:203], v9 offset:29248
buffer_store_dwordx4 v[96:99], v2, s[12:15], s72 offen offset:0 sc1
v_exp_f32 v224, v136
v_exp_f32 v225, v137
v_mfma_f32_32x32x16_bf16 v[144:159], a[220:223], v[212:215], v[144:159]
ds_read_b128 v[204:207], v9 offset:29280
v_exp_f32 v226, v138
v_exp_f32 v227, v139
v_exp_f32 v228, v140
t0e_38:
s_waitcnt lgkmcnt(2)
v_mfma_f32_32x32x16_bf16 v[160:175], a[0:3], v[192:195], 0
v_mfma_f32_32x32x16_bf16 v[176:191], a[112:115], v[192:195], 0
ds_read_b128 v[208:211], v9 offset:29312
s_add_u32 s3, s66, 4096
buffer_load_dwordx4 a[0:3], v7, s[12:15], s3 offen offset:2048 sc1
v_exp_f32 v229, v141
v_exp_f32 v230, v142
v_mfma_f32_32x32x16_bf16 v[160:175], a[4:7], v[196:199], v[160:175]
v_exp_f32 v231, v143
v_add_f32 v224, 1.0, v224
v_add_f32 v225, 1.0, v225
v_add_f32 v226, 1.0, v226
v_add_f32 v227, 1.0, v227
v_mfma_f32_32x32x16_bf16 v[176:191], a[116:119], v[196:199], v[176:191]
ds_read_b128 v[212:215], v9 offset:29344
s_add_u32 s3, s66, 4096
buffer_load_dwordx4 a[4:7], v8, s[12:15], s3 offen offset:2048 sc1
v_add_f32 v228, 1.0, v228
v_add_f32 v229, 1.0, v229
v_add_f32 v230, 1.0, v230
s_waitcnt lgkmcnt(2)
v_mfma_f32_32x32x16_bf16 v[160:175], a[8:11], v[200:203], v[160:175]
v_add_f32 v231, 1.0, v231
v_rcp_f32 v224, v224
v_rcp_f32 v225, v225
v_mfma_f32_32x32x16_bf16 v[176:191], a[120:123], v[200:203], v[176:191]
ds_read_b128 v[192:195], v9 offset:29376
s_add_u32 s3, s67, 4096
buffer_load_dwordx4 a[8:11], v7, s[12:15], s3 offen offset:0 sc1
v_rcp_f32 v226, v226
v_rcp_f32 v227, v227
v_mfma_f32_32x32x16_bf16 v[160:175], a[12:15], v[204:207], v[160:175]
v_rcp_f32 v228, v228
v_rcp_f32 v229, v229
v_rcp_f32 v230, v230
v_mfma_f32_32x32x16_bf16 v[176:191], a[124:127], v[204:207], v[176:191]
ds_read_b128 v[196:199], v9 offset:29408
s_add_u32 s3, s67, 4096
buffer_load_dwordx4 a[12:15], v8, s[12:15], s3 offen offset:0 sc1
v_rcp_f32 v231, v231
v_mul_f32 v224, v224, v136
s_waitcnt lgkmcnt(2)
v_mfma_f32_32x32x16_bf16 v[160:175], a[16:19], v[208:211], v[160:175]
v_mul_f32 v225, v225, v137
v_mul_f32 v226, v226, v138
v_mul_f32 v227, v227, v139
v_mul_f32 v228, v228, v140
v_mul_f32 v229, v229, v141
v_mfma_f32_32x32x16_bf16 v[176:191], a[128:131], v[208:211], v[176:191]
ds_read_b128 v[200:203], v9 offset:29440
s_add_u32 s3, s67, 4096
buffer_load_dwordx4 a[16:19], v7, s[12:15], s3 offen offset:2048 sc1
v_mul_f32 v230, v230, v142
v_mul_f32 v231, v231, v143
v_cvt_pk_bf16_f32 v100, v224, v225
v_mfma_f32_32x32x16_bf16 v[160:175], a[20:23], v[212:215], v[160:175]
v_cvt_pk_bf16_f32 v101, v226, v227
v_cvt_pk_bf16_f32 v102, v228, v229
v_cvt_pk_bf16_f32 v103, v230, v231
buffer_store_dwordx4 v[100:103], v2, s[12:15], s72 offen offset:2048 sc1
v_exp_f32 v216, v144
v_mfma_f32_32x32x16_bf16 v[176:191], a[132:135], v[212:215], v[176:191]
ds_read_b128 v[204:207], v9 offset:29472
v_exp_f32 v217, v145
v_exp_f32 v218, v146
v_exp_f32 v219, v147
s_waitcnt lgkmcnt(2)
v_mfma_f32_32x32x16_bf16 v[160:175], a[24:27], v[192:195], v[160:175]
s_add_u32 s3, s67, 4096
buffer_load_dwordx4 a[20:23], v8, s[12:15], s3 offen offset:2048 sc1
v_exp_f32 v220, v148
v_exp_f32 v221, v149
v_mfma_f32_32x32x16_bf16 v[176:191], a[136:139], v[192:195], v[176:191]
ds_read_b128 v[208:211], v9 offset:29504
v_exp_f32 v222, v150
v_exp_f32 v223, v151
v_add_f32 v216, 1.0, v216
v_mfma_f32_32x32x16_bf16 v[160:175], a[28:31], v[196:199], v[160:175]
s_add_u32 s3, s68, 4096
buffer_load_dwordx4 a[24:27], v7, s[12:15], s3 offen offset:0 sc1
v_add_f32 v217, 1.0, v217
v_add_f32 v218, 1.0, v218
v_add_f32 v219, 1.0, v219
v_add_f32 v220, 1.0, v220
v_mfma_f32_32x32x16_bf16 v[176:191], a[140:143], v[196:199], v[176:191]
ds_read_b128 v[212:215], v9 offset:29536
v_add_f32 v221, 1.0, v221
v_add_f32 v222, 1.0, v222
v_add_f32 v223, 1.0, v223
v_rcp_f32 v216, v216
s_waitcnt lgkmcnt(2)
v_mfma_f32_32x32x16_bf16 v[160:175], a[32:35], v[200:203], v[160:175]
s_add_u32 s3, s68, 4096
buffer_load_dwordx4 a[28:31], v8, s[12:15], s3 offen offset:0 sc1
v_rcp_f32 v217, v217
v_rcp_f32 v218, v218
v_mfma_f32_32x32x16_bf16 v[176:191], a[144:147], v[200:203], v[176:191]
ds_read_b128 v[192:195], v9 offset:29568
v_rcp_f32 v219, v219
v_rcp_f32 v220, v220
v_rcp_f32 v221, v221
v_mfma_f32_32x32x16_bf16 v[160:175], a[36:39], v[204:207], v[160:175]
s_add_u32 s3, s68, 4096
buffer_load_dwordx4 a[32:35], v7, s[12:15], s3 offen offset:2048 sc1
v_rcp_f32 v222, v222
v_rcp_f32 v223, v223
v_mfma_f32_32x32x16_bf16 v[176:191], a[148:151], v[204:207], v[176:191]
ds_read_b128 v[196:199], v9 offset:29600
v_mul_f32 v216, v216, v144
v_mul_f32 v217, v217, v145
v_mul_f32 v218, v218, v146
v_mul_f32 v219, v219, v147
v_mul_f32 v220, v220, v148
s_waitcnt lgkmcnt(2)
v_mfma_f32_32x32x16_bf16 v[160:175], a[40:43], v[208:211], v[160:175]
s_add_u32 s3, s68, 4096
buffer_load_dwordx4 a[36:39], v8, s[12:15], s3 offen offset:2048 sc1
v_mul_f32 v221, v221, v149
v_mul_f32 v222, v222, v150
v_mul_f32 v223, v223, v151
v_mfma_f32_32x32x16_bf16 v[176:191], a[152:155], v[208:211], v[176:191]
ds_read_b128 v[200:203], v9 offset:29632
v_cvt_pk_bf16_f32 v104, v216, v217
v_cvt_pk_bf16_f32 v105, v218, v219
v_cvt_pk_bf16_f32 v106, v220, v221
v_cvt_pk_bf16_f32 v107, v222, v223
buffer_store_dwordx4 v[104:107], v2, s[12:15], s79 offen offset:0 sc1
v_mfma_f32_32x32x16_bf16 v[160:175], a[44:47], v[212:215], v[160:175]
buffer_load_dword v14, v13, s[12:15], 0 offen sc1
v_exp_f32 v224, v152
v_exp_f32 v225, v153
v_exp_f32 v226, v154
v_mfma_f32_32x32x16_bf16 v[176:191], a[156:159], v[212:215], v[176:191]
ds_read_b128 v[204:207], v9 offset:29664
s_add_u32 s3, s69, 4096
buffer_load_dwordx4 a[40:43], v7, s[12:15], s3 offen offset:0 sc1
v_exp_f32 v227, v155
v_exp_f32 v228, v156
s_waitcnt lgkmcnt(2)
v_mfma_f32_32x32x16_bf16 v[160:175], a[48:51], v[192:195], v[160:175]
v_exp_f32 v229, v157
v_exp_f32 v230, v158
v_exp_f32 v231, v159
v_mfma_f32_32x32x16_bf16 v[176:191], a[160:163], v[192:195], v[176:191]
ds_read_b128 v[208:211], v9 offset:29696
s_add_u32 s3, s69, 4096
buffer_load_dwordx4 a[44:47], v8, s[12:15], s3 offen offset:0 sc1
v_add_f32 v224, 1.0, v224
v_add_f32 v225, 1.0, v225
v_add_f32 v226, 1.0, v226
v_mfma_f32_32x32x16_bf16 v[160:175], a[52:55], v[196:199], v[160:175]
v_add_f32 v227, 1.0, v227
v_add_f32 v228, 1.0, v228
v_add_f32 v229, 1.0, v229
v_add_f32 v230, 1.0, v230
v_add_f32 v231, 1.0, v231
v_rcp_f32 v224, v224
v_mfma_f32_32x32x16_bf16 v[176:191], a[164:167], v[196:199], v[176:191]
ds_read_b128 v[212:215], v9 offset:29728
s_add_u32 s3, s69, 4096
buffer_load_dwordx4 a[48:51], v7, s[12:15], s3 offen offset:2048 sc1
v_rcp_f32 v225, v225
v_rcp_f32 v226, v226
s_waitcnt lgkmcnt(2)
v_mfma_f32_32x32x16_bf16 v[160:175], a[56:59], v[200:203], v[160:175]
ds_read_b128 v[192:195], v9 offset:29760
v_rcp_f32 v227, v227
v_rcp_f32 v228, v228
v_mfma_f32_32x32x16_bf16 v[160:175], a[60:63], v[204:207], v[160:175]
ds_read_b128 v[196:199], v9 offset:29792
s_add_u32 s3, s69, 4096
buffer_load_dwordx4 a[52:55], v8, s[12:15], s3 offen offset:2048 sc1
v_rcp_f32 v229, v229
v_rcp_f32 v230, v230
s_waitcnt lgkmcnt(2)
v_mfma_f32_32x32x16_bf16 v[160:175], a[64:67], v[208:211], v[160:175]
ds_read_b128 v[200:203], v9 offset:29824
v_rcp_f32 v231, v231
v_mul_f32 v224, v224, v152
v_mul_f32 v225, v225, v153
v_mfma_f32_32x32x16_bf16 v[160:175], a[68:71], v[212:215], v[160:175]
ds_read_b128 v[204:207], v9 offset:29856
s_add_u32 s3, s70, 4096
buffer_load_dwordx4 a[56:59], v7, s[12:15], s3 offen offset:0 sc1
v_mul_f32 v226, v226, v154
v_mul_f32 v227, v227, v155
v_mul_f32 v228, v228, v156
s_waitcnt lgkmcnt(2)
v_mfma_f32_32x32x16_bf16 v[160:175], a[72:75], v[192:195], v[160:175]
ds_read_b128 v[208:211], v9 offset:29888
v_mul_f32 v229, v229, v157
v_mul_f32 v230, v230, v158
v_mul_f32 v231, v231, v159
v_cvt_pk_bf16_f32 v108, v224, v225
v_mfma_f32_32x32x16_bf16 v[160:175], a[76:79], v[196:199], v[160:175]
ds_read_b128 v[212:215], v9 offset:29920
s_add_u32 s3, s70, 4096
buffer_load_dwordx4 a[60:63], v8, s[12:15], s3 offen offset:0 sc1
v_cvt_pk_bf16_f32 v109, v226, v227
v_cvt_pk_bf16_f32 v110, v228, v229
v_cvt_pk_bf16_f32 v111, v230, v231
s_waitcnt lgkmcnt(2)
v_mfma_f32_32x32x16_bf16 v[160:175], a[80:83], v[200:203], v[160:175]
ds_read_b128 v[192:195], v9 offset:29952
buffer_store_dwordx4 v[108:111], v2, s[12:15], s79 offen offset:2048 sc1
v_mfma_f32_32x32x16_bf16 v[160:175], a[84:87], v[204:207], v[160:175]
ds_read_b128 v[196:199], v9 offset:29984
s_waitcnt lgkmcnt(2)
v_mfma_f32_32x32x16_bf16 v[160:175], a[88:91], v[208:211], v[160:175]
ds_read_b128 v[200:203], v9 offset:30016
s_waitcnt vmcnt(40)
ds_read_b128 a[112:115], v10 offset:0
s_add_u32 s3, s70, 4096
buffer_load_dwordx4 a[64:67], v7, s[12:15], s3 offen offset:2048 sc1
v_mfma_f32_32x32x16_bf16 v[160:175], a[92:95], v[212:215], v[160:175]
ds_read_b128 v[204:207], v9 offset:30048
ds_read_b128 a[116:119], v10 offset:1024
s_waitcnt lgkmcnt(4)
v_mfma_f32_32x32x16_bf16 v[160:175], a[96:99], v[192:195], v[160:175]
ds_read_b128 v[208:211], v9 offset:29632
ds_read_b128 a[120:123], v10 offset:2048
s_add_u32 s3, s70, 4096
buffer_load_dwordx4 a[68:71], v8, s[12:15], s3 offen offset:2048 sc1
v_mfma_f32_32x32x16_bf16 v[160:175], a[100:103], v[196:199], v[160:175]
ds_read_b128 v[212:215], v9 offset:29664
ds_read_b128 a[124:127], v10 offset:3072
s_waitcnt lgkmcnt(5)
v_mfma_f32_32x32x16_bf16 v[160:175], a[104:107], v[200:203], v[160:175]
ds_read_b128 v[192:195], v9 offset:29696
s_waitcnt vmcnt(9)
v_cmp_eq_u32 vcc, 0, v14
s_nop 0
s_cbranch_vccz fok_39
s_mov_b32 s3, 0
poll_40:
buffer_load_dword v14, v13, s[12:15], 0 offen sc1
s_waitcnt vmcnt(0)
v_cmp_eq_u32 vcc, 0, v14
s_nop 0
s_cbranch_vccz pollok_41
s_sleep 2
s_add_u32 s3, s3, 1
s_cmp_lt_u32 s3, 131072
s_cbranch_scc1 poll_40
pollok_41:
fok_39:
ds_read_b128 a[128:131], v10 offset:4096
v_mfma_f32_32x32x16_bf16 v[160:175], a[108:111], v[204:207], v[160:175]
ds_read_b128 v[196:199], v9 offset:29728
ds_read_b128 a[132:135], v10 offset:5120
s_waitcnt lgkmcnt(5)
v_mfma_f32_32x32x16_bf16 v[176:191], a[168:171], v[208:211], v[176:191]
ds_read_b128 v[200:203], v9 offset:29760
ds_read_b128 a[136:139], v10 offset:6144
v_mfma_f32_32x32x16_bf16 v[176:191], a[172:175], v[212:215], v[176:191]
ds_read_b128 v[204:207], v9 offset:29792
ds_read_b128 a[140:143], v10 offset:7168
s_nop 2
v_exp_f32 v128, v160
v_exp_f32 v129, v161
s_waitcnt lgkmcnt(5)
v_mfma_f32_32x32x16_bf16 v[176:191], a[176:179], v[192:195], v[176:191]
ds_read_b128 v[208:211], v9 offset:29824
ds_read_b128 a[144:147], v10 offset:8192
v_exp_f32 v130, v162
v_exp_f32 v131, v163
v_mfma_f32_32x32x16_bf16 v[176:191], a[180:183], v[196:199], v[176:191]
ds_read_b128 v[212:215], v9 offset:29856
ds_read_b128 a[148:151], v10 offset:9216
v_exp_f32 v132, v164
v_exp_f32 v133, v165
s_waitcnt lgkmcnt(5)
v_mfma_f32_32x32x16_bf16 v[176:191], a[184:187], v[200:203], v[176:191]
ds_read_b128 v[192:195], v9 offset:29888
ds_read_b128 a[152:155], v11 offset:0
buffer_load_dwordx4 v[56:59], v2, s[12:15], s73 offen offset:0 sc1
v_exp_f32 v134, v166
v_mfma_f32_32x32x16_bf16 v[176:191], a[188:191], v[204:207], v[176:191]
ds_read_b128 v[196:199], v9 offset:29920
ds_read_b128 a[156:159], v11 offset:1024
buffer_load_dwordx4 v[60:63], v2, s[12:15], s73 offen offset:2048 sc1
v_exp_f32 v135, v167
v_add_f32 v128, 1.0, v128
s_waitcnt lgkmcnt(5)
v_mfma_f32_32x32x16_bf16 v[176:191], a[192:195], v[208:211], v[176:191]
ds_read_b128 v[200:203], v9 offset:29952
ds_read_b128 a[160:163], v11 offset:2048
v_add_f32 v129, 1.0, v129
v_add_f32 v130, 1.0, v130
v_add_f32 v131, 1.0, v131
v_mfma_f32_32x32x16_bf16 v[176:191], a[196:199], v[212:215], v[176:191]
ds_read_b128 v[204:207], v9 offset:29984
ds_read_b128 a[164:167], v11 offset:3072
buffer_load_dwordx4 v[64:67], v2, s[12:15], s74 offen offset:0 sc1
v_add_f32 v132, 1.0, v132
v_add_f32 v133, 1.0, v133
v_add_f32 v134, 1.0, v134
s_waitcnt lgkmcnt(5)
v_mfma_f32_32x32x16_bf16 v[176:191], a[200:203], v[192:195], v[176:191]
ds_read_b128 v[208:211], v9 offset:30016
ds_read_b128 a[168:171], v11 offset:4096
buffer_load_dwordx4 v[68:71], v2, s[12:15], s74 offen offset:2048 sc1
v_add_f32 v135, 1.0, v135
v_rcp_f32 v128, v128
v_mfma_f32_32x32x16_bf16 v[176:191], a[204:207], v[196:199], v[176:191]
ds_read_b128 v[212:215], v9 offset:30048
ds_read_b128 a[172:175], v11 offset:5120
v_rcp_f32 v129, v129
v_rcp_f32 v130, v130
s_waitcnt lgkmcnt(5)
v_mfma_f32_32x32x16_bf16 v[176:191], a[208:211], v[200:203], v[176:191]
ds_read_b128 a[176:179], v11 offset:6144
buffer_load_dwordx4 v[72:75], v2, s[12:15], s75 offen offset:0 sc1
v_rcp_f32 v131, v131
v_rcp_f32 v132, v132
v_mfma_f32_32x32x16_bf16 v[176:191], a[212:215], v[204:207], v[176:191]
ds_read_b128 a[180:183], v11 offset:7168
buffer_load_dwordx4 v[76:79], v2, s[12:15], s75 offen offset:2048 sc1
v_rcp_f32 v133, v133
v_rcp_f32 v134, v134
s_waitcnt lgkmcnt(3)
v_mfma_f32_32x32x16_bf16 v[176:191], a[216:219], v[208:211], v[176:191]
ds_read_b128 a[184:187], v11 offset:8192
v_rcp_f32 v135, v135
v_mul_f32 v128, v128, v160
v_mul_f32 v129, v129, v161
v_mfma_f32_32x32x16_bf16 v[176:191], a[220:223], v[212:215], v[176:191]
ds_read_b128 a[188:191], v11 offset:9216
buffer_load_dwordx4 v[80:83], v2, s[12:15], s76 offen offset:0 sc1
v_mul_f32 v130, v130, v162
v_mul_f32 v131, v131, v163
v_mul_f32 v132, v132, v164
v_mul_f32 v133, v133, v165
s_barrier
s_xor_b32 s4, s62, 1
s_mul_i32 s4, s4, 6144
s_add_u32 s4, s4, 49152
v_add_u32 v9, s4, v2
s_xor_b32 s4, s62, 2
s_mul_i32 s4, s4, 6144
s_add_u32 s4, s4, 51200
v_add_u32 v10, s4, v2
s_xor_b32 s4, s62, 3
s_mul_i32 s4, s4, 6144
s_add_u32 s4, s4, 53248
v_add_u32 v11, s4, v2
v_mfma_f32_32x32x16_bf16 v[192:207], a[224:227], v[96:99], 0
v_mul_f32 v134, v134, v166
v_mul_f32 v135, v135, v167
v_cvt_pk_bf16_f32 v112, v128, v129
v_cvt_pk_bf16_f32 v113, v130, v131
v_cvt_pk_bf16_f32 v114, v132, v133
v_cvt_pk_bf16_f32 v115, v134, v135
v_mfma_f32_32x32x16_bf16 v[224:239], a[228:231], v[96:99], 0
buffer_load_dwordx4 v[84:87], v2, s[12:15], s76 offen offset:2048 sc1
buffer_store_dwordx4 v[112:115], v2, s[12:15], s72 offen offset:1024 sc1
v_exp_f32 v136, v168
v_exp_f32 v137, v169
v_mfma_f32_32x32x16_bf16 v[192:207], a[232:235], v[100:103], v[192:207]
v_exp_f32 v138, v170
v_exp_f32 v139, v171
v_exp_f32 v140, v172
v_mfma_f32_32x32x16_bf16 v[224:239], a[236:239], v[100:103], v[224:239]
buffer_load_dwordx4 v[88:91], v2, s[12:15], s77 offen offset:0 sc1
v_exp_f32 v141, v173
v_exp_f32 v142, v174
v_exp_f32 v143, v175
v_mfma_f32_32x32x16_bf16 v[192:207], a[240:243], v[104:107], v[192:207]
v_add_f32 v136, 1.0, v136
v_add_f32 v137, 1.0, v137
v_add_f32 v138, 1.0, v138
v_add_f32 v139, 1.0, v139
v_add_f32 v140, 1.0, v140
v_add_f32 v141, 1.0, v141
v_mfma_f32_32x32x16_bf16 v[224:239], a[244:247], v[104:107], v[224:239]
buffer_load_dwordx4 v[92:95], v2, s[12:15], s77 offen offset:2048 sc1
v_add_f32 v142, 1.0, v142
v_add_f32 v143, 1.0, v143
v_rcp_f32 v136, v136
v_rcp_f32 v137, v137
v_mfma_f32_32x32x16_bf16 v[192:207], a[248:251], v[108:111], v[192:207]
s_waitcnt vmcnt(9)
v_max_u32 v14, v56, v60
v_cmp_eq_u32 vcc, -1, v14
v_rcp_f32 v138, v138
v_rcp_f32 v139, v139
v_mfma_f32_32x32x16_bf16 v[224:239], a[252:255], v[108:111], v[224:239]
s_cbranch_vccz hok_42
s_mov_b32 s3, 0
poll_43:
buffer_load_dwordx4 v[56:59], v2, s[12:15], s73 offen offset:0 sc1
buffer_load_dwordx4 v[60:63], v2, s[12:15], s73 offen offset:2048 sc1
s_waitcnt vmcnt(0)
v_max_u32 v14, v56, v60
v_cmp_eq_u32 vcc, -1, v14
s_nop 0
s_cbranch_vccz pollok_44
s_add_u32 s3, s3, 1
s_cmp_lt_u32 s3, 131072
s_cbranch_scc1 poll_43
pollok_44:
hok_42:
buffer_load_dwordx4 v[144:147], v2, s[12:15], s78 offen offset:0 sc1
v_rcp_f32 v140, v140
v_rcp_f32 v141, v141
v_mfma_f32_32x32x16_bf16 v[192:207], a[112:115], v[56:59], v[192:207]
v_rcp_f32 v142, v142
v_rcp_f32 v143, v143
v_mul_f32 v136, v136, v168
v_mul_f32 v137, v137, v169
v_mfma_f32_32x32x16_bf16 v[224:239], a[116:119], v[56:59], v[224:239]
buffer_load_dwordx4 v[148:151], v2, s[12:15], s78 offen offset:2048 sc1
v_mul_f32 v138, v138, v170
v_mul_f32 v139, v139, v171
v_mul_f32 v140, v140, v172
v_mul_f32 v141, v141, v173
v_mul_f32 v142, v142, v174
v_mfma_f32_32x32x16_bf16 v[192:207], a[120:123], v[60:63], v[192:207]
s_waitcnt vmcnt(9)
v_max_u32 v14, v64, v68
v_cmp_eq_u32 vcc, -1, v14
v_mul_f32 v143, v143, v175
v_cvt_pk_bf16_f32 v116, v136, v137
v_cvt_pk_bf16_f32 v117, v138, v139
v_mfma_f32_32x32x16_bf16 v[224:239], a[124:127], v[60:63], v[224:239]
s_cbranch_vccz hok_45
s_mov_b32 s3, 0
poll_46:
buffer_load_dwordx4 v[64:67], v2, s[12:15], s74 offen offset:0 sc1
buffer_load_dwordx4 v[68:71], v2, s[12:15], s74 offen offset:2048 sc1
s_waitcnt vmcnt(0)
v_max_u32 v14, v64, v68
v_cmp_eq_u32 vcc, -1, v14
s_nop 0
s_cbranch_vccz pollok_47
s_add_u32 s3, s3, 1
s_cmp_lt_u32 s3, 131072
s_cbranch_scc1 poll_46
pollok_47:
hok_45:
v_cvt_pk_bf16_f32 v118, v140, v141
v_cvt_pk_bf16_f32 v119, v142, v143
buffer_store_dwordx4 v[116:119], v2, s[12:15], s72 offen offset:3072 sc1
v_exp_f32 v128, v176
v_mfma_f32_32x32x16_bf16 v[192:207], a[128:131], v[64:67], v[192:207]
v_exp_f32 v129, v177
v_exp_f32 v130, v178
v_exp_f32 v131, v179
v_mfma_f32_32x32x16_bf16 v[224:239], a[132:135], v[64:67], v[224:239]
v_exp_f32 v132, v180
v_exp_f32 v133, v181
v_exp_f32 v134, v182
v_mfma_f32_32x32x16_bf16 v[192:207], a[136:139], v[68:71], v[192:207]
s_waitcnt vmcnt(8)
v_max_u32 v14, v72, v76
v_cmp_eq_u32 vcc, -1, v14
buffer_load_dwordx4 v[152:155], v2, s[12:15], s87 offen offset:0 sc1
v_exp_f32 v135, v183
v_mfma_f32_32x32x16_bf16 v[224:239], a[140:143], v[68:71], v[224:239]
s_cbranch_vccz hok_48
s_mov_b32 s3, 0
poll_49:
buffer_load_dwordx4 v[72:75], v2, s[12:15], s75 offen offset:0 sc1
buffer_load_dwordx4 v[76:79], v2, s[12:15], s75 offen offset:2048 sc1
s_waitcnt vmcnt(0)
v_max_u32 v14, v72, v76
v_cmp_eq_u32 vcc, -1, v14
s_nop 0
s_cbranch_vccz pollok_50
s_add_u32 s3, s3, 1
s_cmp_lt_u32 s3, 131072
s_cbranch_scc1 poll_49
pollok_50:
hok_48:
buffer_load_dwordx4 v[156:159], v2, s[12:15], s87 offen offset:2048 sc1
v_add_f32 v128, 1.0, v128
v_add_f32 v129, 1.0, v129
v_add_f32 v130, 1.0, v130
v_add_f32 v131, 1.0, v131
v_mfma_f32_32x32x16_bf16 v[192:207], a[144:147], v[72:75], v[192:207]
v_add_f32 v132, 1.0, v132
v_add_f32 v133, 1.0, v133
v_add_f32 v134, 1.0, v134
v_add_f32 v135, 1.0, v135
v_rcp_f32 v128, v128
v_mfma_f32_32x32x16_bf16 v[224:239], a[148:151], v[72:75], v[224:239]
buffer_load_dwordx4 v[56:59], v2, s[12:15], s88 offen offset:0 sc1
v_rcp_f32 v129, v129
v_rcp_f32 v130, v130
v_rcp_f32 v131, v131
v_mfma_f32_32x32x16_bf16 v[192:207], a[152:155], v[76:79], v[192:207]
s_waitcnt vmcnt(9)
v_max_u32 v14, v80, v84
v_cmp_eq_u32 vcc, -1, v14
buffer_load_dwordx4 v[160:163], v2, s[12:15], s88 offen offset:2048 sc1
v_rcp_f32 v132, v132
v_mfma_f32_32x32x16_bf16 v[224:239], a[156:159], v[76:79], v[224:239]
s_cbranch_vccz hok_51
s_mov_b32 s3, 0
poll_52:
buffer_load_dwordx4 v[80:83], v2, s[12:15], s76 offen offset:0 sc1
buffer_load_dwordx4 v[84:87], v2, s[12:15], s76 offen offset:2048 sc1
s_waitcnt vmcnt(0)
v_max_u32 v14, v80, v84
v_cmp_eq_u32 vcc, -1, v14
s_nop 0
s_cbranch_vccz pollok_53
s_add_u32 s3, s3, 1
s_cmp_lt_u32 s3, 131072
s_cbranch_scc1 poll_52
pollok_53:
hok_51:
v_rcp_f32 v133, v133
v_rcp_f32 v134, v134
v_rcp_f32 v135, v135
v_mfma_f32_32x32x16_bf16 v[192:207], a[160:163], v[80:83], v[192:207]
buffer_load_dwordx4 v[164:167], v2, s[12:15], s89 offen offset:0 sc1
v_mul_f32 v128, v128, v176
v_mul_f32 v129, v129, v177
v_mul_f32 v130, v130, v178
v_mul_f32 v131, v131, v179
v_mul_f32 v132, v132, v180
v_mfma_f32_32x32x16_bf16 v[224:239], a[164:167], v[80:83], v[224:239]
buffer_load_dwordx4 v[168:171], v2, s[12:15], s89 offen offset:2048 sc1
v_mul_f32 v133, v133, v181
v_mul_f32 v134, v134, v182
v_mul_f32 v135, v135, v183
v_cvt_pk_bf16_f32 v120, v128, v129
v_cvt_pk_bf16_f32 v121, v130, v131
v_mfma_f32_32x32x16_bf16 v[192:207], a[168:171], v[84:87], v[192:207]
s_waitcnt vmcnt(9)
v_max_u32 v14, v88, v92
v_cmp_eq_u32 vcc, -1, v14
v_cvt_pk_bf16_f32 v122, v132, v133
v_cvt_pk_bf16_f32 v123, v134, v135
buffer_store_dwordx4 v[120:123], v2, s[12:15], s79 offen offset:1024 sc1
s_waitcnt lgkmcnt(4)
v_mfma_f32_32x32x16_bf16 v[224:239], a[172:175], v[84:87], v[224:239]
s_cbranch_vccz hok_54
s_mov_b32 s3, 0
poll_55:
buffer_load_dwordx4 v[88:91], v2, s[12:15], s77 offen offset:0 sc1
buffer_load_dwordx4 v[92:95], v2, s[12:15], s77 offen offset:2048 sc1
s_waitcnt vmcnt(0)
v_max_u32 v14, v88, v92
v_cmp_eq_u32 vcc, -1, v14
s_nop 0
s_cbranch_vccz pollok_56
s_add_u32 s3, s3, 1
s_cmp_lt_u32 s3, 131072
s_cbranch_scc1 poll_55
pollok_56:
hok_54:
v_exp_f32 v136, v184
v_exp_f32 v137, v185
v_exp_f32 v138, v186
s_waitcnt lgkmcnt(3)
v_mfma_f32_32x32x16_bf16 v[192:207], a[176:179], v[88:91], v[192:207]
buffer_load_dwordx4 v[172:175], v2, s[12:15], s90 offen offset:0 sc1
v_exp_f32 v139, v187
v_exp_f32 v140, v188
v_exp_f32 v141, v189
s_waitcnt lgkmcnt(2)
v_mfma_f32_32x32x16_bf16 v[224:239], a[180:183], v[88:91], v[224:239]
buffer_load_dwordx4 v[60:63], v2, s[12:15], s90 offen offset:2048 sc1
v_exp_f32 v142, v190
v_exp_f32 v143, v191
v_add_f32 v136, 1.0, v136
s_waitcnt lgkmcnt(1)
v_mfma_f32_32x32x16_bf16 v[192:207], a[184:187], v[92:95], v[192:207]
s_waitcnt vmcnt(10)
v_max_u32 v14, v144, v148
v_cmp_eq_u32 vcc, -1, v14
v_add_f32 v137, 1.0, v137
v_add_f32 v138, 1.0, v138
v_add_f32 v139, 1.0, v139
s_waitcnt lgkmcnt(0)
v_mfma_f32_32x32x16_bf16 v[224:239], a[188:191], v[92:95], v[224:239]
s_cbranch_vccz hok_57
s_mov_b32 s3, 0
poll_58:
buffer_load_dwordx4 v[144:147], v2, s[12:15], s78 offen offset:0 sc1
buffer_load_dwordx4 v[148:151], v2, s[12:15], s78 offen offset:2048 sc1
s_waitcnt vmcnt(0)
v_max_u32 v14, v144, v148
v_cmp_eq_u32 vcc, -1, v14
s_nop 0
s_cbranch_vccz pollok_59
s_add_u32 s3, s3, 1
s_cmp_lt_u32 s3, 131072
s_cbranch_scc1 poll_58
pollok_59:
hok_57:
buffer_load_dwordx4 v[64:67], v2, s[12:15], s91 offen offset:0 sc1
v_add_f32 v140, 1.0, v140
v_add_f32 v141, 1.0, v141
v_add_f32 v142, 1.0, v142
v_add_f32 v143, 1.0, v143
v_mfma_f32_32x32x16_bf16 v[192:207], v[16:19], v[144:147], v[192:207]
v_rcp_f32 v136, v136
v_rcp_f32 v137, v137
v_rcp_f32 v138, v138
v_mfma_f32_32x32x16_bf16 v[224:239], v[20:23], v[144:147], v[224:239]
buffer_load_dwordx4 v[68:71], v2, s[12:15], s91 offen offset:2048 sc1
v_rcp_f32 v139, v139
v_rcp_f32 v140, v140
v_rcp_f32 v141, v141
v_mfma_f32_32x32x16_bf16 v[192:207], v[24:27], v[148:151], v[192:207]
s_waitcnt vmcnt(9)
v_max_u32 v14, v152, v156
v_cmp_eq_u32 vcc, -1, v14
v_rcp_f32 v142, v142
v_rcp_f32 v143, v143
v_mfma_f32_32x32x16_bf16 v[224:239], v[28:31], v[148:151], v[224:239]
s_cbranch_vccz hok_60
s_mov_b32 s3, 0
poll_61:
buffer_load_dwordx4 v[152:155], v2, s[12:15], s87 offen offset:0 sc1
buffer_load_dwordx4 v[156:159], v2, s[12:15], s87 offen offset:2048 sc1
s_waitcnt vmcnt(0)
v_max_u32 v14, v152, v156
v_cmp_eq_u32 vcc, -1, v14
s_nop 0
s_cbranch_vccz pollok_62
s_add_u32 s3, s3, 1
s_cmp_lt_u32 s3, 131072
s_cbranch_scc1 poll_61
pollok_62:
hok_60:
buffer_load_dwordx4 v[72:75], v2, s[12:15], s92 offen offset:0 sc1
v_mul_f32 v136, v136, v184
v_mul_f32 v137, v137, v185
v_mul_f32 v138, v138, v186
v_mul_f32 v139, v139, v187
v_mfma_f32_32x32x16_bf16 v[192:207], v[32:35], v[152:155], v[192:207]
v_mul_f32 v140, v140, v188
v_mul_f32 v141, v141, v189
v_mul_f32 v142, v142, v190
v_mul_f32 v143, v143, v191
v_cvt_pk_bf16_f32 v124, v136, v137
v_cvt_pk_bf16_f32 v125, v138, v139
v_mfma_f32_32x32x16_bf16 v[224:239], v[36:39], v[152:155], v[224:239]
buffer_load_dwordx4 v[76:79], v2, s[12:15], s92 offen offset:2048 sc1
v_cvt_pk_bf16_f32 v126, v140, v141
v_cvt_pk_bf16_f32 v127, v142, v143
buffer_store_dwordx4 v[124:127], v2, s[12:15], s79 offen offset:3072 sc1
v_mfma_f32_32x32x16_bf16 v[192:207], v[40:43], v[156:159], v[192:207]
s_waitcnt vmcnt(10)
v_max_u32 v14, v56, v160
v_cmp_eq_u32 vcc, -1, v14
v_mfma_f32_32x32x16_bf16 v[224:239], v[44:47], v[156:159], v[224:239]
s_cbranch_vccz hok_63
s_mov_b32 s3, 0
poll_64:
buffer_load_dwordx4 v[56:59], v2, s[12:15], s88 offen offset:0 sc1
buffer_load_dwordx4 v[160:163], v2, s[12:15], s88 offen offset:2048 sc1
s_waitcnt vmcnt(0)
v_max_u32 v14, v56, v160
v_cmp_eq_u32 vcc, -1, v14
s_nop 0
s_cbranch_vccz pollok_65
s_add_u32 s3, s3, 1
s_cmp_lt_u32 s3, 131072
s_cbranch_scc1 poll_64
pollok_65:
hok_63:
v_mfma_f32_32x32x16_bf16 v[192:207], v[48:51], v[56:59], v[192:207]
v_mfma_f32_32x32x16_bf16 v[224:239], v[52:55], v[56:59], v[224:239]
v_mfma_f32_32x32x16_bf16 v[192:207], a[0:3], v[160:163], v[192:207]
s_waitcnt vmcnt(8)
v_max_u32 v14, v164, v168
v_cmp_eq_u32 vcc, -1, v14
v_mfma_f32_32x32x16_bf16 v[224:239], a[4:7], v[160:163], v[224:239]
s_cbranch_vccz hok_66
s_mov_b32 s3, 0
poll_67:
buffer_load_dwordx4 v[164:167], v2, s[12:15], s89 offen offset:0 sc1
buffer_load_dwordx4 v[168:171], v2, s[12:15], s89 offen offset:2048 sc1
s_waitcnt vmcnt(0)
v_max_u32 v14, v164, v168
v_cmp_eq_u32 vcc, -1, v14
s_nop 0
s_cbranch_vccz pollok_68
s_add_u32 s3, s3, 1
s_cmp_lt_u32 s3, 131072
s_cbranch_scc1 poll_67
pollok_68:
hok_66:
v_mfma_f32_32x32x16_bf16 v[192:207], a[8:11], v[164:167], v[192:207]
v_mfma_f32_32x32x16_bf16 v[224:239], a[12:15], v[164:167], v[224:239]
v_mfma_f32_32x32x16_bf16 v[192:207], a[16:19], v[168:171], v[192:207]
s_waitcnt vmcnt(5)
v_max_u32 v14, v172, v60
v_cmp_eq_u32 vcc, -1, v14
v_mfma_f32_32x32x16_bf16 v[224:239], a[20:23], v[168:171], v[224:239]
s_cbranch_vccz hok_69
s_mov_b32 s3, 0
poll_70:
buffer_load_dwordx4 v[172:175], v2, s[12:15], s90 offen offset:0 sc1
buffer_load_dwordx4 v[60:63], v2, s[12:15], s90 offen offset:2048 sc1
s_waitcnt vmcnt(0)
v_max_u32 v14, v172, v60
v_cmp_eq_u32 vcc, -1, v14
s_nop 0
s_cbranch_vccz pollok_71
s_add_u32 s3, s3, 1
s_cmp_lt_u32 s3, 131072
s_cbranch_scc1 poll_70
pollok_71:
hok_69:
v_mfma_f32_32x32x16_bf16 v[192:207], a[24:27], v[172:175], v[192:207]
v_mfma_f32_32x32x16_bf16 v[224:239], a[28:31], v[172:175], v[224:239]
v_mfma_f32_32x32x16_bf16 v[192:207], a[32:35], v[60:63], v[192:207]
s_waitcnt vmcnt(3)
v_max_u32 v14, v64, v68
v_cmp_eq_u32 vcc, -1, v14
v_mfma_f32_32x32x16_bf16 v[224:239], a[36:39], v[60:63], v[224:239]
s_cbranch_vccz hok_72
s_mov_b32 s3, 0
poll_73:
buffer_load_dwordx4 v[64:67], v2, s[12:15], s91 offen offset:0 sc1
buffer_load_dwordx4 v[68:71], v2, s[12:15], s91 offen offset:2048 sc1
s_waitcnt vmcnt(0)
v_max_u32 v14, v64, v68
v_cmp_eq_u32 vcc, -1, v14
s_nop 0
s_cbranch_vccz pollok_74
s_add_u32 s3, s3, 1
s_cmp_lt_u32 s3, 131072
s_cbranch_scc1 poll_73
pollok_74:
hok_72:
buffer_load_dwordx4 v[80:83], v2, s[12:15], s73 offen offset:1024 sc1
v_mfma_f32_32x32x16_bf16 v[192:207], a[40:43], v[64:67], v[192:207]
buffer_load_dwordx4 v[84:87], v2, s[12:15], s73 offen offset:3072 sc1
v_mfma_f32_32x32x16_bf16 v[224:239], a[44:47], v[64:67], v[224:239]
buffer_load_dwordx4 v[88:91], v2, s[12:15], s74 offen offset:1024 sc1
v_mfma_f32_32x32x16_bf16 v[192:207], a[48:51], v[68:71], v[192:207]
s_waitcnt vmcnt(4)
v_max_u32 v14, v72, v76
v_cmp_eq_u32 vcc, -1, v14
buffer_load_dwordx4 v[92:95], v2, s[12:15], s74 offen offset:3072 sc1
v_mfma_f32_32x32x16_bf16 v[224:239], a[52:55], v[68:71], v[224:239]
s_cbranch_vccz hok_75
s_mov_b32 s3, 0
poll_76:
buffer_load_dwordx4 v[72:75], v2, s[12:15], s92 offen offset:0 sc1
buffer_load_dwordx4 v[76:79], v2, s[12:15], s92 offen offset:2048 sc1
s_waitcnt vmcnt(0)
v_max_u32 v14, v72, v76
v_cmp_eq_u32 vcc, -1, v14
s_nop 0
s_cbranch_vccz pollok_77
s_add_u32 s3, s3, 1
s_cmp_lt_u32 s3, 131072
s_cbranch_scc1 poll_76
pollok_77:
hok_75:
v_mfma_f32_32x32x16_bf16 v[192:207], a[56:59], v[72:75], v[192:207]
buffer_load_dwordx4 v[144:147], v2, s[12:15], s75 offen offset:1024 sc1
v_mfma_f32_32x32x16_bf16 v[224:239], a[60:63], v[72:75], v[224:239]
buffer_load_dwordx4 v[148:151], v2, s[12:15], s75 offen offset:3072 sc1
v_mfma_f32_32x32x16_bf16 v[192:207], a[64:67], v[76:79], v[192:207]
v_mfma_f32_32x32x16_bf16 v[224:239], a[68:71], v[76:79], v[224:239]
buffer_load_dwordx4 v[176:179], v2, s[12:15], s76 offen offset:1024 sc1
v_mfma_f32_32x32x16_bf16 v[208:223], a[224:227], v[112:115], 0
v_mfma_f32_32x32x16_bf16 v[240:255], a[228:231], v[112:115], 0
buffer_load_dwordx4 v[180:183], v2, s[12:15], s76 offen offset:3072 sc1
v_mfma_f32_32x32x16_bf16 v[208:223], a[232:235], v[116:119], v[208:223]
v_mfma_f32_32x32x16_bf16 v[240:255], a[236:239], v[116:119], v[240:255]
buffer_load_dwordx4 v[184:187], v2, s[12:15], s77 offen offset:1024 sc1
v_mfma_f32_32x32x16_bf16 v[208:223], a[240:243], v[120:123], v[208:223]
v_mfma_f32_32x32x16_bf16 v[240:255], a[244:247], v[120:123], v[240:255]
buffer_load_dwordx4 v[188:191], v2, s[12:15], s77 offen offset:3072 sc1
v_mfma_f32_32x32x16_bf16 v[208:223], a[248:251], v[124:127], v[208:223]
s_waitcnt vmcnt(8)
v_max_u32 v14, v80, v84
v_cmp_eq_u32 vcc, -1, v14
v_mfma_f32_32x32x16_bf16 v[240:255], a[252:255], v[124:127], v[240:255]
s_cbranch_vccz hok_78
s_mov_b32 s3, 0
poll_79:
buffer_load_dwordx4 v[80:83], v2, s[12:15], s73 offen offset:1024 sc1
buffer_load_dwordx4 v[84:87], v2, s[12:15], s73 offen offset:3072 sc1
s_waitcnt vmcnt(0)
v_max_u32 v14, v80, v84
v_cmp_eq_u32 vcc, -1, v14
s_nop 0
s_cbranch_vccz pollok_80
s_add_u32 s3, s3, 1
s_cmp_lt_u32 s3, 131072
s_cbranch_scc1 poll_79
pollok_80:
hok_78:
buffer_load_dwordx4 v[152:155], v2, s[12:15], s78 offen offset:1024 sc1
v_mfma_f32_32x32x16_bf16 v[208:223], a[112:115], v[80:83], v[208:223]
ds_write_b128 v9, v[200:203] offset:0
v_mfma_f32_32x32x16_bf16 v[240:255], a[116:119], v[80:83], v[240:255]
buffer_load_dwordx4 v[156:159], v2, s[12:15], s78 offen offset:3072 sc1
ds_write_b128 v9, v[204:207] offset:1024
v_mfma_f32_32x32x16_bf16 v[208:223], a[120:123], v[84:87], v[208:223]
s_waitcnt vmcnt(8)
v_max_u32 v14, v88, v92
v_cmp_eq_u32 vcc, -1, v14
v_mfma_f32_32x32x16_bf16 v[240:255], a[124:127], v[84:87], v[240:255]
s_cbranch_vccz hok_81
s_mov_b32 s3, 0
poll_82:
buffer_load_dwordx4 v[88:91], v2, s[12:15], s74 offen offset:1024 sc1
buffer_load_dwordx4 v[92:95], v2, s[12:15], s74 offen offset:3072 sc1
s_waitcnt vmcnt(0)
v_max_u32 v14, v88, v92
v_cmp_eq_u32 vcc, -1, v14
s_nop 0
s_cbranch_vccz pollok_83
s_add_u32 s3, s3, 1
s_cmp_lt_u32 s3, 131072
s_cbranch_scc1 poll_82
pollok_83:
hok_81:
ds_write_b128 v10, v[224:227] offset:0
v_mfma_f32_32x32x16_bf16 v[208:223], a[128:131], v[88:91], v[208:223]
ds_write_b128 v10, v[228:231] offset:1024
v_mfma_f32_32x32x16_bf16 v[240:255], a[132:135], v[88:91], v[240:255]
buffer_load_dwordx4 v[56:59], v2, s[12:15], s87 offen offset:1024 sc1
ds_write_b128 v11, v[232:235] offset:0
v_mfma_f32_32x32x16_bf16 v[208:223], a[136:139], v[92:95], v[208:223]
s_waitcnt vmcnt(7)
v_max_u32 v14, v144, v148
v_cmp_eq_u32 vcc, -1, v14
buffer_load_dwordx4 v[160:163], v2, s[12:15], s87 offen offset:3072 sc1
v_mfma_f32_32x32x16_bf16 v[240:255], a[140:143], v[92:95], v[240:255]
s_cbranch_vccz hok_84
s_mov_b32 s3, 0
poll_85:
buffer_load_dwordx4 v[144:147], v2, s[12:15], s75 offen offset:1024 sc1
buffer_load_dwordx4 v[148:151], v2, s[12:15], s75 offen offset:3072 sc1
s_waitcnt vmcnt(0)
v_max_u32 v14, v144, v148
v_cmp_eq_u32 vcc, -1, v14
s_nop 0
s_cbranch_vccz pollok_86
s_add_u32 s3, s3, 1
s_cmp_lt_u32 s3, 131072
s_cbranch_scc1 poll_85
pollok_86:
hok_84:
ds_write_b128 v11, v[236:239] offset:1024
s_mul_i32 s6, s62, 6144
v_mfma_f32_32x32x16_bf16 v[208:223], a[144:147], v[144:147], v[208:223]
buffer_load_dwordx4 v[164:167], v2, s[12:15], s88 offen offset:1024 sc1
s_add_u32 s6, s6, 49152
v_add_u32 v5, s6, v2
v_lshrrev_b32 v132, 5, v1
v_and_b32 v7, 31, v1
s_lshl_b32 s6, s62, 10
v_mfma_f32_32x32x16_bf16 v[240:255], a[148:151], v[144:147], v[240:255]
buffer_load_dwordx4 v[168:171], v2, s[12:15], s88 offen offset:3072 sc1
s_add_u32 s6, s6, 114688
v_lshlrev_b32 v6, 4, v7
v_lshl_add_u32 v6, v132, 3, v6
v_add_u32 v6, s6, v6
s_lshl_b32 s6, s62, 6
v_mfma_f32_32x32x16_bf16 v[208:223], a[152:155], v[148:151], v[208:223]
s_waitcnt vmcnt(8)
v_max_u32 v14, v176, v180
v_cmp_eq_u32 vcc, -1, v14
s_add_u32 s6, s6, 47104
v_lshl_add_u32 v133, v132, 4, s6
ds_read_b128 v[96:99], v133
v_mfma_f32_32x32x16_bf16 v[240:255], a[156:159], v[148:151], v[240:255]
s_cbranch_vccz hok_87
s_mov_b32 s3, 0
poll_88:
buffer_load_dwordx4 v[176:179], v2, s[12:15], s76 offen offset:1024 sc1
buffer_load_dwordx4 v[180:183], v2, s[12:15], s76 offen offset:3072 sc1
s_waitcnt vmcnt(0)
v_max_u32 v14, v176, v180
v_cmp_eq_u32 vcc, -1, v14
s_nop 0
s_cbranch_vccz pollok_89
s_add_u32 s3, s3, 1
s_cmp_lt_u32 s3, 131072
s_cbranch_scc1 poll_88
pollok_89:
hok_87:
buffer_load_dwordx4 v[172:175], v2, s[12:15], s89 offen offset:1024 sc1
ds_read_b128 v[100:103], v133 offset:32
v_and_b32 v133, 3, v7
v_lshlrev_b32 v133, 5, v133
v_lshrrev_b32 v7, 2, v7
v_mfma_f32_32x32x16_bf16 v[208:223], a[160:163], v[176:179], v[208:223]
v_add3_u32 v7, v7, v133, s97
v_mul_u32_u24 v7, 896, v7
v_lshl_add_u32 v7, v132, 4, v7
s_lshl_b32 s4, s63, 7
s_lshl_b32 s5, s62, 5
s_add_u32 s4, s4, s5
v_mfma_f32_32x32x16_bf16 v[240:255], a[164:167], v[176:179], v[240:255]
buffer_load_dwordx4 v[60:63], v2, s[12:15], s89 offen offset:3072 sc1
s_add_u32 s5, s4, 7168
s_mov_b32 s28, s56
s_and_b32 s29, s57, 0xffff
s_mov_b32 s30, 1835008
s_mov_b32 s31, 0x20000
v_mfma_f32_32x32x16_bf16 v[208:223], a[168:171], v[180:183], v[208:223]
s_waitcnt vmcnt(8)
v_max_u32 v14, v184, v188
v_cmp_eq_u32 vcc, -1, v14
v_mfma_f32_32x32x16_bf16 v[240:255], a[172:175], v[180:183], v[240:255]
s_cbranch_vccz hok_90
s_mov_b32 s3, 0
poll_91:
buffer_load_dwordx4 v[184:187], v2, s[12:15], s77 offen offset:1024 sc1
buffer_load_dwordx4 v[188:191], v2, s[12:15], s77 offen offset:3072 sc1
s_waitcnt vmcnt(0)
v_max_u32 v14, v184, v188
v_cmp_eq_u32 vcc, -1, v14
s_nop 0
s_cbranch_vccz pollok_92
s_add_u32 s3, s3, 1
s_cmp_lt_u32 s3, 131072
s_cbranch_scc1 poll_91
pollok_92:
hok_90:
buffer_load_dwordx4 v[64:67], v2, s[12:15], s90 offen offset:1024 sc1
v_mfma_f32_32x32x16_bf16 v[208:223], a[176:179], v[184:187], v[208:223]
v_mfma_f32_32x32x16_bf16 v[240:255], a[180:183], v[184:187], v[240:255]
buffer_load_dwordx4 v[68:71], v2, s[12:15], s90 offen offset:3072 sc1
s_waitcnt lgkmcnt(0)
s_barrier
v_mfma_f32_32x32x16_bf16 v[208:223], a[184:187], v[188:191], v[208:223]
s_waitcnt vmcnt(8)
v_max_u32 v14, v152, v156
v_cmp_eq_u32 vcc, -1, v14
ds_read_b128 v[104:107], v5 offset:0
ds_read_b128 v[108:111], v5 offset:1024
ds_read_b128 v[112:115], v5 offset:2048
v_mfma_f32_32x32x16_bf16 v[240:255], a[188:191], v[188:191], v[240:255]
s_cbranch_vccz hok_93
s_mov_b32 s3, 0
poll_94:
buffer_load_dwordx4 v[152:155], v2, s[12:15], s78 offen offset:1024 sc1
buffer_load_dwordx4 v[156:159], v2, s[12:15], s78 offen offset:3072 sc1
s_waitcnt vmcnt(0)
v_max_u32 v14, v152, v156
v_cmp_eq_u32 vcc, -1, v14
s_nop 0
s_cbranch_vccz pollok_95
s_add_u32 s3, s3, 1
s_cmp_lt_u32 s3, 131072
s_cbranch_scc1 poll_94
pollok_95:
hok_93:
buffer_load_dwordx4 v[72:75], v2, s[12:15], s91 offen offset:1024 sc1
ds_read_b128 v[116:119], v5 offset:3072
ds_read_b128 v[120:123], v5 offset:4096
ds_read_b128 v[124:127], v5 offset:5120
ds_read_b64 v[128:129], v6 offset:0
v_mfma_f32_32x32x16_bf16 v[208:223], v[16:19], v[152:155], v[208:223]
ds_read_b64 v[130:131], v6 offset:512
v_mfma_f32_32x32x16_bf16 v[240:255], v[20:23], v[152:155], v[240:255]
buffer_load_dwordx4 v[76:79], v2, s[12:15], s91 offen offset:3072 sc1
v_mfma_f32_32x32x16_bf16 v[208:223], v[24:27], v[156:159], v[208:223]
s_waitcnt vmcnt(8)
v_max_u32 v14, v56, v160
v_cmp_eq_u32 vcc, -1, v14
v_mfma_f32_32x32x16_bf16 v[240:255], v[28:31], v[156:159], v[240:255]
s_cbranch_vccz hok_96
s_mov_b32 s3, 0
poll_97:
buffer_load_dwordx4 v[56:59], v2, s[12:15], s87 offen offset:1024 sc1
buffer_load_dwordx4 v[160:163], v2, s[12:15], s87 offen offset:3072 sc1
s_waitcnt vmcnt(0)
v_max_u32 v14, v56, v160
v_cmp_eq_u32 vcc, -1, v14
s_nop 0
s_cbranch_vccz pollok_98
s_add_u32 s3, s3, 1
s_cmp_lt_u32 s3, 131072
s_cbranch_scc1 poll_97
pollok_98:
hok_96:
buffer_load_dwordx4 v[80:83], v2, s[12:15], s92 offen offset:1024 sc1
v_mfma_f32_32x32x16_bf16 v[208:223], v[32:35], v[56:59], v[208:223]
s_waitcnt lgkmcnt(1)
v_lshlrev_b32 v132, 16, v128
v_and_b32 v133, s99, v128
v_lshlrev_b32 v134, 16, v129
v_and_b32 v135, s99, v129
s_waitcnt lgkmcnt(0)
v_lshlrev_b32 v136, 16, v130
v_and_b32 v137, s99, v130
v_mfma_f32_32x32x16_bf16 v[240:255], v[36:39], v[56:59], v[240:255]
buffer_load_dwordx4 v[84:87], v2, s[12:15], s92 offen offset:3072 sc1
v_lshlrev_b32 v138, 16, v131
v_and_b32 v139, s99, v131
v_add_f32 v192, v192, v104
v_add_f32 v193, v193, v105
v_add_f32 v194, v194, v106
v_mfma_f32_32x32x16_bf16 v[208:223], v[40:43], v[160:163], v[208:223]
s_waitcnt vmcnt(8)
v_max_u32 v14, v164, v168
v_cmp_eq_u32 vcc, -1, v14
v_add_f32 v195, v195, v107
v_add_f32 v196, v196, v108
v_add_f32 v197, v197, v109
v_mfma_f32_32x32x16_bf16 v[240:255], v[44:47], v[160:163], v[240:255]
s_cbranch_vccz hok_99
s_mov_b32 s3, 0
poll_100:
buffer_load_dwordx4 v[164:167], v2, s[12:15], s88 offen offset:1024 sc1
buffer_load_dwordx4 v[168:171], v2, s[12:15], s88 offen offset:3072 sc1
s_waitcnt vmcnt(0)
v_max_u32 v14, v164, v168
v_cmp_eq_u32 vcc, -1, v14
s_nop 0
s_cbranch_vccz pollok_101
s_add_u32 s3, s3, 1
s_cmp_lt_u32 s3, 131072
s_cbranch_scc1 poll_100
pollok_101:
hok_99:
v_add_f32 v198, v198, v110
v_add_f32 v199, v199, v111
v_add_f32 v192, v192, v112
v_add_f32 v193, v193, v113
v_add_f32 v194, v194, v114
v_mfma_f32_32x32x16_bf16 v[208:223], v[48:51], v[164:167], v[208:223]
v_add_f32 v195, v195, v115
v_add_f32 v196, v196, v116
v_add_f32 v197, v197, v117
v_add_f32 v198, v198, v118
v_add_f32 v199, v199, v119
v_add_f32 v192, v192, v120
v_mfma_f32_32x32x16_bf16 v[240:255], v[52:55], v[164:167], v[240:255]
v_add_f32 v193, v193, v121
v_add_f32 v194, v194, v122
v_add_f32 v195, v195, v123
v_add_f32 v196, v196, v124
v_add_f32 v197, v197, v125
v_add_f32 v198, v198, v126
v_mfma_f32_32x32x16_bf16 v[208:223], a[0:3], v[168:171], v[208:223]
s_waitcnt vmcnt(6)
v_max_u32 v14, v172, v60
v_cmp_eq_u32 vcc, -1, v14
v_add_f32 v199, v199, v127
v_fmac_f32 v132, v192, v96
v_fmac_f32 v133, v193, v97
v_mfma_f32_32x32x16_bf16 v[240:255], a[4:7], v[168:171], v[240:255]
s_cbranch_vccz hok_102
s_mov_b32 s3, 0
poll_103:
buffer_load_dwordx4 v[172:175], v2, s[12:15], s89 offen offset:1024 sc1
buffer_load_dwordx4 v[60:63], v2, s[12:15], s89 offen offset:3072 sc1
s_waitcnt vmcnt(0)
v_max_u32 v14, v172, v60
v_cmp_eq_u32 vcc, -1, v14
s_nop 0
s_cbranch_vccz pollok_104
s_add_u32 s3, s3, 1
s_cmp_lt_u32 s3, 131072
s_cbranch_scc1 poll_103
pollok_104:
hok_102:
v_fmac_f32 v134, v194, v98
v_fmac_f32 v135, v195, v99
v_fmac_f32 v136, v196, v100
v_fmac_f32 v137, v197, v101
v_fmac_f32 v138, v198, v102
v_mfma_f32_32x32x16_bf16 v[208:223], a[8:11], v[172:175], v[208:223]
v_fmac_f32 v139, v199, v103
v_cvt_pk_bf16_f32 v140, v132, v133
v_cvt_pk_bf16_f32 v141, v134, v135
v_cvt_pk_bf16_f32 v142, v136, v137
v_cvt_pk_bf16_f32 v143, v138, v139
s_nop 0
v_permlane32_swap_b32 v140, v142
v_mfma_f32_32x32x16_bf16 v[240:255], a[12:15], v[172:175], v[240:255]
v_permlane32_swap_b32 v141, v143
buffer_store_dwordx4 v[140:143], v7, s[28:31], s4 offen
v_mfma_f32_32x32x16_bf16 v[208:223], a[16:19], v[60:63], v[208:223]
s_waitcnt vmcnt(5)
v_max_u32 v14, v64, v68
v_cmp_eq_u32 vcc, -1, v14
v_mfma_f32_32x32x16_bf16 v[240:255], a[20:23], v[60:63], v[240:255]
s_cbranch_vccz hok_105
s_mov_b32 s3, 0
poll_106:
buffer_load_dwordx4 v[64:67], v2, s[12:15], s90 offen offset:1024 sc1
buffer_load_dwordx4 v[68:71], v2, s[12:15], s90 offen offset:3072 sc1
s_waitcnt vmcnt(0)
v_max_u32 v14, v64, v68
v_cmp_eq_u32 vcc, -1, v14
s_nop 0
s_cbranch_vccz pollok_107
s_add_u32 s3, s3, 1
s_cmp_lt_u32 s3, 131072
s_cbranch_scc1 poll_106
pollok_107:
hok_105:
v_mfma_f32_32x32x16_bf16 v[208:223], a[24:27], v[64:67], v[208:223]
v_mfma_f32_32x32x16_bf16 v[240:255], a[28:31], v[64:67], v[240:255]
v_mfma_f32_32x32x16_bf16 v[208:223], a[32:35], v[68:71], v[208:223]
s_waitcnt vmcnt(3)
v_max_u32 v14, v72, v76
v_cmp_eq_u32 vcc, -1, v14
v_mfma_f32_32x32x16_bf16 v[240:255], a[36:39], v[68:71], v[240:255]
s_cbranch_vccz hok_108
s_mov_b32 s3, 0
poll_109:
buffer_load_dwordx4 v[72:75], v2, s[12:15], s91 offen offset:1024 sc1
buffer_load_dwordx4 v[76:79], v2, s[12:15], s91 offen offset:3072 sc1
s_waitcnt vmcnt(0)
v_max_u32 v14, v72, v76
v_cmp_eq_u32 vcc, -1, v14
s_nop 0
s_cbranch_vccz pollok_110
s_add_u32 s3, s3, 1
s_cmp_lt_u32 s3, 131072
s_cbranch_scc1 poll_109
pollok_110:
hok_108:
v_mfma_f32_32x32x16_bf16 v[208:223], a[40:43], v[72:75], v[208:223]
v_mfma_f32_32x32x16_bf16 v[240:255], a[44:47], v[72:75], v[240:255]
v_mfma_f32_32x32x16_bf16 v[208:223], a[48:51], v[76:79], v[208:223]
s_waitcnt vmcnt(1)
v_max_u32 v14, v80, v84
v_cmp_eq_u32 vcc, -1, v14
v_mfma_f32_32x32x16_bf16 v[240:255], a[52:55], v[76:79], v[240:255]
s_cbranch_vccz hok_111
s_mov_b32 s3, 0
poll_112:
buffer_load_dwordx4 v[80:83], v2, s[12:15], s92 offen offset:1024 sc1
buffer_load_dwordx4 v[84:87], v2, s[12:15], s92 offen offset:3072 sc1
s_waitcnt vmcnt(0)
v_max_u32 v14, v80, v84
v_cmp_eq_u32 vcc, -1, v14
s_nop 0
s_cbranch_vccz pollok_113
s_add_u32 s3, s3, 1
s_cmp_lt_u32 s3, 131072
s_cbranch_scc1 poll_112
pollok_113:
hok_111:
v_mfma_f32_32x32x16_bf16 v[208:223], a[56:59], v[80:83], v[208:223]
v_mfma_f32_32x32x16_bf16 v[240:255], a[60:63], v[80:83], v[240:255]
v_mfma_f32_32x32x16_bf16 v[208:223], a[64:67], v[84:87], v[208:223]
v_mfma_f32_32x32x16_bf16 v[240:255], a[68:71], v[84:87], v[240:255]
s_nop 10
ds_write_b128 v9, v[216:219] offset:24576
ds_write_b128 v9, v[220:223] offset:25600
ds_write_b128 v10, v[240:243] offset:24576
ds_write_b128 v10, v[244:247] offset:25600
ds_write_b128 v11, v[248:251] offset:24576
ds_write_b128 v11, v[252:255] offset:25600
s_waitcnt lgkmcnt(0)
s_barrier
ds_read_b128 v[104:107], v5 offset:24576
ds_read_b128 v[108:111], v5 offset:25600
ds_read_b128 v[112:115], v5 offset:26624
ds_read_b128 v[116:119], v5 offset:27648
ds_read_b128 v[120:123], v5 offset:28672
ds_read_b128 v[124:127], v5 offset:29696
ds_read_b64 v[128:129], v6 offset:4096
ds_read_b64 v[130:131], v6 offset:4608
s_waitcnt lgkmcnt(1)
v_lshlrev_b32 v132, 16, v128
v_and_b32 v133, s99, v128
v_lshlrev_b32 v134, 16, v129
v_and_b32 v135, s99, v129
s_waitcnt lgkmcnt(0)
v_lshlrev_b32 v136, 16, v130
v_and_b32 v137, s99, v130
v_lshlrev_b32 v138, 16, v131
v_and_b32 v139, s99, v131
v_pk_add_f32 v[208:209], v[208:209], v[104:105]
v_pk_add_f32 v[210:211], v[210:211], v[106:107]
v_pk_add_f32 v[212:213], v[212:213], v[108:109]
v_pk_add_f32 v[214:215], v[214:215], v[110:111]
v_pk_add_f32 v[208:209], v[208:209], v[112:113]
v_pk_add_f32 v[210:211], v[210:211], v[114:115]
v_pk_add_f32 v[212:213], v[212:213], v[116:117]
v_pk_add_f32 v[214:215], v[214:215], v[118:119]
v_pk_add_f32 v[208:209], v[208:209], v[120:121]
v_pk_add_f32 v[210:211], v[210:211], v[122:123]
v_pk_add_f32 v[212:213], v[212:213], v[124:125]
v_pk_add_f32 v[214:215], v[214:215], v[126:127]
v_pk_fma_f32 v[132:133], v[208:209], v[96:97], v[132:133]
v_pk_fma_f32 v[134:135], v[210:211], v[98:99], v[134:135]
v_pk_fma_f32 v[136:137], v[212:213], v[100:101], v[136:137]
v_pk_fma_f32 v[138:139], v[214:215], v[102:103], v[138:139]
v_cvt_pk_bf16_f32 v140, v132, v133
v_cvt_pk_bf16_f32 v141, v134, v135
v_cvt_pk_bf16_f32 v142, v136, v137
v_cvt_pk_bf16_f32 v143, v138, v139
s_nop 0
v_permlane32_swap_b32 v140, v142
v_permlane32_swap_b32 v141, v143
buffer_store_dwordx4 v[140:143], v7, s[28:31], s5 offen
L_end:
s_endpgm
L_service:
s_cmp_lt_u32 s2, 8
s_cbranch_scc1 L_touch
s_lshr_b32 s4, s2, 3
s_sub_u32 s4, s4, 1
s_mul_i32 s78, s80, 7
s_add_u32 s78, s78, s4
s_mov_b32 s87, 196
s_cmp_lg_u32 s62, 0
s_cbranch_scc1 L_sv1
s_cmp_ge_u32 s77, 14
s_cselect_b32 s74, 0.5, 0
s_barrier
s_waitcnt vmcnt(15)
v_lshlrev_b32 v32, 16, v64
v_and_b32 v33, s99, v64
v_lshlrev_b32 v34, 16, v65
v_and_b32 v35, s99, v65
v_lshlrev_b32 v36, 16, v66
v_and_b32 v37, s99, v66
v_lshlrev_b32 v38, 16, v67
v_and_b32 v39, s99, v67
s_waitcnt vmcnt(14)
v_lshlrev_b32 v40, 16, v68
v_and_b32 v41, s99, v68
v_lshlrev_b32 v42, 16, v69
v_and_b32 v43, s99, v69
v_lshlrev_b32 v44, 16, v70
v_and_b32 v45, s99, v70
v_mul_f32 v64, 0xbfb8aa3b, v32
v_mul_f32 v65, 0xbfb8aa3b, v33
v_mul_f32 v66, 0xbfb8aa3b, v34
v_mul_f32 v67, 0xbfb8aa3b, v35
v_mul_f32 v68, 0xbfb8aa3b, v36
v_mul_f32 v69, 0xbfb8aa3b, v37
v_mul_f32 v70, 0xbfb8aa3b, v38
v_mul_f32 v71, 0xbfb8aa3b, v39
v_mul_f32 v72, 0xbfb8aa3b, v40
v_mul_f32 v73, 0xbfb8aa3b, v41
v_mul_f32 v74, 0xbfb8aa3b, v42
v_mul_f32 v75, 0xbfb8aa3b, v43
v_mul_f32 v76, 0xbfb8aa3b, v44
v_mul_f32 v77, 0xbfb8aa3b, v45
v_exp_f32 v64, v64
v_exp_f32 v65, v65
v_exp_f32 v66, v66
v_exp_f32 v67, v67
v_exp_f32 v68, v68
v_exp_f32 v69, v69
v_exp_f32 v70, v70
v_exp_f32 v71, v71
v_exp_f32 v72, v72
v_exp_f32 v73, v73
v_exp_f32 v74, v74
v_exp_f32 v75, v75
v_exp_f32 v76, v76
v_exp_f32 v77, v77
v_add_f32 v64, 1.0, v64
v_add_f32 v65, 1.0, v65
v_add_f32 v66, 1.0, v66
v_add_f32 v67, 1.0, v67
v_add_f32 v68, 1.0, v68
v_add_f32 v69, 1.0, v69
v_add_f32 v70, 1.0, v70
v_add_f32 v71, 1.0, v71
v_add_f32 v72, 1.0, v72
v_add_f32 v73, 1.0, v73
v_add_f32 v74, 1.0, v74
v_add_f32 v75, 1.0, v75
v_add_f32 v76, 1.0, v76
v_add_f32 v77, 1.0, v77
v_rcp_f32 v64, v64
v_rcp_f32 v65, v65
v_rcp_f32 v66, v66
v_rcp_f32 v67, v67
v_rcp_f32 v68, v68
v_rcp_f32 v69, v69
v_rcp_f32 v70, v70
v_rcp_f32 v71, v71
v_rcp_f32 v72, v72
v_rcp_f32 v73, v73
v_rcp_f32 v74, v74
v_rcp_f32 v75, v75
v_rcp_f32 v76, v76
v_rcp_f32 v77, v77
v_mul_f32 v32, v32, v64
v_mul_f32 v33, v33, v65
v_mul_f32 v34, v34, v66
v_mul_f32 v35, v35, v67
v_mul_f32 v36, v36, v68
v_mul_f32 v37, v37, v69
v_mul_f32 v38, v38, v70
v_mul_f32 v39, v39, v71
v_mul_f32 v40, v40, v72
v_mul_f32 v41, v41, v73
v_mul_f32 v42, v42, v74
v_mul_f32 v43, v43, v75
v_mul_f32 v44, v44, v76
v_mul_f32 v45, v45, v77
v_cvt_pk_bf16_f32 v64, v32, 0
v_lshlrev_b32 v32, 16, v64
v_cvt_pk_bf16_f32 v65, v33, 0
v_lshlrev_b32 v33, 16, v65
v_cvt_pk_bf16_f32 v66, v34, 0
v_lshlrev_b32 v34, 16, v66
v_cvt_pk_bf16_f32 v67, v35, 0
v_lshlrev_b32 v35, 16, v67
v_cvt_pk_bf16_f32 v68, v36, 0
v_lshlrev_b32 v36, 16, v68
v_cvt_pk_bf16_f32 v69, v37, 0
v_lshlrev_b32 v37, 16, v69
v_cvt_pk_bf16_f32 v70, v38, 0
v_lshlrev_b32 v38, 16, v70
v_cvt_pk_bf16_f32 v71, v39, 0
v_lshlrev_b32 v39, 16, v71
v_cvt_pk_bf16_f32 v72, v40, 0
v_lshlrev_b32 v40, 16, v72
v_cvt_pk_bf16_f32 v73, v41, 0
v_lshlrev_b32 v41, 16, v73
v_cvt_pk_bf16_f32 v74, v42, 0
v_lshlrev_b32 v42, 16, v74
v_cvt_pk_bf16_f32 v75, v43, 0
v_lshlrev_b32 v43, 16, v75
v_cvt_pk_bf16_f32 v76, v44, 0
v_lshlrev_b32 v44, 16, v76
v_cvt_pk_bf16_f32 v77, v45, 0
v_lshlrev_b32 v45, 16, v77
v_and_b32 v4, 3, v1
v_lshlrev_b32 v4, 3, v4
v_lshrrev_b32 v3, 4, v1
v_lshl_add_u32 v3, v3, 1, v4
v_lshlrev_b32 v4, 2, v3
s_waitcnt vmcnt(13)
v_dot2_f32_bf16 v16, v128, v64, 0
v_dot2_f32_bf16 v17, v128, v32, 0
v_dot2_f32_bf16 v18, v129, v64, 0
v_dot2_f32_bf16 v19, v129, v32, 0
v_dot2_f32_bf16 v20, v130, v64, 0
v_dot2_f32_bf16 v21, v130, v32, 0
v_dot2_f32_bf16 v22, v131, v64, 0
v_dot2_f32_bf16 v23, v131, v32, 0
s_waitcnt vmcnt(12)
v_dot2_f32_bf16 v16, v132, v65, v16
v_dot2_f32_bf16 v17, v132, v33, v17
v_dot2_f32_bf16 v18, v133, v65, v18
v_dot2_f32_bf16 v19, v133, v33, v19
v_dot2_f32_bf16 v20, v134, v65, v20
v_dot2_f32_bf16 v21, v134, v33, v21
v_dot2_f32_bf16 v22, v135, v65, v22
v_dot2_f32_bf16 v23, v135, v33, v23
s_waitcnt vmcnt(11)
v_dot2_f32_bf16 v16, v136, v66, v16
v_dot2_f32_bf16 v17, v136, v34, v17
v_dot2_f32_bf16 v18, v137, v66, v18
v_dot2_f32_bf16 v19, v137, v34, v19
v_dot2_f32_bf16 v20, v138, v66, v20
v_dot2_f32_bf16 v21, v138, v34, v21
v_dot2_f32_bf16 v22, v139, v66, v22
v_dot2_f32_bf16 v23, v139, v34, v23
s_waitcnt vmcnt(10)
v_dot2_f32_bf16 v16, v140, v67, v16
v_dot2_f32_bf16 v17, v140, v35, v17
v_dot2_f32_bf16 v18, v141, v67, v18
v_dot2_f32_bf16 v19, v141, v35, v19
v_dot2_f32_bf16 v20, v142, v67, v20
v_dot2_f32_bf16 v21, v142, v35, v21
v_dot2_f32_bf16 v22, v143, v67, v22
v_dot2_f32_bf16 v23, v143, v35, v23
s_waitcnt vmcnt(9)
v_dot2_f32_bf16 v16, v144, v68, v16
v_dot2_f32_bf16 v17, v144, v36, v17
v_dot2_f32_bf16 v18, v145, v68, v18
v_dot2_f32_bf16 v19, v145, v36, v19
v_dot2_f32_bf16 v20, v146, v68, v20
v_dot2_f32_bf16 v21, v146, v36, v21
v_dot2_f32_bf16 v22, v147, v68, v22
v_dot2_f32_bf16 v23, v147, v36, v23
s_waitcnt vmcnt(8)
v_dot2_f32_bf16 v16, v148, v69, v16
v_dot2_f32_bf16 v17, v148, v37, v17
v_dot2_f32_bf16 v18, v149, v69, v18
v_dot2_f32_bf16 v19, v149, v37, v19
v_dot2_f32_bf16 v20, v150, v69, v20
v_dot2_f32_bf16 v21, v150, v37, v21
v_dot2_f32_bf16 v22, v151, v69, v22
v_dot2_f32_bf16 v23, v151, v37, v23
s_waitcnt vmcnt(7)
v_dot2_f32_bf16 v16, v152, v70, v16
v_dot2_f32_bf16 v17, v152, v38, v17
v_dot2_f32_bf16 v18, v153, v70, v18
v_dot2_f32_bf16 v19, v153, v38, v19
v_dot2_f32_bf16 v20, v154, v70, v20
v_dot2_f32_bf16 v21, v154, v38, v21
v_dot2_f32_bf16 v22, v155, v70, v22
v_dot2_f32_bf16 v23, v155, v38, v23
s_waitcnt vmcnt(6)
v_dot2_f32_bf16 v16, v156, v71, v16
v_dot2_f32_bf16 v17, v156, v39, v17
v_dot2_f32_bf16 v18, v157, v71, v18
v_dot2_f32_bf16 v19, v157, v39, v19
v_dot2_f32_bf16 v20, v158, v71, v20
v_dot2_f32_bf16 v21, v158, v39, v21
v_dot2_f32_bf16 v22, v159, v71, v22
v_dot2_f32_bf16 v23, v159, v39, v23
s_waitcnt vmcnt(5)
v_dot2_f32_bf16 v16, v160, v72, v16
v_dot2_f32_bf16 v17, v160, v40, v17
v_dot2_f32_bf16 v18, v161, v72, v18
v_dot2_f32_bf16 v19, v161, v40, v19
v_dot2_f32_bf16 v20, v162, v72, v20
v_dot2_f32_bf16 v21, v162, v40, v21
v_dot2_f32_bf16 v22, v163, v72, v22
v_dot2_f32_bf16 v23, v163, v40, v23
s_waitcnt vmcnt(4)
v_dot2_f32_bf16 v16, v164, v73, v16
v_dot2_f32_bf16 v17, v164, v41, v17
v_dot2_f32_bf16 v18, v165, v73, v18
v_dot2_f32_bf16 v19, v165, v41, v19
v_dot2_f32_bf16 v20, v166, v73, v20
v_dot2_f32_bf16 v21, v166, v41, v21
v_dot2_f32_bf16 v22, v167, v73, v22
v_dot2_f32_bf16 v23, v167, v41, v23
s_waitcnt vmcnt(3)
v_dot2_f32_bf16 v16, v168, v74, v16
v_dot2_f32_bf16 v17, v168, v42, v17
v_dot2_f32_bf16 v18, v169, v74, v18
v_dot2_f32_bf16 v19, v169, v42, v19
v_dot2_f32_bf16 v20, v170, v74, v20
v_dot2_f32_bf16 v21, v170, v42, v21
v_dot2_f32_bf16 v22, v171, v74, v22
v_dot2_f32_bf16 v23, v171, v42, v23
s_waitcnt vmcnt(2)
v_dot2_f32_bf16 v16, v172, v75, v16
v_dot2_f32_bf16 v17, v172, v43, v17
v_dot2_f32_bf16 v18, v173, v75, v18
v_dot2_f32_bf16 v19, v173, v43, v19
v_dot2_f32_bf16 v20, v174, v75, v20
v_dot2_f32_bf16 v21, v174, v43, v21
v_dot2_f32_bf16 v22, v175, v75, v22
v_dot2_f32_bf16 v23, v175, v43, v23
s_waitcnt vmcnt(1)
v_dot2_f32_bf16 v16, v176, v76, v16
v_dot2_f32_bf16 v17, v176, v44, v17
v_dot2_f32_bf16 v18, v177, v76, v18
v_dot2_f32_bf16 v19, v177, v44, v19
v_dot2_f32_bf16 v20, v178, v76, v20
v_dot2_f32_bf16 v21, v178, v44, v21
v_dot2_f32_bf16 v22, v179, v76, v22
v_dot2_f32_bf16 v23, v179, v44, v23
s_waitcnt vmcnt(0)
v_dot2_f32_bf16 v16, v180, v77, v16
v_dot2_f32_bf16 v17, v180, v45, v17
v_dot2_f32_bf16 v18, v181, v77, v18
v_dot2_f32_bf16 v19, v181, v45, v19
v_dot2_f32_bf16 v20, v182, v77, v20
v_dot2_f32_bf16 v21, v182, v45, v21
v_dot2_f32_bf16 v22, v183, v77, v22
v_dot2_f32_bf16 v23, v183, v45, v23
v_permlane32_swap_b32 v16, v20
v_permlane32_swap_b32 v17, v21
v_permlane32_swap_b32 v18, v22
v_permlane32_swap_b32 v19, v23
v_add_f32 v16, v16, v20
v_add_f32 v17, v17, v21
v_add_f32 v18, v18, v22
v_add_f32 v19, v19, v23
s_nop 0
v_permlane16_swap_b32 v16, v18
v_permlane16_swap_b32 v17, v19
v_add_f32 v16, v16, v18
v_add_f32 v17, v17, v19
s_nop 0
v_add_f32_dpp v16, v16, v16 row_ror:4 row_mask:0xf bank_mask:0xf
v_add_f32_dpp v17, v17, v17 row_ror:4 row_mask:0xf bank_mask:0xf
s_nop 0
v_add_f32_dpp v16, v16, v16 row_ror:8 row_mask:0xf bank_mask:0xf
v_add_f32_dpp v17, v17, v17 row_ror:8 row_mask:0xf bank_mask:0xf
v_mov_b32 v13, 143360
v_mov_b32 v14, 1
v_add_f32 v16, s74, v16
v_min_u32 v16, -2, v16
v_add_f32 v17, s74, v17
v_min_u32 v17, -2, v17
s_mov_b32 exec_lo, 0x000f000f
s_mov_b32 exec_hi, 0x000f000f
buffer_store_dwordx2 v[16:17], v4, s[12:15], s75 offen sc1
s_mov_b64 exec, -1
ds_write_b32 v13, v14 offset:4
s_branch L_svend
L_sv1:
v_mov_b32 v12, 143360
v_mov_b32 v14, 0
ds_write2_b32 v12, v14, v14 offset0:0 offset1:1
s_waitcnt lgkmcnt(0)
s_barrier
s_cmp_lg_u32 s62, 1
s_cbranch_scc1 L_sv2
s_waitcnt vmcnt(0)
v_readfirstlane_b32 s4, v16
s_nop 0
s_cmp_lt_u32 s4, 55
s_cbranch_scc1 L_svend
v_mov_b32 v13, 0
v_mov_b32 v14, 1
s_mov_b64 exec, 1
global_store_dword v13, v14, s[58:59] offset:128 sc1
s_mov_b64 exec, -1
s_branch L_svend
L_sv2:
s_mov_b32 s3, 0
poll_114:
s_sleep 4
ds_read_b32 v14, v12 offset:4
s_waitcnt lgkmcnt(0)
v_cmp_eq_u32 vcc, 0, v14
s_nop 0
s_cbranch_vccz pollok_115
s_add_u32 s3, s3, 1
s_cmp_lt_u32 s3, 131072
s_cbranch_scc1 poll_114
pollok_115:
s_sub_u32 s77, s62, 2
s_mov_b32 s28, s42
s_and_b32 s29, s43, 0xffff
s_mov_b32 s30, 921600
s_mov_b32 s31, 0x20000
s_mov_b32 s32, s44
s_and_b32 s33, s45, 0xffff
s_mov_b32 s34, 921600
s_mov_b32 s35, 0x20000
s_lshr_b32 s4, s2, 6
s_bfe_u32 s5, s2, 0x10005
s_bfe_u32 s6, s2, 0x20003
s_bfe_u32 s7, s2, 0x20001
s_lshl_b32 s85, s5, 10
s_lshl_b32 s6, s6, 8
s_add_u32 s85, s85, s6
s_lshl_b32 s84, s4, 4
s_lshl_b32 s5, s7, 2
s_add_u32 s84, s84, s5
s_add_u32 s84, s84, s85
s_lshl_b32 s86, s4, 11
s_add_u32 s86, s86, s85
s_lshl_b32 s5, s7, 6
s_add_u32 s86, s86, s5
s_and_b32 s85, s2, 1
s_lshl_b32 s85, s85, 2
s_add_u32 s85, s85, s77
s_lshl_b32 s85, s85, 5
v_bfe_u32 v7, v1, 2, 2
v_lshrrev_b32 v8, 4, v1
v_lshl_add_u32 v7, v8, 6, v7
v_mul_u32_u24 v7, 450, v7
v_and_b32 v8, 3, v1
v_lshl_add_u32 v7, v8, 4, v7
s_mul_i32 s4, s84, 450
s_lshl_b32 s5, s85, 1
s_add_u32 s4, s4, s5
s_lshl_b32 s95, s77, 11
s_mov_b32 m0, s95
s_nop 0
buffer_load_dwordx4 v7, s[28:31], s4 offen lds
s_add_u32 m0, s95, 1024
s_nop 0
buffer_load_dwordx4 v7, s[32:35], s4 offen lds
s_mov_b32 s70, s85
s_mov_b32 s71, s95
s_sub_u32 s77, s62, 0
s_mov_b32 s28, s42
s_and_b32 s29, s43, 0xffff
s_mov_b32 s30, 921600
s_mov_b32 s31, 0x20000
s_mov_b32 s32, s44
s_and_b32 s33, s45, 0xffff
s_mov_b32 s34, 921600
s_mov_b32 s35, 0x20000
s_lshr_b32 s4, s2, 6
s_bfe_u32 s5, s2, 0x10005
s_bfe_u32 s6, s2, 0x20003
s_bfe_u32 s7, s2, 0x20001
s_lshl_b32 s85, s5, 10
s_lshl_b32 s6, s6, 8
s_add_u32 s85, s85, s6
s_lshl_b32 s84, s4, 4
s_lshl_b32 s5, s7, 2
s_add_u32 s84, s84, s5
s_add_u32 s84, s84, s85
s_lshl_b32 s86, s4, 11
s_add_u32 s86, s86, s85
s_lshl_b32 s5, s7, 6
s_add_u32 s86, s86, s5
s_and_b32 s85, s2, 1
s_lshl_b32 s85, s85, 2
s_add_u32 s85, s85, s77
s_lshl_b32 s85, s85, 5
v_bfe_u32 v7, v1, 2, 2
v_lshrrev_b32 v8, 4, v1
v_lshl_add_u32 v7, v8, 6, v7
v_mul_u32_u24 v7, 450, v7
v_and_b32 v8, 3, v1
v_lshl_add_u32 v7, v8, 4, v7
s_mul_i32 s4, s84, 450
s_lshl_b32 s5, s85, 1
s_add_u32 s4, s4, s5
s_lshl_b32 s95, s77, 11
s_mov_b32 m0, s95
s_nop 0
buffer_load_dwordx4 v7, s[28:31], s4 offen lds
s_add_u32 m0, s95, 1024
s_nop 0
buffer_load_dwordx4 v7, s[32:35], s4 offen lds
s_mov_b32 s72, s85
s_mov_b32 s73, s95
s_waitcnt vmcnt(0)
s_mov_b32 s85, s70
s_mov_b32 s95, s71
s_add_u32 s24, s60, 6291456
s_addc_u32 s25, s61, 0
s_and_b32 s25, s25, 0xffff
s_mov_b32 s26, 1843200
s_mov_b32 s27, 0x20000
v_and_b32 v7, 15, v1
v_lshrrev_b32 v8, 4, v1
v_lshlrev_b32 v11, 6, v7
v_lshl_add_u32 v11, v8, 3, v11
v_add_u32 v11, s95, v11
ds_read_b64_tr_b16 v[16:17], v11 offset:0
ds_read_b64_tr_b16 v[18:19], v11 offset:1024
ds_read_b64_tr_b16 v[20:21], v11 offset:32
ds_read_b64_tr_b16 v[22:23], v11 offset:1056
v_and_b32 v12, 3, v7
v_lshl_add_u32 v12, v8, 2, v12
v_add_u32 v12, s85, v12
v_lshlrev_b32 v40, 13, v12
v_lshrrev_b32 v12, 2, v7
v_lshl_add_u32 v40, v12, 4, v40
v_add_u32 v40, s86, v40
s_mov_b32 s38, 131072
v_lshlrev_b32 v41, 4, v1
s_waitcnt lgkmcnt(2)
buffer_store_dwordx4 v[16:19], v40, s[24:27], 0 offen sc1
s_waitcnt lgkmcnt(0)
buffer_store_dwordx4 v[20:23], v40, s[24:27], s38 offen sc1
s_mov_b32 s85, s72
s_mov_b32 s95, s73
s_add_u32 s24, s60, 6291456
s_addc_u32 s25, s61, 0
s_and_b32 s25, s25, 0xffff
s_mov_b32 s26, 1843200
s_mov_b32 s27, 0x20000
v_and_b32 v7, 15, v1
v_lshrrev_b32 v8, 4, v1
v_lshlrev_b32 v11, 6, v7
v_lshl_add_u32 v11, v8, 3, v11
v_add_u32 v11, s95, v11
ds_read_b64_tr_b16 v[16:17], v11 offset:0
ds_read_b64_tr_b16 v[18:19], v11 offset:1024
ds_read_b64_tr_b16 v[20:21], v11 offset:32
ds_read_b64_tr_b16 v[22:23], v11 offset:1056
v_and_b32 v12, 3, v7
v_lshl_add_u32 v12, v8, 2, v12
v_add_u32 v12, s85, v12
v_lshlrev_b32 v40, 13, v12
v_lshrrev_b32 v12, 2, v7
v_lshl_add_u32 v40, v12, 4, v40
v_add_u32 v40, s86, v40
s_mov_b32 s38, 131072
v_lshlrev_b32 v41, 4, v1
s_waitcnt lgkmcnt(2)
buffer_store_dwordx4 v[16:19], v40, s[24:27], 0 offen sc1
s_waitcnt lgkmcnt(0)
buffer_store_dwordx4 v[20:23], v40, s[24:27], s38 offen sc1
L_svend:
s_waitcnt vmcnt(0)
v_lshlrev_b32 v13, 6, v1
v_and_b32 v13, 64, v13
global_load_dword v42, v13, s[58:59] offset:128 sc1
s_add_u32 s16, s60, 2097152
s_addc_u32 s17, s61, 0
s_and_b32 s17, s17, 0xffff
s_mov_b32 s18, 1843200
s_mov_b32 s19, 0x20000
s_add_u32 s20, s60, 2097152
s_addc_u32 s21, s61, 0
s_and_b32 s21, s21, 0xffff
s_mov_b32 s22, 1843200
s_mov_b32 s23, 0x20000
s_add_u32 s24, s60, 6291456
s_addc_u32 s25, s61, 0
s_and_b32 s25, s25, 0xffff
s_mov_b32 s26, 1843200
s_mov_b32 s27, 0x20000
s_branch L_arrive1
L_touch:
v_min_u32 v7, 9, v1
v_lshlrev_b32 v7, 21, v7
v_add_u32 v7, 0x1fff00, v7
buffer_load_dword v250, v7, s[12:15], 0 offen sc1
v_mov_b32 v7, 0
global_load_dword v251, v7, s[56:57] sc1
s_min_u32 s87, s2, 4
s_add_u32 s87, s87, 192
s_mov_b32 s28, s42
s_and_b32 s29, s43, 0xffff
s_mov_b32 s30, 921600
s_mov_b32 s31, 0x20000
s_mov_b32 s32, s44
s_and_b32 s33, s45, 0xffff
s_mov_b32 s34, 921600
s_mov_b32 s35, 0x20000
s_lshr_b32 s4, s2, 6
s_bfe_u32 s5, s2, 0x10005
s_bfe_u32 s6, s2, 0x20003
s_bfe_u32 s7, s2, 0x20001
s_lshl_b32 s85, s5, 10
s_lshl_b32 s6, s6, 8
s_add_u32 s85, s85, s6
s_lshl_b32 s84, s4, 4
s_lshl_b32 s5, s7, 2
s_add_u32 s84, s84, s5
s_add_u32 s84, s84, s85
s_lshl_b32 s86, s4, 11
s_add_u32 s86, s86, s85
s_lshl_b32 s5, s7, 6
s_add_u32 s86, s86, s5
s_and_b32 s85, s2, 1
s_lshl_b32 s85, s85, 2
s_add_u32 s85, s85, s62
s_lshl_b32 s85, s85, 5
v_bfe_u32 v7, v1, 2, 2
v_lshrrev_b32 v8, 4, v1
v_lshl_add_u32 v7, v8, 6, v7
v_mul_u32_u24 v7, 450, v7
v_and_b32 v8, 3, v1
v_lshl_add_u32 v7, v8, 4, v7
s_mul_i32 s4, s84, 450
s_lshl_b32 s5, s85, 1
s_add_u32 s4, s4, s5
s_lshl_b32 s95, s62, 11
s_mov_b32 m0, s95
s_nop 0
buffer_load_dwordx4 v7, s[28:31], s4 offen lds
s_add_u32 m0, s95, 1024
s_nop 0
buffer_load_dwordx4 v7, s[32:35], s4 offen lds
s_cmp_ge_u32 s87, 196
s_cbranch_scc1 L_nopre1s
s_mul_i32 s89, s87, 9363
s_lshr_b32 s89, s89, 16
s_mul_i32 s4, s89, 7
s_sub_u32 s98, s87, s4
s_lshl_b32 s4, s62, 11
s_add_u32 s94, s4, 144384
s_mov_b32 s28, s48
s_and_b32 s29, s49, 0xffff
s_mov_b32 s30, 1605632
s_mov_b32 s31, 0x20000
v_lshrrev_b32 v7, 3, v1
v_lshrrev_b32 v8, 1, v7
v_and_b32 v10, 1, v8
v_lshlrev_b32 v10, 2, v10
v_and_b32 v11, 7, v1
v_xor_b32 v10, v10, v11
v_lshlrev_b32 v10, 4, v10
v_mul_u32_u24 v8, 14, v8
v_and_b32 v11, 1, v7
v_add_u32 v8, v8, v11
v_mul_u32_u24 v8, 3584, v8
s_lshl_b32 s4, s98, 9
s_lshl_b32 s5, s62, 7
s_add_u32 s4, s4, s5
s_mul_i32 s6, s89, 37
s_lshr_b32 s6, s6, 8
s_mul_i32 s6, s6, 98
s_lshl_b32 s5, s89, 1
s_add_u32 s5, s5, s6
s_mul_i32 s5, s5, 3584
s_add_u32 s4, s5, s4
s_add_u32 s5, s4, 200704
v_add_u32 v8, v8, v10
s_mov_b32 m0, s94
s_nop 0
buffer_load_dwordx4 v8, s[28:31], s4 offen lds
s_add_u32 m0, s94, 1024
s_nop 0
buffer_load_dwordx4 v8, s[28:31], s5 offen lds
L_nopre1s:
s_waitcnt vmcnt(0)
s_add_u32 s24, s60, 6291456
s_addc_u32 s25, s61, 0
s_and_b32 s25, s25, 0xffff
s_mov_b32 s26, 1843200
s_mov_b32 s27, 0x20000
v_and_b32 v7, 15, v1
v_lshrrev_b32 v8, 4, v1
v_lshlrev_b32 v11, 6, v7
v_lshl_add_u32 v11, v8, 3, v11
v_add_u32 v11, s95, v11
ds_read_b64_tr_b16 v[16:17], v11 offset:0
ds_read_b64_tr_b16 v[18:19], v11 offset:1024
ds_read_b64_tr_b16 v[20:21], v11 offset:32
ds_read_b64_tr_b16 v[22:23], v11 offset:1056
v_and_b32 v12, 3, v7
v_lshl_add_u32 v12, v8, 2, v12
v_add_u32 v12, s85, v12
v_lshlrev_b32 v40, 13, v12
v_lshrrev_b32 v12, 2, v7
v_lshl_add_u32 v40, v12, 4, v40
v_add_u32 v40, s86, v40
s_mov_b32 s38, 131072
v_lshlrev_b32 v41, 4, v1
s_cmp_ge_u32 s87, 196
s_cbranch_scc1 L_nopre2s2
v_and_b32 v7, 15, v1
v_lshrrev_b32 v8, 4, v1
v_lshrrev_b32 v12, 2, v7
v_lshrrev_b32 v13, 1, v12
v_lshlrev_b32 v11, 2, v13
v_and_b32 v13, 1, v8
v_lshl_or_b32 v11, v13, 1, v11
v_bfe_u32 v13, v7, 1, 1
v_or_b32 v11, v11, v13
v_lshlrev_b32 v11, 4, v11
v_and_b32 v13, 1, v7
v_lshl_or_b32 v11, v13, 3, v11
v_lshl_or_b32 v11, v12, 7, v11
v_lshrrev_b32 v13, 1, v8
v_lshl_add_u32 v11, v13, 10, v11
v_add_u32 v11, s94, v11
v_xor_b32 v12, 64, v11
ds_read_b64_tr_b16 v[24:25], v11
ds_read_b64_tr_b16 v[26:27], v11 offset:512
ds_read_b64_tr_b16 v[28:29], v12
ds_read_b64_tr_b16 v[30:31], v12 offset:512
s_add_u32 s4, s98, 0
s_lshl_b32 s4, s4, 2
s_add_u32 s4, s4, s62
s_mul_i32 s4, s4, 57344
s_lshl_b32 s5, s89, 11
s_add_u32 s4, s4, s5
s_add_u32 s88, s4, 8388608
s_waitcnt lgkmcnt(0)
L_nopre2s2:
s_waitcnt lgkmcnt(2)
buffer_store_dwordx4 v[16:19], v40, s[24:27], 0 offen sc1
s_waitcnt lgkmcnt(0)
buffer_store_dwordx4 v[20:23], v40, s[24:27], s38 offen sc1
s_cmp_ge_u32 s87, 196
s_cbranch_scc1 L_nopre3s2
buffer_store_dwordx4 v[24:27], v41, s[12:15], s88 offen offset:0 sc1
buffer_store_dwordx4 v[28:31], v41, s[12:15], s88 offen offset:1024 sc1
L_nopre3s2:
v_lshlrev_b32 v13, 6, v1
v_and_b32 v13, 64, v13
global_load_dword v42, v13, s[58:59] offset:128 sc1
s_add_u32 s16, s60, 2097152
s_addc_u32 s17, s61, 0
s_and_b32 s17, s17, 0xffff
s_mov_b32 s18, 1843200
s_mov_b32 s19, 0x20000
s_add_u32 s20, s60, 2097152
s_addc_u32 s21, s61, 0
s_and_b32 s21, s21, 0xffff
s_mov_b32 s22, 1843200
s_mov_b32 s23, 0x20000
s_branch L_arrive1
.p2align 8
.type const_tbl,@object
const_tbl:
.long 0x3f80,0xbee43ffa,0,0,0x3f80,0xbfe73f5e,0,0
.long 0x3f80,0xbfe7bf5e,0,0,0x3f80,0xbee4bffa,0,0
.long 0,0,0xbe653ffe,0xbf293ff2,0,0,0xbf883fd9,0xbffebe65
.long 0,0,0xbfd93f88,0xbe65bffe,0,0,0xbffe3e65,0x3ff2bf29
.long 0x3f80,0xbfa03fc8,0,0,0x3f80,0xc0000000,0,0
.long 0x3f80,0xbfa0bfc8,0,0,0x3f80,0x3ee4bffa,0,0
.long 0,0,0xbf293ff2,0xbfd93f88,0,0,0xbfb53fb5,0xbfb5bfb5
.long 0,0,0xbff23f29,0x3f88bfd9,0,0,0xbffebe65,0x3ff23f29
.long 0xbf5e3fe7,0xbfa03fc8,0,0,0xbfc8bfa0,0x3ee4bffa,0,0
.long 0x3fc8bfa0,0x3ee43ffa,0,0,0x3f5e3fe7,0xbfa0bfc8,0,0
.long 0,0,0xbf883fd9,0xbfb53fb5,0,0,0xbf29bff2,0x3fb5bfb5
.long 0,0,0x3ff23f29,0xbfb53fb5,0,0,0xbfd93f88,0x3fb5bfb5
.long 0xbffa3ee4,0xbfe7bf5e,0,0,0xc000,0x40000000,0,0
.long 0x3ffa3ee4,0xbfe73f5e,0,0,0xbf5e3fe7,0x3fa0bfc8,0,0
.long 0,0,0xbffebe65,0xbfb5bfb5,0,0,0x3fb5bfb5,0x3fb53fb5
.long 0,0,0x3e653ffe,0xbfb5bfb5,0,0,0xbfd9bf88,0x3fb53fb5
.long 0xbfc83fa0,0xbfe73f5e,0,0,0x3ffabee4,0x3fa03fc8,0,0
.long 0xbffabee4,0x3fa0bfc8,0,0,0x3fc83fa0,0xbfe7bf5e,0,0
.long 0,0,0xbfd93f88,0xbff23f29,0,0,0x3ff23f29,0x3e653ffe
.long 0,0,0xbf29bff2,0x3ffe3e65,0,0,0xbf883fd9,0x3f29bff2
.long 0xbf5ebfe7,0x3ee4bffa,0,0,0x4000,0xc0000000,0,0
.long 0x3f5ebfe7,0x3ee43ffa,0,0,0xbfc83fa0,0x3fe7bf5e,0,0
.long 0,0,0xbe65bffe,0x3f88bfd9,0,0,0xbfb53fb5,0xbfb5bfb5
.long 0,0,0x3ffe3e65,0xbfd93f88,0,0,0xbf88bfd9,0x3f293ff2
.long 0xbffa3ee4,0xbf800000,0,0,0xbf5e3fe7,0xbf800000,0,0
.long 0x3f5e3fe7,0xbf800000,0,0,0x3ffa3ee4,0xbf800000,0,0
.long 0,0,0xbffe3e65,0,0,0,0xbfd93f88,0
.long 0,0,0xbf883fd9,0,0,0,0xbe653ffe,0
.long 0x3fc8bfa0,0x3f800000,0,0,0xc000,0x3f800000,0,0
.long 0xbfc8bfa0,0x3f800000,0,0,0xbffa3ee4,0x3f800000,0,0
.long 0,0,0x3ff2bf29,0,0,0,0x3fb5bfb5,0
.long 0,0,0x3f29bff2,0,0,0,0xbe65bffe,0
.long 0x3f80,0x3fa0bfc8,0,0,0x3f80,0x40000000,0,0
.long 0x3f80,0x3fa03fc8,0,0,0,0,0,0
.long 0,0,0xbff2bf29,0x3f883fd9,0,0,0xbfb5bfb5,0xbfb53fb5
.long 0,0,0xbf29bff2,0xbfd9bf88,0,0,0,0
.long 0x3f80,0x3fe7bf5e,0,0,0x3f80,0x3fe73f5e,0,0
.long 0x3f80,0x3ee43ffa,0,0,0,0,0,0
.long 0,0,0xbfd9bf88,0xbe653ffe,0,0,0xbf88bfd9,0xbffe3e65
.long 0,0,0xbe65bffe,0xbf29bff2,0,0,0,0
.long 0xbffa3ee4,0x3fe73f5e,0,0,0xc000,0xc0000000,0,0
.long 0x3ffa3ee4,0x3fe7bf5e,0,0,0,0,0,0
.long 0,0,0x3e65bffe,0xbfb53fb5,0,0,0x3fb53fb5,0x3fb5bfb5
.long 0,0,0xbffe3e65,0xbfb53fb5,0,0,0,0
.long 0xbfc8bfa0,0xbee43ffa,0,0,0x3fc8bfa0,0xbee4bffa,0,0
.long 0x3f5e3fe7,0x3fa03fc8,0,0,0,0,0,0
.long 0,0,0x3ff2bf29,0xbfb5bfb5,0,0,0xbf293ff2,0x3fb53fb5
.long 0,0,0xbf88bfd9,0xbfb5bfb5,0,0,0,0
.long 0xbf5ebfe7,0xbee43ffa,0,0,0x4000,0x40000000,0,0
.long 0x3f5ebfe7,0xbee4bffa,0,0,0,0,0,0
.long 0,0,0x3ffebe65,0xbfd9bf88,0,0,0xbfb5bfb5,0xbfb53fb5
.long 0,0,0xbe653ffe,0x3f883fd9,0,0,0,0
.long 0x3ffabee4,0xbfa0bfc8,0,0,0xbffabee4,0xbfa03fc8,0,0
.long 0x3fc83fa0,0x3fe73f5e,0,0,0,0,0,0
.long 0,0,0xbf293ff2,0x3ffebe65,0,0,0x3ff2bf29,0x3e65bffe
.long 0,0,0xbfd9bf88,0xbff2bf29,0,0,0,0
.long 0x3fc8bfa0,0xbf800000,0,0,0xc000,0xbf800000,0,0
.long 0xbfc8bfa0,0xbf800000,0,0,0,0,0,0
.long 0,0,0x3f293ff2,0,0,0,0x3fb53fb5,0
.long 0,0,0x3ff23f29,0,0,0,0,0
.long 0xbf5e3fe7,0x3f800000,0,0,0x3f5e3fe7,0x3f800000,0,0
.long 0x3ffa3ee4,0x3f800000,0,0,0,0,0,0
.long 0,0,0xbf88bfd9,0,0,0,0xbfd9bf88,0
.long 0,0,0xbffebe65,0,0,0,0,0
.long 0xbbe63f80,0xbe6b3f79,0xbe5d3f7a,0xbedb3f67,0xbd103f80,0xbf6a3ece,0xbf633eee,0xbf4ebf18
.long 0xbd813f7f,0xbf5fbefb,0xbf6dbec1,0x3f3ebf2c,0xbdba3f7f,0xbe08bf7e,0xbe9fbf73,0x3f043f5c
.long 0x3f803be6,0x3f793e6b,0xbf7abe5d,0xbf67bedb,0x3f803d10,0x3ece3f6a,0xbeeebf63,0x3f18bf4e
.long 0x3f7f3d81,0xbefb3f5f,0x3ec1bf6d,0x3f2c3f3e,0x3f7f3dba,0xbf7e3e08,0x3f73be9f,0xbf5c3f04
.long 0xbcac3f80,0xbf243f45,0xbf1b3f4b,0xbf783e79,0xbd493f80,0xbf80bd49,0xbf803d49,0xbd49bf80
.long 0xbd9e3f7f,0xbf10bf54,0xbf2fbf3b,0x3f7d3e16,0xbdd73f7f,0x3ea6bf72,0x3df4bf7e,0xbeac3f71
.long 0x3f803cac,0x3f453f24,0xbf4bbf1b,0xbe79bf78,0x3f803d49,0xbd493f80,0xbd49bf80,0x3f80bd49
.long 0x3f7f3d9e,0xbf543f10,0x3f3bbf2f,0xbe163f7d,0x3f7f3dd7,0xbf72bea6,0x3f7e3df4,0xbf71beac
.long 0xbee13f66,0xbf213f47,0xbf1e3f49,0xbf473f21,0xbf42bf27,0x3e83bf77,0x3e41bf7b,0x3f77be83
.long 0x3f52bf13,0x3e243f7d,0x3e913f75,0xbf7dbe24,0x3eb33f70,0xbf0dbf56,0xbf31bf39,0x3f563f0d
.long 0x3f663ee1,0x3f473f21,0xbf49bf1e,0xbf21bf47,0xbf273f42,0xbf77be83,0x3f7b3e41,0x3e833f77
.long 0xbf13bf52,0x3f7dbe24,0xbf753e91,0x3e24bf7d,0x3f70beb3,0xbf563f0d,0x3f39bf31,0xbf0d3f56
.long 0xbf7b3e4f,0xbf64bee8,0xbf69bed4,0xbee8bf64,0x3d49bf80,0x3f803d49,0x3f80bd49,0x3d493f80
.long 0x3f743e98,0xbf6f3eba,0xbf5d3f01,0x3ebabf6f,0xbf073f5a,0x3f34bf36,0x3f0abf58,0xbf363f34
.long 0x3e4f3f7b,0xbee83f64,0x3ed4bf69,0x3f64bee8,0xbf80bd49,0x3d49bf80,0x3d493f80,0xbf803d49
.long 0x3e98bf74,0x3eba3f6f,0xbf01bf5d,0x3f6f3eba,0x3f5a3f07,0xbf36bf34,0x3f583f0a,0xbf34bf36
.long 0xbf493f1e,0xbf673edb,0xbf663ee1,0xbf793e6b,0x3f7bbe41,0x3f183f4e,0x3f273f42,0xbece3f6a
.long 0xbf75be91,0x3f2cbf3e,0x3f13bf52,0x3efb3f5f,0x3f393f31,0xbf5cbf04,0xbf70beb3,0x3f7e3e08
.long 0x3f1e3f49,0x3edb3f67,0xbee1bf66,0xbe6bbf79,0xbe41bf7b,0x3f4ebf18,0xbf423f27,0xbf6abece
.long 0xbe913f75,0xbf3ebf2c,0x3f523f13,0xbf5f3efb,0x3f31bf39,0xbf043f5c,0x3eb3bf70,0xbe083f7e
.long 0xbed4bf69,0x3e79bf78,0x3e4fbf7b,0x3f45bf24,0xbd493f80,0xbf80bd49,0xbf803d49,0xbd49bf80
.long 0x3f01bf5d,0x3e163f7d,0x3e983f74,0xbf54bf10,0xbf583f0a,0x3f71beac,0x3f5abf07,0xbf723ea6
.long 0xbf693ed4,0xbf78be79,0x3f7b3e4f,0x3f243f45,0x3f803d49,0xbd493f80,0xbd49bf80,0x3f80bd49
.long 0xbf5dbf01,0x3f7dbe16,0xbf743e98,0x3f10bf54,0x3f0a3f58,0xbeacbf71,0x3f073f5a,0xbea6bf72
.long 0xbf7a3e5d,0,0xbf803be6,0,0xbeee3f63,0,0xbf803d10,0
.long 0x3ec13f6d,0,0xbf7f3d81,0,0x3f733e9f,0,0xbf7f3dba,0
.long 0x3e5d3f7a,0,0xbbe6bf80,0,0x3f633eee,0,0xbd10bf80,0
.long 0x3f6dbec1,0,0xbd81bf7f,0,0x3e9fbf73,0,0xbdbabf7f,0
.long 0x3f4bbf1b,0,0x3f80bcac,0,0x3d49bf80,0,0x3f80bd49,0
.long 0xbf3bbf2f,0,0x3f7fbd9e,0,0xbf7e3df4,0,0x3f7fbdd7,0
.long 0xbf1bbf4b,0,0x3cac3f80,0,0xbf80bd49,0,0x3d493f80,0
.long 0xbf2f3f3b,0,0x3d9e3f7f,0,0x3df43f7e,0,0x3dd73f7f,0
.long 0xbdf43f7e,0x3f36bf34,0x3f07bf5a,0xbf713eac,0xbe163f7d,0x3f7d3e16,0x3f7dbe16,0xbe16bf7d
.long 0xbe333f7c,0x3ef53f61,0x3f403f29,0x3f803d49,0,0,0,0
.long 0x3f7e3df4,0xbf34bf36,0x3f5a3f07,0xbeacbf71,0x3f7d3e16,0x3e16bf7d,0x3e163f7d,0x3f7dbe16
.long 0x3f7c3e33,0x3f61bef5,0xbf293f40,0xbd493f80,0,0,0,0
.long 0xbe083f7e,0x3f73be9f,0x3f56bf0d,0xbf5cbf04,0xbe243f7d,0x3f523f13,0x3f753e91,0x3f2cbf3e
.long 0xbe413f7b,0x3d103f80,0x3ece3f6a,0x3f183f4e,0,0,0,0
.long 0x3f7e3e08,0xbe9fbf73,0x3f0d3f56,0x3f04bf5c,0x3f7d3e24,0x3f13bf52,0xbe913f75,0x3f3e3f2c
.long 0x3f7b3e41,0x3f80bd10,0xbf6a3ece,0xbf4e3f18,0,0,0,0
.long 0xbf7f3dd7,0x3f583f0a,0x3f723ea6,0xbf0abf58,0x3e16bf7d,0xbf7dbe16,0xbf7d3e16,0x3e163f7d
.long 0x3f6c3ec7,0x3f76be8a,0x3f50bf16,0x3e8abf76,0,0,0,0
.long 0x3dd73f7f,0x3f0abf58,0xbea63f72,0x3f58bf0a,0xbf7dbe16,0xbe163f7d,0xbe16bf7d,0xbf7d3e16
.long 0x3ec7bf6c,0xbe8abf76,0x3f163f50,0x3f763e8a,0,0,0,0
.long 0xbf31bf39,0xbeb33f70,0xbdba3f7f,0x3f70beb3,0x3f5fbefb,0xbd81bf7f,0xbec1bf6d,0xbf7fbd81
.long 0x3e833f77,0x3eee3f63,0x3f423f27,0x3f633eee,0,0,0,0
.long 0xbf393f31,0x3f703eb3,0xbf7fbdba,0x3eb33f70,0xbefbbf5f,0xbf7f3d81,0x3f6dbec1,0x3d81bf7f
.long 0x3f77be83,0x3f63beee,0xbf273f42,0xbeee3f63,0,0,0,0
.long 0xbea6bf72,0xbeac3f71,0xbdd73f7f,0x3f34bf36,0xbe163f7d,0x3f7d3e16,0x3f7dbe16,0xbe16bf7d
.long 0x3f16bf50,0xbd49bf80,0xbec7bf6c,0xbf61bef5,0,0,0,0
.long 0xbf723ea6,0x3f713eac,0xbf7fbdd7,0x3f363f34,0x3f7d3e16,0x3e16bf7d,0x3e163f7d,0x3f7dbe16
.long 0xbf50bf16,0xbf803d49,0x3f6cbec7,0x3ef5bf61,0,0,0,0
.long 0x3f7fbdba,0xbf04bf5c,0xbf39bf31,0xbe9f3f73,0xbf6dbec1,0xbf3e3f2c,0xbefb3f5f,0x3f133f52
.long 0x3f273f42,0x3f4e3f18,0x3f773e83,0x3f803d10,0,0,0,0
.long 0xbdbabf7f,0xbf5c3f04,0x3f31bf39,0xbf73be9f,0xbec13f6d,0x3f2c3f3e,0xbf5fbefb,0xbf523f13
.long 0x3f42bf27,0x3f18bf4e,0xbe833f77,0xbd103f80,0,0,0,0
.long 0x3f5abf07,0,0xbf7e3df4,0,0x3e16bf7d,0,0xbf7d3e16,0
.long 0xbf29bf40,0,0xbf7c3e33,0,0,0,0,0
.long 0xbf07bf5a,0,0xbdf4bf7e,0,0xbf7dbe16,0,0xbe16bf7d,0
.long 0xbf403f29,0,0xbe33bf7c,0,0,0,0,0
.long 0xbf0d3f56,0,0x3f7ebe08,0,0x3e913f75,0,0x3f7dbe24,0
.long 0x3f6a3ece,0,0x3f7bbe41,0,0,0,0,0
.long 0x3f563f0d,0,0x3e083f7e,0,0x3f75be91,0,0x3e243f7d,0
.long 0x3ecebf6a,0,0x3e413f7b,0,0,0,0,0
.long 0xbc663f80,0xbe723f79,0xbe563f7a,0xbed83f68,0xbd8f3f7f,0xbf6e3ebd,0xbf5e3efe,0xbf53bf11
.long 0xbe013f7e,0xbf57bf0b,0xbf73bea2,0x3f32bf38,0xbe3a3f7c,0xbd2cbf80,0xbecbbf6b,0x3f173f4f
.long 0x3f803c66,0x3f793e72,0xbf7abe56,0xbf68bed8,0x3f7f3d8f,0x3ebd3f6e,0xbefebf5e,0x3f11bf53
.long 0x3f7e3e01,0xbf0b3f57,0x3ea2bf73,0x3f383f32,0x3f7c3e3a,0xbf803d2c,0x3f6bbecb,0xbf4f3f17
.long 0xbd2c3f80,0xbf283f41,0xbf173f4f,0xbf773e87,0xbdc93f7f,0xbf7fbdc9,0xbf7f3dc9,0xbdc9bf7f
.long 0xbe1d3f7d,0xbefebf5e,0xbf3cbf2d,0x3f7f3d8f,0xbe563f7a,0x3ed8bf68,0x3c66bf80,0xbe723f79
.long 0x3f803d2c,0x3f413f28,0xbf4fbf17,0xbe87bf77,0x3f7f3dc9,0xbdc93f7f,0xbdc9bf7f,0x3f7fbdc9
.long 0x3f7d3e1d,0xbf5e3efe,0x3f2dbf3c,0xbd8f3f7f,0x3f7a3e56,0xbf68bed8,0x3f803c66,0xbf79be72
.long 0xbee53f65,0xbf223f46,0xbf1d3f4a,0xbf463f22,0xbf3cbf2d,0x3e95bf75,0x3e1dbf7d,0x3f75be95
.long 0x3f5bbf05,0x3dc93f7f,0x3eb03f70,0xbf7fbdc9,0x3e873f77,0xbef1bf62,0xbf41bf28,0x3f623ef1
.long 0x3f653ee5,0x3f463f22,0xbf4abf1d,0xbf22bf46,0xbf2d3f3c,0xbf75be95,0x3f7d3e1d,0x3e953f75
.long 0xbf05bf5b,0x3f7fbdc9,0xbf703eb0,0x3dc9bf7f,0x3f77be87,0xbf623ef1,0x3f28bf41,0xbef13f62
.long 0xbf7c3e3a,0xbf62bef1,0xbf6bbecb,0xbef1bf62,0x3dc9bf7f,0x3f7f3dc9,0x3f7fbdc9,0x3dc93f7f
.long 0x3f6e3ebd,0xbf753e95,0xbf533f11,0x3e95bf75,0xbf1d3f4a,0x3f46bf22,0x3ee5bf65,0xbf223f46
.long 0x3e3a3f7c,0xbef13f62,0x3ecbbf6b,0x3f62bef1,0xbf7fbdc9,0x3dc9bf7f,0x3dc93f7f,0xbf7f3dc9
.long 0x3ebdbf6e,0x3e953f75,0xbf11bf53,0x3f753e95,0x3f4a3f1d,0xbf22bf46,0x3f653ee5,0xbf46bf22
.long 0xbf4a3f1d,0xbf683ed8,0xbf653ee5,0xbf793e72,0x3f7dbe1d,0x3f113f53,0x3f2d3f3c,0xbebd3f6e
.long 0xbf70beb0,0x3f38bf32,0x3f05bf5b,0x3f0b3f57,0x3f283f41,0xbf4fbf17,0xbf77be87,0x3f803d2c
.long 0x3f1d3f4a,0x3ed83f68,0xbee5bf65,0xbe72bf79,0xbe1dbf7d,0x3f53bf11,0xbf3c3f2d,0xbf6ebebd
.long 0xbeb03f70,0xbf32bf38,0x3f5b3f05,0xbf573f0b,0x3f41bf28,0xbf173f4f,0x3e87bf77,0xbd2c3f80
.long 0xbecbbf6b,0x3e87bf77,0x3e3abf7c,0x3f41bf28,0xbdc93f7f,0xbf7fbdc9,0xbf7f3dc9,0xbdc9bf7f
.long 0x3f11bf53,0x3d8f3f7f,0x3ebd3f6e,0xbf5ebefe,0xbf653ee5,0x3f79be72,0x3f4abf1d,0xbf683ed8
.long 0xbf6b3ecb,0xbf77be87,0x3f7c3e3a,0x3f283f41,0x3f7f3dc9,0xbdc93f7f,0xbdc9bf7f,0x3f7fbdc9
.long 0xbf53bf11,0x3f7fbd8f,0xbf6e3ebd,0x3efebf5e,0x3ee53f65,0xbe72bf79,0x3f1d3f4a,0xbed8bf68
.long 0xbf7a3e56,0,0xbf803c66,0,0xbefe3f5e,0,0xbf7f3d8f,0
.long 0x3ea23f73,0,0xbf7e3e01,0,0x3f6b3ecb,0,0xbf7c3e3a,0
.long 0x3e563f7a,0,0xbc66bf80,0,0x3f5e3efe,0,0xbd8fbf7f,0
.long 0x3f73bea2,0,0xbe01bf7e,0,0x3ecbbf6b,0,0xbe3abf7c,0
.long 0x3f4fbf17,0,0x3f80bd2c,0,0x3dc9bf7f,0,0x3f7fbdc9,0
.long 0xbf2dbf3c,0,0x3f7dbe1d,0,0xbf803c66,0,0x3f7abe56,0
.long 0xbf17bf4f,0,0x3d2c3f80,0,0xbf7fbdc9,0,0x3dc93f7f,0
.long 0xbf3c3f2d,0,0x3e1d3f7d,0,0x3c663f80,0,0x3e563f7a,0
.long 0xbe723f79,0x3f4abf1d,0x3ed8bf68,0xbf653ee5,0xbe953f75,0x3f753e95,0x3f75be95,0xbe95bf75
.long 0xbeb03f70,0x3ea23f73,0x3f5b3f05,0x3f7ebe01,0,0,0,0
.long 0x3f793e72,0xbf1dbf4a,0x3f683ed8,0xbee5bf65,0x3f753e95,0x3e95bf75,0x3e953f75,0x3f75be95
.long 0x3f703eb0,0x3f73bea2,0xbf053f5b,0x3e013f7e,0,0,0,0
.long 0xbe873f77,0x3f7cbe3a,0x3f41bf28,0xbf6bbecb,0xbea23f73,0x3f383f32,0x3f7e3e01,0x3f0bbf57
.long 0xbebd3f6e,0xbe1d3f7d,0x3f113f53,0x3f3c3f2d,0,0,0,0
.long 0x3f773e87,0xbe3abf7c,0x3f283f41,0x3ecbbf6b,0x3f733ea2,0x3f32bf38,0xbe013f7e,0x3f573f0b
.long 0x3f6e3ebd,0x3f7d3e1d,0xbf533f11,0xbf2d3f3c,0,0,0,0
.long 0xbf80bc66,0x3f463f22,0x3f7a3e56,0xbf22bf46,0x3e95bf75,0xbf75be95,0xbf753e95,0x3e953f75
.long 0x3f573f0b,0x3f7fbdc9,0x3f32bf38,0x3dc9bf7f,0,0,0,0
.long 0xbc663f80,0x3f22bf46,0xbe563f7a,0x3f46bf22,0xbf75be95,0xbe953f75,0xbe95bf75,0xbf753e95
.long 0x3f0bbf57,0xbdc9bf7f,0x3f383f32,0x3f7f3dc9,0,0,0,0
.long 0xbf17bf4f,0xbef13f62,0x3d2c3f80,0x3f62bef1,0x3f70beb0,0x3dc9bf7f,0xbf05bf5b,0xbf7f3dc9
.long 0x3d8f3f7f,0x3e953f75,0x3f5e3efe,0x3f753e95,0,0,0,0
.long 0xbf4f3f17,0x3f623ef1,0xbf803d2c,0x3ef13f62,0xbeb0bf70,0xbf7fbdc9,0x3f5bbf05,0xbdc9bf7f
.long 0x3f7fbd8f,0x3f75be95,0xbefe3f5e,0xbe953f75,0,0,0,0
.long 0xbe56bf7a,0xbee53f65,0x3c663f80,0x3f1dbf4a,0xbe953f75,0x3f753e95,0x3f75be95,0xbe95bf75
.long 0x3f38bf32,0x3e01bf7e,0xbf0bbf57,0xbf73bea2,0,0,0,0
.long 0xbf7a3e56,0x3f653ee5,0xbf803c66,0x3f4a3f1d,0x3f753e95,0x3e95bf75,0x3e953f75,0x3f75be95
.long 0xbf32bf38,0xbf7ebe01,0x3f57bf0b,0x3ea2bf73,0,0,0,0
.long 0x3f803d2c,0xbecbbf6b,0xbf4fbf17,0xbe3a3f7c,0xbf5bbf05,0xbf573f0b,0xbeb03f70,0x3f323f38
.long 0x3efe3f5e,0x3f2d3f3c,0x3f7f3d8f,0x3f7dbe1d,0,0,0,0
.long 0x3d2cbf80,0xbf6b3ecb,0x3f17bf4f,0xbf7cbe3a,0xbf053f5b,0x3f0b3f57,0xbf70beb0,0xbf383f32
.long 0x3f5ebefe,0x3f3cbf2d,0xbd8f3f7f,0x3e1d3f7d,0,0,0,0
.long 0x3f68bed8,0,0xbf793e72,0,0x3e95bf75,0,0xbf753e95,0
.long 0xbf05bf5b,0,0xbf703eb0,0,0,0,0,0
.long 0xbed8bf68,0,0xbe72bf79,0,0xbf75be95,0,0xbe95bf75,0
.long 0xbf5b3f05,0,0xbeb0bf70,0,0,0,0,0
.long 0xbf283f41,0,0x3f77be87,0,0x3e013f7e,0,0x3f73bea2,0
.long 0x3f533f11,0,0x3f6ebebd,0,0,0,0,0
.long 0x3f413f28,0,0x3e873f77,0,0x3f7ebe01,0,0x3ea23f73,0
.long 0x3f11bf53,0,0x3ebd3f6e,0,0,0,0,0
.long 0xbcac3f80,0xbe793f78,0xbe4f3f7b,0xbed43f69,0xbdd73f7f,0xbf713eac,0xbf5a3f07,0xbf58bf0a
.long 0xbe413f7b,0xbf4ebf18,0xbf77be83,0x3f27bf42,0xbe8a3f76,0x3d49bf80,0xbef5bf61,0x3f293f40
.long 0x3f803cac,0x3f783e79,0xbf7bbe4f,0xbf69bed4,0x3f7f3dd7,0x3eac3f71,0xbf07bf5a,0x3f0abf58
.long 0x3f7b3e41,0xbf183f4e,0x3e83bf77,0x3f423f27,0x3f763e8a,0xbf80bd49,0x3f61bef5,0xbf403f29
.long 0xbd813f7f,0xbf2c3f3e,0xbf133f52,0xbf753e91,0xbe163f7d,0xbf7dbe16,0xbf7d3e16,0xbe16bf7d
.long 0xbe6b3f79,0xbedbbf67,0xbf49bf1e,0x3f80bbe6,0xbe9f3f73,0x3f04bf5c,0xbdbabf7f,0xbe083f7e
.long 0x3f7f3d81,0x3f3e3f2c,0xbf52bf13,0xbe91bf75,0x3f7d3e16,0xbe163f7d,0xbe16bf7d,0x3f7dbe16
.long 0x3f793e6b,0xbf673edb,0x3f1ebf49,0x3be63f80,0x3f733e9f,0xbf5cbf04,0x3f7fbdba,0xbf7ebe08
.long 0xbee83f64,0xbf243f45,0xbf1b3f4b,0xbf453f24,0xbf36bf34,0x3ea6bf72,0x3df4bf7e,0x3f72bea6
.long 0x3f63beee,0x3d103f80,0x3ece3f6a,0xbf80bd10,0x3e333f7c,0xbec7bf6c,0xbf50bf16,0x3f6c3ec7
.long 0x3f643ee8,0x3f453f24,0xbf4bbf1b,0xbf24bf45,0xbf343f36,0xbf72bea6,0x3f7e3df4,0x3ea63f72
.long 0xbeeebf63,0x3f80bd10,0xbf6a3ece,0x3d10bf80,0x3f7cbe33,0xbf6c3ec7,0x3f16bf50,0xbec73f6c
.long 0xbf7d3e24,0xbf5fbefb,0xbf6dbec1,0xbefbbf5f,0x3e16bf7d,0x3f7d3e16,0x3f7dbe16,0x3e163f7d
.long 0x3f663ee1,0xbf7a3e5d,0xbf473f21,0x3e5dbf7a,0xbf313f39,0x3f56bf0d,0x3eb3bf70,0xbf0d3f56
.long 0x3e243f7d,0xbefb3f5f,0x3ec1bf6d,0x3f5fbefb,0xbf7dbe16,0x3e16bf7d,0x3e163f7d,0xbf7d3e16
.long 0x3ee1bf66,0x3e5d3f7a,0xbf21bf47,0x3f7a3e5d,0x3f393f31,0xbf0dbf56,0x3f703eb3,0xbf56bf0d
.long 0xbf4b3f1b,0xbf693ed4,0xbf643ee8,0xbf783e79,0x3f7ebdf4,0x3f0a3f58,0x3f343f36,0xbeac3f71
.long 0xbf6abece,0x3f42bf27,0x3eeebf63,0x3f183f4e,0x3f163f50,0xbf40bf29,0xbf7cbe33,0x3f80bd49
.long 0x3f1b3f4b,0x3ed43f69,0xbee8bf64,0xbe79bf78,0xbdf4bf7e,0x3f58bf0a,0xbf363f34,0xbf71beac
.long 0xbece3f6a,0xbf27bf42,0x3f633eee,0xbf4e3f18,0x3f50bf16,0xbf293f40,0x3e33bf7c,0x3d493f80
.long 0xbec1bf6d,0x3e91bf75,0x3e24bf7d,0x3f3ebf2c,0xbe163f7d,0xbf7dbe16,0xbf7d3e16,0xbe16bf7d
.long 0x3f21bf47,0xbbe63f80,0x3ee13f66,0xbf67bedb,0xbf703eb3,0x3f7ebe08,0x3f39bf31,0xbf5c3f04
.long 0xbf6d3ec1,0xbf75be91,0x3f7d3e24,0x3f2c3f3e,0x3f7d3e16,0xbe163f7d,0xbe16bf7d,0x3f7dbe16
.long 0xbf47bf21,0x3f803be6,0xbf663ee1,0x3edbbf67,0x3eb33f70,0xbe08bf7e,0x3f313f39,0xbf04bf5c
.long 0xbf7b3e4f,0,0xbf803cac,0,0xbf073f5a,0,0xbf7f3dd7,0
.long 0x3e833f77,0,0xbf7b3e41,0,0x3f613ef5,0,0xbf763e8a,0
.long 0x3e4f3f7b,0,0xbcacbf80,0,0x3f5a3f07,0,0xbdd7bf7f,0
.long 0x3f77be83,0,0xbe41bf7b,0,0x3ef5bf61,0,0xbe8abf76,0
.long 0x3f52bf13,0,0x3f7fbd81,0,0x3e16bf7d,0,0x3f7dbe16,0
.long 0xbf1ebf49,0,0x3f79be6b,0,0xbf7fbdba,0,0x3f73be9f,0
.long 0xbf13bf52,0,0x3d813f7f,0,0xbf7dbe16,0,0x3e163f7d,0
.long 0xbf493f1e,0,0x3e6b3f79,0,0xbdba3f7f,0,0x3e9f3f73,0
.long 0xbeb33f70,0x3f5cbf04,0x3e9fbf73,0xbf563f0d,0xbedb3f67,0x3f673edb,0x3f67bedb,0xbedbbf67
.long 0xbf013f5d,0x3e163f7d,0x3f6f3eba,0x3f74be98,0,0,0,0
.long 0x3f703eb3,0xbf04bf5c,0x3f733e9f,0xbf0dbf56,0x3f673edb,0x3edbbf67,0x3edb3f67,0x3f67bedb
.long 0x3f5d3f01,0x3f7dbe16,0xbeba3f6f,0x3e983f74,0,0,0,0
.long 0xbec73f6c,0x3f80bd49,0x3f29bf40,0xbf76be8a,0xbeee3f63,0x3f183f4e,0x3f80bd10,0x3ecebf6a
.long 0xbf0a3f58,0xbeac3f71,0x3f363f34,0x3f5a3f07,0,0,0,0
.long 0x3f6c3ec7,0xbd49bf80,0x3f403f29,0x3e8abf76,0x3f633eee,0x3f4ebf18,0x3d103f80,0x3f6a3ece
.long 0x3f583f0a,0x3f713eac,0xbf343f36,0xbf073f5a,0,0,0,0
.long 0xbf7ebe08,0x3f313f39,0x3f7f3dba,0xbf39bf31,0x3edbbf67,0xbf67bedb,0xbf673edb,0x3edb3f67
.long 0x3f3b3f2f,0x3f7f3d9e,0x3f10bf54,0xbd9ebf7f,0,0,0,0
.long 0xbe083f7e,0x3f39bf31,0xbdba3f7f,0x3f31bf39,0xbf67bedb,0xbedb3f67,0xbedbbf67,0xbf673edb
.long 0x3f2fbf3b,0x3d9ebf7f,0x3f543f10,0x3f7fbd9e,0,0,0,0
.long 0xbef5bf61,0xbf163f50,0x3e333f7c,0x3f50bf16,0x3f7bbe41,0x3e83bf77,0xbf27bf42,0xbf773e83
.long 0xbdf43f7e,0x3dd73f7f,0x3f723ea6,0x3f7f3dd7,0,0,0,0
.long 0xbf613ef5,0x3f503f16,0xbf7c3e33,0x3f163f50,0xbe41bf7b,0xbf77be83,0x3f42bf27,0xbe83bf77
.long 0x3f7e3df4,0x3f7fbdd7,0xbea63f72,0xbdd73f7f,0,0,0,0
.long 0xbdbabf7f,0xbf0d3f56,0x3e083f7e,0x3f04bf5c,0xbedb3f67,0x3f673edb,0x3f67bedb,0xbedbbf67
.long 0x3f54bf10,0x3e98bf74,0xbf2fbf3b,0xbf7dbe16,0,0,0,0
.long 0xbf7f3dba,0x3f563f0d,0xbf7e3e08,0x3f5c3f04,0x3f673edb,0x3edbbf67,0x3edb3f67,0x3f67bedb
.long 0xbf10bf54,0xbf74be98,0x3f3bbf2f,0x3e16bf7d,0,0,0,0
.long 0x3f7c3e33,0xbe8abf76,0xbf61bef5,0xbd493f80,0xbf42bf27,0xbf6a3ece,0xbe413f7b,0x3f4e3f18
.long 0x3ea63f72,0x3f073f5a,0x3f7ebdf4,0x3f71beac,0,0,0,0
.long 0x3e33bf7c,0xbf763e8a,0x3ef5bf61,0xbf80bd49,0xbf273f42,0x3ece3f6a,0xbf7bbe41,0xbf183f4e
.long 0x3f72bea6,0x3f5abf07,0x3df43f7e,0x3eac3f71,0,0,0,0
.long 0x3f73be9f,0,0xbf703eb3,0,0x3edbbf67,0,0xbf673edb,0
.long 0xbebabf6f,0,0xbf5d3f01,0,0,0,0,0
.long 0xbe9fbf73,0,0xbeb3bf70,0,0xbf67bedb,0,0xbedbbf67,0
.long 0xbf6f3eba,0,0xbf01bf5d,0,0,0,0,0
.long 0xbf403f29,0,0x3f6cbec7,0,0xbd103f80,0,0x3f63beee,0
.long 0x3f343f36,0,0x3f58bf0a,0,0,0,0,0
.long 0x3f293f40,0,0x3ec73f6c,0,0x3f803d10,0,0x3eee3f63,0
.long 0x3f36bf34,0,0x3f0a3f58,0,0,0,0,0
.long 0xbce63f80,0xbe803f78,0xbe483f7b,0xbed13f6a,0xbe0f3f7d,0xbf743e9b,0xbf553f0e,0xbf5cbf02
.long 0xbe803f78,0xbf44bf25,0xbf7bbe48,0x3f1abf4d,0xbeb73f6f,0x3e0fbf7d,0xbf0ebf55,0x3f3a3f30
.long 0x3f803ce6,0x3f783e80,0xbf7bbe48,0xbf6abed1,0x3f7d3e0f,0x3e9b3f74,0xbf0ebf55,0x3f02bf5c
.long 0x3f783e80,0xbf253f44,0x3e48bf7b,0x3f4d3f1a,0x3f6f3eb7,0xbf7dbe0f,0x3f55bf0e,0xbf303f3a
.long 0xbdac3f7f,0xbf303f3a,0xbf0e3f55,0xbf743e9b,0xbe483f7b,0xbf7bbe48,0xbf7b3e48,0xbe48bf7b
.long 0xbe9b3f74,0xbeb7bf6f,0xbf55bf0e,0x3f7fbdac,0xbed13f6a,0x3f1abf4d,0xbe48bf7b,0xbce63f80
.long 0x3f7f3dac,0x3f3a3f30,0xbf55bf0e,0xbe9bbf74,0x3f7b3e48,0xbe483f7b,0xbe48bf7b,0x3f7bbe48
.long 0x3f743e9b,0xbf6f3eb7,0x3f0ebf55,0x3dac3f7f,0x3f6a3ed1,0xbf4dbf1a,0x3f7bbe48,0xbf80bce6
.long 0xbeeb3f63,0xbf253f44,0xbf1a3f4d,0xbf443f25,0xbf30bf3a,0x3eb7bf6f,0x3dacbf7f,0x3f6fbeb7
.long 0x3f6abed1,0xbce63f80,0x3eeb3f63,0xbf803ce6,0x3dac3f7f,0xbe9bbf74,0xbf5cbf02,0x3f743e9b
.long 0x3f633eeb,0x3f443f25,0xbf4dbf1a,0xbf25bf44,0xbf3a3f30,0xbf6fbeb7,0x3f7f3dac,0x3eb73f6f
.long 0xbed1bf6a,0x3f803ce6,0xbf633eeb,0xbce6bf80,0x3f7fbdac,0xbf743e9b,0x3f02bf5c,0xbe9b3f74
.long 0xbf7d3e0f,0xbf5cbf02,0xbf6fbeb7,0xbf02bf5c,0x3e48bf7b,0x3f7b3e48,0x3f7bbe48,0x3e483f7b
.long 0x3f5c3f02,0xbf7d3e0f,0xbf3a3f30,0x3e0fbf7d,0xbf443f25,0x3f63beeb,0x3e80bf78,0xbeeb3f63
.long 0x3e0f3f7d,0xbf023f5c,0x3eb7bf6f,0x3f5cbf02,0xbf7bbe48,0x3e48bf7b,0x3e483f7b,0xbf7b3e48
.long 0x3f02bf5c,0x3e0f3f7d,0xbf30bf3a,0x3f7d3e0f,0x3f253f44,0xbeebbf63,0x3f783e80,0xbf63beeb
.long 0xbf4d3f1a,0xbf6a3ed1,0xbf633eeb,0xbf783e80,0x3f7fbdac,0x3f023f5c,0x3f3a3f30,0xbe9b3f74
.long 0xbf63beeb,0x3f4dbf1a,0x3ed1bf6a,0x3f253f44,0x3f023f5c,0xbf30bf3a,0xbf7fbdac,0x3f7dbe0f
.long 0x3f1a3f4d,0x3ed13f6a,0xbeebbf63,0xbe80bf78,0xbdacbf7f,0x3f5cbf02,0xbf303f3a,0xbf74be9b
.long 0xbeeb3f63,0xbf1abf4d,0x3f6a3ed1,0xbf443f25,0x3f5cbf02,0xbf3a3f30,0x3dacbf7f,0x3e0f3f7d
.long 0xbeb7bf6f,0x3e9bbf74,0x3e0fbf7d,0x3f3abf30,0xbe483f7b,0xbf7bbe48,0xbf7b3e48,0xbe48bf7b
.long 0x3f30bf3a,0xbdac3f7f,0x3f023f5c,0xbf6fbeb7,0xbf783e80,0x3f80bce6,0x3f25bf44,0xbf4d3f1a
.long 0xbf6f3eb7,0xbf74be9b,0x3f7d3e0f,0x3f303f3a,0x3f7b3e48,0xbe483f7b,0xbe48bf7b,0x3f7bbe48
.long 0xbf3abf30,0x3f7f3dac,0xbf5c3f02,0x3eb7bf6f,0x3e803f78,0xbce6bf80,0x3f443f25,0xbf1abf4d
.long 0xbf7b3e48,0,0xbf803ce6,0,0xbf0e3f55,0,0xbf7d3e0f,0
.long 0x3e483f7b,0,0xbf783e80,0,0x3f553f0e,0,0xbf6f3eb7,0
.long 0x3e483f7b,0,0xbce6bf80,0,0x3f553f0e,0,0xbe0fbf7d,0
.long 0x3f7bbe48,0,0xbe80bf78,0,0x3f0ebf55,0,0xbeb7bf6f,0
.long 0x3f55bf0e,0,0x3f7fbdac,0,0x3e48bf7b,0,0x3f7bbe48,0
.long 0xbf0ebf55,0,0x3f74be9b,0,0xbf7bbe48,0,0x3f6abed1,0
.long 0xbf0ebf55,0,0x3dac3f7f,0,0xbf7bbe48,0,0x3e483f7b,0
.long 0xbf553f0e,0,0x3e9b3f74,0,0xbe483f7b,0,0x3ed13f6a,0
.long 0xbeeb3f63,0x3f6abed1,0x3e48bf7b,0xbf443f25,0xbf0e3f55,0x3f553f0e,0x3f55bf0e,0xbf0ebf55
.long 0xbf253f44,0xbce63f80,0x3f7b3e48,0x3f63beeb,0,0,0,0
.long 0x3f633eeb,0xbed1bf6a,0x3f7b3e48,0xbf25bf44,0x3f553f0e,0x3f0ebf55,0x3f0e3f55,0x3f55bf0e
.long 0x3f443f25,0x3f803ce6,0xbe483f7b,0x3eeb3f63,0,0,0,0
.long 0xbf023f5c,0x3f7f3dac,0x3f0ebf55,0xbf7dbe0f,0xbf1a3f4d,0x3eeb3f63,0x3f7bbe48,0x3e80bf78
.long 0xbf303f3a,0xbf023f5c,0x3f553f0e,0x3f6f3eb7,0,0,0,0
.long 0x3f5c3f02,0x3dacbf7f,0x3f553f0e,0x3e0fbf7d,0x3f4d3f1a,0x3f63beeb,0x3e483f7b,0x3f783e80
.long 0x3f3a3f30,0x3f5c3f02,0xbf0e3f55,0xbeb73f6f,0,0,0,0
.long 0xbf78be80,0x3f1a3f4d,0x3f80bce6,0xbf4dbf1a,0x3f0ebf55,0xbf55bf0e,0xbf553f0e,0x3f0e3f55
.long 0x3f1a3f4d,0x3f783e80,0x3ed1bf6a,0xbe80bf78,0,0,0,0
.long 0xbe803f78,0x3f4dbf1a,0x3ce63f80,0x3f1abf4d,0xbf55bf0e,0xbf0e3f55,0xbf0ebf55,0xbf553f0e
.long 0x3f4dbf1a,0x3e80bf78,0x3f6a3ed1,0x3f78be80,0,0,0,0
.long 0xbeb7bf6f,0xbf303f3a,0x3e9b3f74,0x3f3abf30,0x3f80bce6,0x3ed1bf6a,0xbf44bf25,0xbf6a3ed1
.long 0xbe9b3f74,0xbdac3f7f,0x3f7d3e0f,0x3f7fbdac,0,0,0,0
.long 0xbf6f3eb7,0x3f3a3f30,0xbf743e9b,0x3f303f3a,0xbce6bf80,0xbf6abed1,0x3f25bf44,0xbed1bf6a
.long 0x3f743e9b,0x3f7f3dac,0xbe0f3f7d,0x3dac3f7f,0,0,0,0
.long 0x3ce6bf80,0xbf253f44,0x3e803f78,0x3ed1bf6a,0xbf0e3f55,0x3f553f0e,0x3f55bf0e,0xbf0ebf55
.long 0x3f6abed1,0x3eebbf63,0xbf4dbf1a,0xbf803ce6,0,0,0,0
.long 0xbf80bce6,0x3f443f25,0xbf783e80,0x3f6a3ed1,0x3f553f0e,0x3f0ebf55,0x3f0e3f55,0x3f55bf0e
.long 0xbed1bf6a,0xbf63beeb,0x3f1abf4d,0xbce6bf80,0,0,0,0
.long 0x3f743e9b,0xbe0fbf7d,0xbf6fbeb7,0x3dac3f7f,0xbf25bf44,0xbf783e80,0xbce63f80,0x3f633eeb
.long 0x3e0f3f7d,0x3eb73f6f,0x3f74be9b,0x3f5cbf02,0,0,0,0
.long 0x3e9bbf74,0xbf7d3e0f,0x3eb7bf6f,0xbf7f3dac,0xbf443f25,0x3e803f78,0xbf80bce6,0xbeeb3f63
.long 0x3f7dbe0f,0x3f6fbeb7,0x3e9b3f74,0x3f023f5c,0,0,0,0
.long 0x3f7bbe48,0,0xbf633eeb,0,0x3f0ebf55,0,0xbf553f0e,0
.long 0xbe48bf7b,0,0xbf443f25,0,0,0,0,0
.long 0xbe48bf7b,0,0xbeebbf63,0,0xbf55bf0e,0,0xbf0ebf55,0
.long 0xbf7b3e48,0,0xbf25bf44,0,0,0,0,0
.long 0xbf553f0e,0,0x3f5cbf02,0,0xbe483f7b,0,0x3f4dbf1a,0
.long 0x3f0e3f55,0,0x3f3abf30,0,0,0,0,0
.long 0x3f0e3f55,0,0x3f023f5c,0,0x3f7b3e48,0,0x3f1a3f4d,0
.long 0x3f55bf0e,0,0x3f303f3a,0,0,0,0,0
.long 0xbd103f80,0xbe833f77,0xbe413f7b,0xbece3f6a,0xbe333f7c,0xbf763e8a,0xbf503f16,0xbf61bef5
.long 0xbe9f3f73,0xbf39bf31,0xbf7ebe08,0x3f0dbf56,0xbee13f66,0x3e6bbf79,0xbf21bf47,0x3f493f1e
.long 0x3f803d10,0x3f773e83,0xbf7bbe41,0xbf6abece,0x3f7c3e33,0x3e8a3f76,0xbf16bf50,0x3ef5bf61
.long 0x3f733e9f,0xbf313f39,0x3e08bf7e,0x3f563f0d,0x3f663ee1,0xbf79be6b,0x3f47bf21,0xbf1e3f49
.long 0xbdd73f7f,0xbf343f36,0xbf0a3f58,0xbf723ea6,0xbe793f78,0xbf78be79,0xbf783e79,0xbe79bf78
.long 0xbec13f6d,0xbe91bf75,0xbf5fbefb,0x3f7dbe24,0xbf013f5d,0x3f2fbf3b,0xbe98bf74,0x3d9e3f7f
.long 0x3f7f3dd7,0x3f363f34,0xbf58bf0a,0xbea6bf72,0x3f783e79,0xbe793f78,0xbe79bf78,0x3f78be79
.long 0x3f6d3ec1,0xbf753e91,0x3efbbf5f,0x3e243f7d,0x3f5d3f01,0xbf3bbf2f,0x3f74be98,0xbf7f3d9e
.long 0xbeee3f63,0xbf273f42,0xbf183f4e,0xbf423f27,0xbf29bf40,0x3ec7bf6c,0x3d49bf80,0x3f6cbec7
.long 0x3f70beb3,0xbdba3f7f,0x3f043f5c,0xbf7f3dba,0xbbe63f80,0xbe5dbf7a,0xbf67bedb,0x3f7a3e5d
.long 0x3f633eee,0x3f423f27,0xbf4ebf18,0xbf27bf42,0xbf403f29,0xbf6cbec7,0x3f803d49,0x3ec73f6c
.long 0xbeb3bf70,0x3f7f3dba,0xbf5c3f04,0xbdbabf7f,0x3f803be6,0xbf7a3e5d,0x3edbbf67,0xbe5d3f7a
.long 0xbf7e3df4,0xbf5abf07,0xbf71beac,0xbf07bf5a,0x3e79bf78,0x3f783e79,0x3f78be79,0x3e793f78
.long 0x3f523f13,0xbf7f3d81,0xbf2c3f3e,0x3d81bf7f,0xbf543f10,0x3f6fbeba,0x3e16bf7d,0xbeba3f6f
.long 0x3df43f7e,0xbf073f5a,0x3eacbf71,0x3f5abf07,0xbf78be79,0x3e79bf78,0x3e793f78,0xbf783e79
.long 0x3f13bf52,0x3d813f7f,0xbf3ebf2c,0x3f7f3d81,0x3f103f54,0xbebabf6f,0x3f7d3e16,0xbf6fbeba
.long 0xbf4e3f18,0xbf6a3ece,0xbf633eee,0xbf773e83,0x3f80bd49,0x3ef53f61,0x3f403f29,0xbe8a3f76
.long 0xbf5cbf04,0x3f56bf0d,0x3eb3bf70,0x3f313f39,0x3edb3f67,0xbf1ebf49,0xbf803be6,0x3f79be6b
.long 0x3f183f4e,0x3ece3f6a,0xbeeebf63,0xbe83bf77,0xbd49bf80,0x3f61bef5,0xbf293f40,0xbf76be8a
.long 0xbf043f5c,0xbf0dbf56,0x3f703eb3,0xbf393f31,0x3f67bedb,0xbf493f1e,0xbbe6bf80,0x3e6b3f79
.long 0xbeacbf71,0x3ea6bf72,0x3df4bf7e,0x3f36bf34,0xbe793f78,0xbf78be79,0xbf783e79,0xbe79bf78
.long 0x3f3ebf2c,0xbe243f7d,0x3f133f52,0xbf75be91,0xbf7d3e16,0x3f7f3d9e,0x3f10bf54,0xbf3b3f2f
.long 0xbf713eac,0xbf72bea6,0x3f7e3df4,0x3f343f36,0x3f783e79,0xbe793f78,0xbe79bf78,0x3f78be79
.long 0xbf2cbf3e,0x3f7d3e24,0xbf523f13,0x3e91bf75,0x3e163f7d,0x3d9ebf7f,0x3f543f10,0xbf2fbf3b
.long 0xbf7b3e41,0,0xbf803d10,0,0xbf163f50,0,0xbf7c3e33,0
.long 0x3e083f7e,0,0xbf733e9f,0,0x3f473f21,0,0xbf663ee1,0
.long 0x3e413f7b,0,0xbd10bf80,0,0x3f503f16,0,0xbe33bf7c,0
.long 0x3f7ebe08,0,0xbe9fbf73,0,0x3f21bf47,0,0xbee1bf66,0
.long 0x3f58bf0a,0,0x3f7fbdd7,0,0x3e79bf78,0,0x3f78be79,0
.long 0xbefbbf5f,0,0x3f6dbec1,0,0xbf74be98,0,0x3f5dbf01,0
.long 0xbf0abf58,0,0x3dd73f7f,0,0xbf78be79,0,0x3e793f78,0
.long 0xbf5f3efb,0,0x3ec13f6d,0,0xbe983f74,0,0x3f013f5d,0
.long 0xbf103f54,0x3f74be98,0x3d9ebf7f,0xbf2f3f3b,0xbf2c3f3e,0x3f3e3f2c,0x3f3ebf2c,0xbf2cbf3e
.long 0xbf453f24,0xbe4f3f7b,0x3f803cac,0x3f4bbf1b,0,0,0,0
.long 0x3f543f10,0xbe98bf74,0x3f7f3d9e,0xbf3bbf2f,0x3f3e3f2c,0x3f2cbf3e,0x3f2c3f3e,0x3f3ebf2c
.long 0x3f243f45,0x3f7b3e4f,0xbcac3f80,0x3f1b3f4b,0,0,0,0
.long 0xbf1e3f49,0x3f7a3e5d,0x3ee1bf66,0xbf80bbe6,0xbf393f31,0x3e9f3f73,0x3f70beb3,0x3dbabf7f
.long 0xbf503f16,0xbf293f40,0x3f6c3ec7,0x3f7c3e33,0,0,0,0
.long 0x3f493f1e,0x3e5dbf7a,0x3f663ee1,0x3be6bf80,0x3f313f39,0x3f73be9f,0x3eb33f70,0x3f7f3dba
.long 0x3f163f50,0x3f403f29,0xbec73f6c,0xbe333f7c,0,0,0,0
.long 0xbf6fbeba,0x3f013f5d,0x3f7dbe16,0xbf5dbf01,0x3f2cbf3e,0xbf3ebf2c,0xbf3e3f2c,0x3f2c3f3e
.long 0x3ee83f64,0x3f693ed4,0x3e79bf78,0xbed4bf69,0,0,0,0
.long 0xbeba3f6f,0x3f5dbf01,0x3e163f7d,0x3f01bf5d,0xbf3ebf2c,0xbf2c3f3e,0xbf2cbf3e,0xbf3e3f2c
.long 0x3f64bee8,0x3ed4bf69,0x3f783e79,0x3f69bed4,0,0,0,0
.long 0xbe6bbf79,0xbf473f21,0x3edb3f67,0x3f21bf47,0x3f7e3e08,0x3f0dbf56,0xbf5cbf04,0xbf563f0d
.long 0xbef53f61,0xbe8a3f76,0x3f80bd49,0x3f76be8a,0,0,0,0
.long 0xbf793e6b,0x3f213f47,0xbf673edb,0x3f473f21,0x3e08bf7e,0xbf56bf0d,0x3f04bf5c,0xbf0dbf56
.long 0x3f613ef5,0x3f763e8a,0x3d493f80,0x3e8a3f76,0,0,0,0
.long 0x3e16bf7d,0xbf3b3f2f,0x3eba3f6f,0x3e98bf74,0xbf2c3f3e,0x3f3e3f2c,0x3f3ebf2c,0xbf2cbf3e
.long 0x3f78be79,0x3f1bbf4b,0xbf64bee8,0xbf7b3e4f,0,0,0,0
.long 0xbf7dbe16,0x3f2f3f3b,0xbf6f3eba,0x3f743e98,0x3f3e3f2c,0x3f2cbf3e,0x3f2c3f3e,0x3f3ebf2c
.long 0xbe79bf78,0xbf4bbf1b,0x3ee8bf64,0xbe4fbf7b,0,0,0,0
.long 0x3f673edb,0xbbe6bf80,0xbf79be6b,0x3e5d3f7a,0xbf04bf5c,0xbf7f3dba,0x3e083f7e,0x3f733e9f
.long 0xbd493f80,0x3e333f7c,0x3f61bef5,0x3f40bf29,0,0,0,0
.long 0x3edbbf67,0xbf803be6,0x3e6bbf79,0xbf7a3e5d,0xbf5c3f04,0x3dba3f7f,0xbf7e3e08,0xbe9f3f73
.long 0x3f803d49,0x3f7cbe33,0x3ef53f61,0x3f293f40,0,0,0,0
.long 0x3f7fbd9e,0,0xbf543f10,0,0x3f2cbf3e,0,0xbf3e3f2c,0
.long 0xbcacbf80,0,0xbf243f45,0,0,0,0,0
.long 0xbd9ebf7f,0,0xbf10bf54,0,0xbf3ebf2c,0,0xbf2cbf3e,0
.long 0xbf803cac,0,0xbf45bf24,0,0,0,0,0
.long 0xbf663ee1,0,0x3f49bf1e,0,0xbeb33f70,0,0x3f31bf39,0
.long 0x3ec73f6c,0,0x3f16bf50,0,0,0,0,0
.long 0x3ee13f66,0,0x3f1e3f49,0,0x3f703eb3,0,0x3f393f31,0
.long 0x3f6cbec7,0,0x3f503f16,0,0,0,0,0
.long 0xbd2c3f80,0xbe873f77,0xbe3a3f7c,0xbecb3f6b,0xbe563f7a,0xbf793e72,0xbf4a3f1d,0xbf65bee5
.long 0xbebd3f6e,0xbf2dbf3c,0xbf7fbd8f,0x3efebf5e,0xbf053f5b,0x3ea2bf73,0xbf32bf38,0x3f573f0b
.long 0x3f803d2c,0x3f773e87,0xbf7cbe3a,0xbf6bbecb,0x3f7a3e56,0x3e723f79,0xbf1dbf4a,0x3ee5bf65
.long 0x3f6e3ebd,0xbf3c3f2d,0x3d8fbf7f,0x3f5e3efe,0x3f5b3f05,0xbf73bea2,0x3f38bf32,0xbf0b3f57
.long 0xbe013f7e,0xbf383f32,0xbf053f5b,0xbf703eb0,0xbe953f75,0xbf75be95,0xbf753e95,0xbe95bf75
.long 0xbee53f65,0xbe56bf7a,0xbf68bed8,0x3f79be72,0xbf173f4f,0x3f41bf28,0xbecbbf6b,0x3e3a3f7c
.long 0x3f7e3e01,0x3f323f38,0xbf5bbf05,0xbeb0bf70,0x3f753e95,0xbe953f75,0xbe95bf75,0x3f75be95
.long 0x3f653ee5,0xbf7a3e56,0x3ed8bf68,0x3e723f79,0x3f4f3f17,0xbf28bf41,0x3f6bbecb,0xbf7c3e3a
.long 0xbef13f62,0xbf283f41,0xbf173f4f,0xbf413f28,0xbf22bf46,0x3ed8bf68,0x3c66bf80,0x3f68bed8
.long 0x3f75be95,0xbe1d3f7d,0x3f113f53,0xbf7d3e1d,0xbdc93f7f,0xbe01bf7e,0xbf70beb0,0x3f7e3e01
.long 0x3f623ef1,0x3f413f28,0xbf4fbf17,0xbf28bf41,0xbf463f22,0xbf68bed8,0x3f803c66,0x3ed83f68
.long 0xbe95bf75,0x3f7d3e1d,0xbf533f11,0xbe1dbf7d,0x3f7f3dc9,0xbf7e3e01,0x3eb0bf70,0xbe013f7e
.long 0xbf7f3dc9,0xbf57bf0b,0xbf73bea2,0xbf0bbf57,0x3e95bf75,0x3f753e95,0x3f75be95,0x3e953f75
.long 0x3f463f22,0xbf80bc66,0xbf1d3f4a,0xbc66bf80,0xbf623ef1,0x3f77be87,0x3d2cbf80,0xbe873f77
.long 0x3dc93f7f,0xbf0b3f57,0x3ea2bf73,0x3f57bf0b,0xbf75be95,0x3e95bf75,0x3e953f75,0xbf753e95
.long 0x3f22bf46,0xbc663f80,0xbf4abf1d,0x3f80bc66,0x3ef13f62,0xbe87bf77,0x3f803d2c,0xbf77be87
.long 0xbf4f3f17,0xbf6b3ecb,0xbf623ef1,0xbf773e87,0x3f80bc66,0x3ee53f65,0x3f463f22,0xbe723f79
.long 0xbf53bf11,0x3f5ebefe,0x3e95bf75,0x3f3c3f2d,0x3eb03f70,0xbf0bbf57,0xbf7f3dc9,0x3f73bea2
.long 0x3f173f4f,0x3ecb3f6b,0xbef1bf62,0xbe87bf77,0xbc66bf80,0x3f65bee5,0xbf223f46,0xbf79be72
.long 0xbf113f53,0xbefebf5e,0x3f753e95,0xbf2d3f3c,0x3f70beb0,0xbf573f0b,0xbdc9bf7f,0x3ea23f73
.long 0xbea2bf73,0x3eb0bf70,0x3dc9bf7f,0x3f32bf38,0xbe953f75,0xbf75be95,0xbf753e95,0xbe95bf75
.long 0x3f4abf1d,0xbe723f79,0x3f223f46,0xbf7abe56,0xbf803d2c,0x3f7c3e3a,0x3ef1bf62,0xbf283f41
.long 0xbf733ea2,0xbf70beb0,0x3f7f3dc9,0x3f383f32,0x3f753e95,0xbe953f75,0xbe95bf75,0x3f75be95
.long 0xbf1dbf4a,0x3f793e72,0xbf463f22,0x3e56bf7a,0x3d2c3f80,0x3e3abf7c,0x3f623ef1,0xbf41bf28
.long 0xbf7c3e3a,0,0xbf803d2c,0,0xbf1d3f4a,0,0xbf7a3e56,0
.long 0x3d8f3f7f,0,0xbf6e3ebd,0,0x3f383f32,0,0xbf5b3f05,0
.long 0x3e3a3f7c,0,0xbd2cbf80,0,0x3f4a3f1d,0,0xbe56bf7a,0
.long 0x3f7fbd8f,0,0xbebdbf6e,0,0x3f32bf38,0,0xbf05bf5b,0
.long 0x3f5bbf05,0,0x3f7ebe01,0,0x3e95bf75,0,0x3f75be95,0
.long 0xbed8bf68,0,0x3f65bee5,0,0xbf6bbecb,0,0x3f4fbf17,0
.long 0xbf05bf5b,0,0x3e013f7e,0,0xbf75be95,0,0x3e953f75,0
.long 0xbf683ed8,0,0x3ee53f65,0,0xbecb3f6b,0,0x3f173f4f,0
.long 0xbf283f41,0x3f7cbe3a,0xbd2cbf80,0xbf173f4f,0xbf463f22,0x3f223f46,0x3f22bf46,0xbf46bf22
.long 0xbf5e3efe,0xbebd3f6e,0x3f7dbe1d,0x3f2dbf3c,0,0,0,0
.long 0x3f413f28,0xbe3abf7c,0x3f80bd2c,0xbf4fbf17,0x3f223f46,0x3f46bf22,0x3f463f22,0x3f22bf46
.long 0x3efe3f5e,0x3f6e3ebd,0x3e1d3f7d,0x3f3c3f2d,0,0,0,0
.long 0xbf383f32,0x3f703eb0,0x3ea2bf73,0xbf7e3e01,0xbf533f11,0x3e1d3f7d,0x3f5ebefe,0xbd8fbf7f
.long 0xbf683ed8,0xbf4a3f1d,0x3f7a3e56,0x3f80bc66,0,0,0,0
.long 0x3f323f38,0x3eb0bf70,0x3f733ea2,0xbe01bf7e,0x3f113f53,0x3f7dbe1d,0x3efe3f5e,0x3f7fbd8f
.long 0x3ed83f68,0x3f1d3f4a,0xbe563f7a,0x3c663f80,0,0,0,0
.long 0xbf62bef1,0x3ecb3f6b,0x3f77be87,0xbf6bbecb,0x3f46bf22,0xbf22bf46,0xbf223f46,0x3f463f22
.long 0x3e953f75,0x3f533f11,0x3d8fbf7f,0xbf11bf53,0,0,0,0
.long 0xbef13f62,0x3f6bbecb,0x3e873f77,0x3ecbbf6b,0xbf22bf46,0xbf463f22,0xbf46bf22,0xbf223f46
.long 0x3f75be95,0x3f11bf53,0x3f7f3d8f,0x3f53bf11,0,0,0,0
.long 0xbdc9bf7f,0xbf5b3f05,0x3f0b3f57,0x3f05bf5b,0x3f753e95,0x3f2dbf3c,0xbf6ebebd,0xbf3c3f2d
.long 0xbf223f46,0xbee53f65,0x3f79be72,0x3f65bee5,0,0,0,0
.long 0xbf7f3dc9,0x3f053f5b,0xbf573f0b,0x3f5b3f05,0x3e95bf75,0xbf3cbf2d,0x3ebdbf6e,0xbf2dbf3c
.long 0x3f463f22,0x3f653ee5,0x3e723f79,0x3ee53f65,0,0,0,0
.long 0x3e87bf77,0xbf4f3f17,0x3ef13f62,0x3e3abf7c,0xbf463f22,0x3f223f46,0x3f22bf46,0xbf46bf22
.long 0x3f7fbd8f,0x3f3cbf2d,0xbf75be95,0xbf6e3ebd,0,0,0,0
.long 0xbf77be87,0x3f173f4f,0xbf623ef1,0x3f7c3e3a,0x3f223f46,0x3f46bf22,0x3f463f22,0x3f22bf46
.long 0xbd8fbf7f,0xbf2dbf3c,0x3e95bf75,0xbebdbf6e,0,0,0,0
.long 0x3f573f0b,0x3e01bf7e,0xbf7fbdc9,0x3eb03f70,0xbebdbf6e,0xbf7fbd8f,0x3e953f75,0x3f7d3e1d
.long 0xbe723f79,0xbc663f80,0x3f46bf22,0x3f1dbf4a,0,0,0,0
.long 0x3f0bbf57,0xbf7ebe01,0x3dc9bf7f,0xbf703eb0,0xbf6e3ebd,0xbd8f3f7f,0xbf753e95,0xbe1d3f7d
.long 0x3f793e72,0x3f803c66,0x3f223f46,0x3f4a3f1d,0,0,0,0
.long 0x3f803d2c,0,0xbf413f28,0,0x3f46bf22,0,0xbf223f46,0
.long 0x3e1dbf7d,0,0xbefe3f5e,0,0,0,0,0
.long 0x3d2cbf80,0,0xbf28bf41,0,0xbf22bf46,0,0xbf46bf22,0
.long 0xbf7dbe1d,0,0xbf5ebefe,0,0,0,0,0
.long 0xbf733ea2,0,0x3f32bf38,0,0xbefe3f5e,0,0x3f11bf53,0
.long 0x3e563f7a,0,0x3ed8bf68,0,0,0,0,0
.long 0x3ea23f73,0,0x3f383f32,0,0x3f5e3efe,0,0x3f533f11,0
.long 0x3f7abe56,0,0x3f683ed8,0,0,0,0,0
.long 0xbd493f80,0xbe8a3f76,0xbe333f7c,0xbec73f6c,0xbe793f78,0xbf7b3e4f,0xbf453f24,0xbf69bed4
.long 0xbedb3f67,0xbf21bf47,0xbf80bbe6,0x3ee1bf66,0xbf183f4e,0x3ecebf6a,0xbf42bf27,0x3f633eee
.long 0x3f803d49,0x3f763e8a,0xbf7cbe33,0xbf6cbec7,0x3f783e79,0x3e4f3f7b,0xbf24bf45,0x3ed4bf69
.long 0x3f673edb,0xbf473f21,0x3be6bf80,0x3f663ee1,0x3f4e3f18,0xbf6abece,0x3f27bf42,0xbeee3f63
.long 0xbe163f7d,0xbf3b3f2f,0xbf013f5d,0xbf6f3eba,0xbeac3f71,0xbf71beac,0xbf713eac,0xbeacbf71
.long 0xbf043f5c,0xbe08bf7e,0xbf70beb3,0x3f73be9f,0xbf2c3f3e,0x3f52bf13,0xbefbbf5f,0x3e913f75
.long 0x3f7d3e16,0x3f2f3f3b,0xbf5dbf01,0xbebabf6f,0x3f713eac,0xbeac3f71,0xbeacbf71,0x3f71beac
.long 0x3f5c3f04,0xbf7e3e08,0x3eb3bf70,0x3e9f3f73,0x3f3e3f2c,0xbf13bf52,0x3f5fbefb,0xbf753e91
.long 0xbef53f61,0xbf293f40,0xbf163f50,0xbf403f29,0xbf1bbf4b,0x3ee8bf64,0xbcacbf80,0x3f64bee8
.long 0x3f79be6b,0xbe5d3f7a,0x3f1e3f49,0xbf7a3e5d,0xbe413f7b,0xbd10bf80,0xbf77be83,0x3f803d10
.long 0x3f613ef5,0x3f403f29,0xbf50bf16,0xbf29bf40,0xbf4b3f1b,0xbf64bee8,0x3f80bcac,0x3ee83f64
.long 0xbe6bbf79,0x3f7a3e5d,0xbf493f1e,0xbe5dbf7a,0x3f7b3e41,0xbf803d10,0x3e83bf77,0xbd103f80
.long 0xbf7f3d9e,0xbf54bf10,0xbf74be98,0xbf10bf54,0x3eacbf71,0x3f713eac,0x3f71beac,0x3eac3f71
.long 0x3f393f31,0xbf7fbdba,0xbf0d3f56,0xbdbabf7f,0xbf6d3ec1,0x3f7dbe24,0xbd81bf7f,0xbe243f7d
.long 0x3d9e3f7f,0xbf103f54,0x3e98bf74,0x3f54bf10,0xbf71beac,0x3eacbf71,0x3eac3f71,0xbf713eac
.long 0x3f31bf39,0xbdba3f7f,0xbf56bf0d,0x3f7fbdba,0x3ec13f6d,0xbe24bf7d,0x3f7fbd81,0xbf7dbe24
.long 0xbf503f16,0xbf6c3ec7,0xbf613ef5,0xbf763e8a,0x3f803cac,0x3ed43f69,0x3f4b3f1b,0xbe4f3f7b
.long 0xbf49bf1e,0x3f66bee1,0x3e6bbf79,0x3f473f21,0x3e833f77,0xbeeebf63,0xbf7b3e41,0x3f6abece
.long 0x3f163f50,0x3ec73f6c,0xbef5bf61,0xbe8abf76,0x3cacbf80,0x3f69bed4,0xbf1b3f4b,0xbf7bbe4f
.long 0xbf1e3f49,0xbee1bf66,0x3f793e6b,0xbf213f47,0x3f77be83,0xbf633eee,0xbe41bf7b,0x3ece3f6a
.long 0xbe98bf74,0x3ebabf6f,0x3d9ebf7f,0x3f2fbf3b,0xbeac3f71,0xbf71beac,0xbf713eac,0xbeacbf71
.long 0x3f56bf0d,0xbe9f3f73,0x3f313f39,0xbf7ebe08,0xbf7fbd81,0x3f753e91,0x3ec1bf6d,0xbf133f52
.long 0xbf743e98,0xbf6fbeba,0x3f7f3d9e,0x3f3b3f2f,0x3f713eac,0xbeac3f71,0xbeacbf71,0x3f71beac
.long 0xbf0dbf56,0x3f733e9f,0xbf393f31,0x3e08bf7e,0xbd813f7f,0x3e91bf75,0x3f6d3ec1,0xbf52bf13
.long 0xbf7c3e33,0,0xbf803d49,0,0xbf243f45,0,0xbf783e79,0
.long 0x3be63f80,0,0xbf673edb,0,0x3f273f42,0,0xbf4e3f18,0
.long 0x3e333f7c,0,0xbd49bf80,0,0x3f453f24,0,0xbe79bf78,0
.long 0x3f80bbe6,0,0xbedbbf67,0,0x3f42bf27,0,0xbf18bf4e,0
.long 0x3f5dbf01,0,0x3f7dbe16,0,0x3eacbf71,0,0x3f71beac,0
.long 0xbeb3bf70,0,0x3f5cbf04,0,0xbf5fbefb,0,0x3f3ebf2c,0
.long 0xbf01bf5d,0,0x3e163f7d,0,0xbf71beac,0,0x3eac3f71,0
.long 0xbf703eb3,0,0x3f043f5c,0,0xbefb3f5f,0,0x3f2c3f3e,0
.long 0xbf3e3f2c,0x3f7fbd81,0xbe24bf7d,0xbefb3f5f,0xbf5c3f04,0x3f043f5c,0x3f04bf5c,0xbf5cbf04
.long 0xbf713eac,0xbf073f5a,0x3f72bea6,0x3f0abf58,0,0,0,0
.long 0x3f2c3f3e,0xbd81bf7f,0x3f7dbe24,0xbf5fbefb,0x3f043f5c,0x3f5cbf04,0x3f5c3f04,0x3f04bf5c
.long 0x3eac3f71,0x3f5a3f07,0x3ea63f72,0x3f583f0a,0,0,0,0
.long 0xbf4e3f18,0x3f633eee,0x3e41bf7b,0xbf773e83,0xbf673edb,0xbbe63f80,0x3f47bf21,0xbe6bbf79
.long 0xbf783e79,0xbf643ee8,0x3f803cac,0x3f7bbe4f,0,0,0,0
.long 0x3f183f4e,0x3eeebf63,0x3f7b3e41,0xbe83bf77,0x3edb3f67,0x3f803be6,0x3f213f47,0x3f79be6b
.long 0x3e793f78,0x3ee83f64,0xbcac3f80,0x3e4f3f7b,0,0,0,0
.long 0xbf52bf13,0x3e913f75,0x3f6dbec1,0xbf75be91,0x3f5cbf04,0xbf04bf5c,0xbf043f5c,0x3f5c3f04
.long 0x3df43f7e,0x3f363f34,0xbdd7bf7f,0xbf34bf36,0,0,0,0
.long 0xbf133f52,0x3f75be91,0x3ec13f6d,0x3e91bf75,0xbf04bf5c,0xbf5c3f04,0xbf5cbf04,0xbf043f5c
.long 0x3f7ebdf4,0x3f34bf36,0x3f7fbdd7,0x3f36bf34,0,0,0,0
.long 0x3d10bf80,0xbf6a3ece,0x3f273f42,0x3ecebf6a,0x3f663ee1,0x3f49bf1e,0xbf7abe5d,0xbf1e3f49
.long 0xbf453f24,0xbf1b3f4b,0x3f69bed4,0x3f4bbf1b,0,0,0,0
.long 0xbf80bd10,0x3ece3f6a,0xbf423f27,0x3f6a3ece,0x3ee1bf66,0xbf1ebf49,0x3e5dbf7a,0xbf49bf1e
.long 0x3f243f45,0x3f4b3f1b,0x3ed43f69,0x3f1b3f4b,0,0,0,0
.long 0x3ec1bf6d,0xbf5f3efb,0x3f133f52,0x3d81bf7f,0xbf5c3f04,0x3f043f5c,0x3f04bf5c,0xbf5cbf04
.long 0x3f7f3dd7,0x3f58bf0a,0xbf7ebdf4,0xbf5a3f07,0,0,0,0
.long 0xbf6dbec1,0x3efb3f5f,0xbf523f13,0x3f7f3d81,0x3f043f5c,0x3f5cbf04,0x3f5c3f04,0x3f04bf5c
.long 0x3dd7bf7f,0xbf0abf58,0x3df4bf7e,0xbf07bf5a,0,0,0,0
.long 0x3f423f27,0x3e83bf77,0xbf803d10,0x3eee3f63,0xbe5dbf7a,0xbf79be6b,0x3ee13f66,0x3f80bbe6
.long 0xbed43f69,0xbe4f3f7b,0x3f24bf45,0x3ee8bf64,0,0,0,0
.long 0x3f27bf42,0xbf77be83,0xbd10bf80,0xbf633eee,0xbf7a3e5d,0xbe6b3f79,0xbf663ee1,0x3be63f80
.long 0x3f693ed4,0x3f7b3e4f,0x3f453f24,0x3f643ee8,0,0,0,0
.long 0x3f7d3e24,0,0xbf2c3f3e,0,0x3f5cbf04,0,0xbf043f5c,0
.long 0x3ea6bf72,0,0xbeac3f71,0,0,0,0,0
.long 0x3e24bf7d,0,0xbf3ebf2c,0,0xbf04bf5c,0,0xbf5cbf04,0
.long 0xbf72bea6,0,0xbf71beac,0,0,0,0,0
.long 0xbf7b3e41,0,0x3f18bf4e,0,0xbf213f47,0,0x3edbbf67,0
.long 0x3cac3f80,0,0x3e79bf78,0,0,0,0,0
.long 0x3e413f7b,0,0x3f4e3f18,0,0x3f473f21,0,0x3f673edb,0
.long 0x3f80bcac,0,0x3f783e79,0,0,0,0,0
.long 0xbd663f80,0xbe8e3f76,0xbe2c3f7c,0xbec43f6d,0xbe8e3f76,0xbf7c3e2c,0xbf3f3f2b,0xbf6dbec4
.long 0xbef83f60,0xbf14bf51,0xbf803d66,0x3ec4bf6d,0xbf2b3f3f,0x3ef8bf60,0xbf51bf14,0x3f6d3ec4
.long 0x3f803d66,0x3f763e8e,0xbf7cbe2c,0xbf6dbec4,0x3f763e8e,0x3e2c3f7c,0xbf2bbf3f,0x3ec4bf6d
.long 0x3f603ef8,0xbf513f14,0xbd66bf80,0x3f6d3ec4,0x3f3f3f2b,0xbf60bef8,0x3f14bf51,0xbec43f6d
.long 0xbe2c3f7c,0xbf3f3f2b,0xbef83f60,0xbf6d3ec4,0xbec43f6d,0xbf6dbec4,0xbf6d3ec4,0xbec4bf6d
.long 0xbf143f51,0xbd66bf80,0xbf76be8e,0x3f6dbec4,0xbf3f3f2b,0x3f60bef8,0xbf14bf51,0x3ec43f6d
.long 0x3f7c3e2c,0x3f2b3f3f,0xbf60bef8,0xbec4bf6d,0x3f6d3ec4,0xbec43f6d,0xbec4bf6d,0x3f6dbec4
.long 0x3f513f14,0xbf803d66,0x3e8ebf76,0x3ec43f6d,0x3f2b3f3f,0xbef8bf60,0x3f51bf14,0xbf6d3ec4
.long 0xbef83f60,0xbf2b3f3f,0xbf143f51,0xbf3f3f2b,0xbf14bf51,0x3ef8bf60,0xbd66bf80,0x3f60bef8
.long 0x3f7cbe2c,0xbe8e3f76,0x3f2b3f3f,0xbf763e8e,0xbe8e3f76,0x3d66bf80,0xbf7cbe2c,0x3f80bd66
.long 0x3f603ef8,0x3f3f3f2b,0xbf51bf14,0xbf2bbf3f,0xbf513f14,0xbf60bef8,0x3f80bd66,0x3ef83f60
.long 0xbe2cbf7c,0x3f763e8e,0xbf3f3f2b,0xbe8ebf76,0x3f763e8e,0xbf80bd66,0x3e2cbf7c,0x3d663f80
.long 0xbf803d66,0xbf51bf14,0xbf76be8e,0xbf14bf51,0x3ec4bf6d,0x3f6d3ec4,0x3f6dbec4,0x3ec43f6d
.long 0x3f2b3f3f,0xbf7cbe2c,0xbef83f60,0xbe2cbf7c,0xbf763e8e,0x3f80bd66,0xbe2cbf7c,0xbd663f80
.long 0x3d663f80,0xbf143f51,0x3e8ebf76,0x3f51bf14,0xbf6dbec4,0x3ec4bf6d,0x3ec43f6d,0xbf6d3ec4
.long 0x3f3fbf2b,0xbe2c3f7c,0xbf60bef8,0x3f7cbe2c,0x3e8e3f76,0xbd66bf80,0x3f7cbe2c,0xbf80bd66
.long 0xbf513f14,0xbf6d3ec4,0xbf603ef8,0xbf763e8e,0x3f803d66,0x3ec43f6d,0x3f513f14,0xbe2c3f7c
.long 0xbf3fbf2b,0x3f6dbec4,0x3e2cbf7c,0x3f513f14,0x3e2c3f7c,0xbec4bf6d,0xbf763e8e,0x3f60bef8
.long 0x3f143f51,0x3ec43f6d,0xbef8bf60,0xbe8ebf76,0x3d66bf80,0x3f6dbec4,0xbf143f51,0xbf7cbe2c
.long 0xbf2b3f3f,0xbec4bf6d,0x3f7c3e2c,0xbf143f51,0x3f7cbe2c,0xbf6d3ec4,0xbe8ebf76,0x3ef83f60
.long 0xbe8ebf76,0x3ec4bf6d,0x3d66bf80,0x3f2bbf3f,0xbec43f6d,0xbf6dbec4,0xbf6d3ec4,0xbec4bf6d
.long 0x3f60bef8,0xbec43f6d,0x3f3f3f2b,0xbf80bd66,0xbf7cbe2c,0x3f6d3ec4,0x3e8ebf76,0xbef83f60
.long 0xbf763e8e,0xbf6dbec4,0x3f803d66,0x3f3f3f2b,0x3f6d3ec4,0xbec43f6d,0xbec4bf6d,0x3f6dbec4
.long 0xbef8bf60,0x3f6d3ec4,0xbf2b3f3f,0x3d66bf80,0xbe2c3f7c,0x3ec4bf6d,0x3f763e8e,0xbf60bef8
.long 0xbf7c3e2c,0,0xbf803d66,0,0xbf2b3f3f,0,0xbf763e8e,0
.long 0xbd663f80,0,0xbf603ef8,0,0x3f143f51,0,0xbf3f3f2b,0
.long 0x3e2c3f7c,0,0xbd66bf80,0,0x3f3f3f2b,0,0xbe8ebf76,0
.long 0x3f803d66,0,0xbef8bf60,0,0x3f51bf14,0,0xbf2bbf3f,0
.long 0x3f60bef8,0,0x3f7cbe2c,0,0x3ec4bf6d,0,0x3f6dbec4,0
.long 0xbe8ebf76,0,0x3f51bf14,0,0xbf51bf14,0,0x3f2bbf3f,0
.long 0xbef8bf60,0,0x3e2c3f7c,0,0xbf6dbec4,0,0x3ec43f6d,0
.long 0xbf763e8e,0,0x3f143f51,0,0xbf143f51,0,0x3f3f3f2b,0
.long 0xbf513f14,0x3f803d66,0xbe8ebf76,0xbec43f6d,0xbf6d3ec4,0x3ec43f6d,0x3ec4bf6d,0xbf6dbec4
.long 0xbf7c3e2c,0xbf2b3f3f,0x3f60bef8,0x3ec4bf6d,0,0,0,0
.long 0x3f143f51,0x3d66bf80,0x3f76be8e,0xbf6dbec4,0x3ec43f6d,0x3f6dbec4,0x3f6d3ec4,0x3ec4bf6d
.long 0x3e2c3f7c,0x3f3f3f2b,0x3ef83f60,0x3f6d3ec4,0,0,0,0
.long 0xbf603ef8,0x3f513f14,0x3d66bf80,0xbf6d3ec4,0xbf763e8e,0xbe2c3f7c,0x3f2bbf3f,0xbec4bf6d
.long 0xbf803d66,0xbf763e8e,0x3f7cbe2c,0x3f6dbec4,0,0,0,0
.long 0x3ef83f60,0x3f14bf51,0x3f803d66,0xbec4bf6d,0x3e8e3f76,0x3f7c3e2c,0x3f3f3f2b,0x3f6dbec4
.long 0x3d663f80,0x3e8e3f76,0x3e2c3f7c,0x3ec43f6d,0,0,0,0
.long 0xbf3fbf2b,0x3e2c3f7c,0x3f60bef8,0xbf7cbe2c,0x3f6dbec4,0xbec4bf6d,0xbec43f6d,0x3f6d3ec4
.long 0xbd663f80,0x3f143f51,0xbe8ebf76,0xbf51bf14,0,0,0,0
.long 0xbf2b3f3f,0x3f7cbe2c,0x3ef83f60,0x3e2cbf7c,0xbec4bf6d,0xbf6d3ec4,0xbf6dbec4,0xbec43f6d
.long 0x3f803d66,0x3f51bf14,0x3f76be8e,0x3f14bf51,0,0,0,0
.long 0x3e2cbf7c,0xbf763e8e,0x3f3f3f2b,0x3e8ebf76,0x3f513f14,0x3f60bef8,0xbf80bd66,0xbef83f60
.long 0xbf603ef8,0xbf3f3f2b,0x3f51bf14,0x3f2bbf3f,0,0,0,0
.long 0xbf7cbe2c,0x3e8e3f76,0xbf2b3f3f,0x3f763e8e,0x3f14bf51,0xbef8bf60,0x3d66bf80,0xbf60bef8
.long 0x3ef83f60,0x3f2b3f3f,0x3f143f51,0x3f3f3f2b,0,0,0,0
.long 0x3ef8bf60,0xbf6d3ec4,0x3f2b3f3f,0xbd66bf80,0xbf6d3ec4,0x3ec43f6d,0x3ec4bf6d,0xbf6dbec4
.long 0x3f763e8e,0x3f6dbec4,0xbf803d66,0xbf3f3f2b,0,0,0,0
.long 0xbf60bef8,0x3ec43f6d,0xbf3f3f2b,0x3f80bd66,0x3ec43f6d,0x3f6dbec4,0x3f6d3ec4,0x3ec4bf6d
.long 0x3e8ebf76,0xbec4bf6d,0xbd66bf80,0xbf2bbf3f,0,0,0,0
.long 0x3f2b3f3f,0x3ec4bf6d,0xbf7c3e2c,0x3f143f51,0xbd66bf80,0xbf6dbec4,0x3f143f51,0x3f7cbe2c
.long 0xbf143f51,0xbec43f6d,0x3ef8bf60,0x3e8ebf76,0,0,0,0
.long 0x3f3fbf2b,0xbf6dbec4,0xbe2cbf7c,0xbf513f14,0xbf803d66,0xbec43f6d,0xbf513f14,0x3e2c3f7c
.long 0x3f513f14,0x3f6d3ec4,0x3f603ef8,0x3f763e8e,0,0,0,0
.long 0x3f763e8e,0,0xbf143f51,0,0x3f6dbec4,0,0xbec43f6d,0
.long 0x3ef8bf60,0,0xbe2c3f7c,0,0,0,0,0
.long 0x3e8ebf76,0,0xbf51bf14,0,0xbec4bf6d,0,0xbf6dbec4,0
.long 0xbf60bef8,0,0xbf7cbe2c,0,0,0,0,0
.long 0xbf803d66,0,0x3ef8bf60,0,0xbf3f3f2b,0,0x3e8ebf76,0
.long 0xbe2c3f7c,0,0x3d66bf80,0,0,0,0,0
.long 0x3d663f80,0,0x3f603ef8,0,0x3f2b3f3f,0,0x3f763e8e,0
.long 0x3f7c3e2c,0,0x3f803d66,0,0,0,0,0
.long 0xbd813f7f,0xbe913f75,0xbe243f7d,0xbec13f6d,0xbe9f3f73,0xbf7e3e08,0xbf393f31,0xbf70beb3
.long 0xbf0a3f58,0xbf07bf5a,0xbf7e3df4,0x3ea6bf72,0xbf3b3f2f,0x3f10bf54,0xbf5dbf01,0x3f743e98
.long 0x3f7f3d81,0x3f753e91,0xbf7dbe24,0xbf6dbec1,0x3f733e9f,0x3e083f7e,0xbf31bf39,0x3eb3bf70
.long 0x3f583f0a,0xbf5a3f07,0xbdf4bf7e,0x3f723ea6,0x3f2f3f3b,0xbf54bf10,0x3f01bf5d,0xbe983f74
.long 0xbe413f7b,0xbf423f27,0xbeee3f63,0xbf6a3ece,0xbedb3f67,0xbf67bedb,0xbf673edb,0xbedbbf67
.long 0xbf243f45,0x3cacbf80,0xbf7bbe4f,0x3f64bee8,0xbf503f16,0x3f6cbec7,0xbf29bf40,0x3ef53f61
.long 0x3f7b3e41,0x3f273f42,0xbf63beee,0xbecebf6a,0x3f673edb,0xbedb3f67,0xbedbbf67,0x3f67bedb
.long 0x3f453f24,0xbf80bcac,0x3e4fbf7b,0x3ee83f64,0x3f163f50,0xbec7bf6c,0x3f40bf29,0xbf613ef5
.long 0xbefb3f5f,0xbf2c3f3e,0xbf133f52,0xbf3e3f2c,0xbf0dbf56,0x3f04bf5c,0xbdbabf7f,0x3f5cbf04
.long 0x3f7fbdd7,0xbeac3f71,0x3f363f34,0xbf713eac,0xbeba3f6f,0x3e16bf7d,0xbf7fbd9e,0x3f7dbe16
.long 0x3f5f3efb,0x3f3e3f2c,0xbf52bf13,0xbf2cbf3e,0xbf563f0d,0xbf5cbf04,0x3f7fbdba,0x3f043f5c
.long 0xbdd7bf7f,0x3f713eac,0xbf343f36,0xbeacbf71,0x3f6f3eba,0xbf7dbe16,0x3d9ebf7f,0x3e163f7d
.long 0xbf803d10,0xbf4ebf18,0xbf77be83,0xbf18bf4e,0x3edbbf67,0x3f673edb,0x3f67bedb,0x3edb3f67
.long 0x3f1b3f4b,0xbf78be79,0xbed43f69,0xbe79bf78,0xbf7c3e33,0x3f803d49,0xbe8abf76,0x3d493f80
.long 0x3d103f80,0xbf183f4e,0x3e83bf77,0x3f4ebf18,0xbf67bedb,0x3edbbf67,0x3edb3f67,0xbf673edb
.long 0x3f4bbf1b,0xbe793f78,0xbf69bed4,0x3f78be79,0x3e333f7c,0x3d49bf80,0x3f76be8a,0xbf803d49
.long 0xbf523f13,0xbf6d3ec1,0xbf5f3efb,0xbf753e91,0x3f7f3dba,0x3eb33f70,0x3f563f0d,0xbe083f7e
.long 0xbf34bf36,0x3f72bea6,0x3dd7bf7f,0x3f5a3f07,0x3d9e3f7f,0xbe98bf74,0xbf6f3eba,0x3f54bf10
.long 0x3f133f52,0x3ec13f6d,0xbefbbf5f,0xbe91bf75,0x3dbabf7f,0x3f70beb3,0xbf0d3f56,0xbf7ebe08
.long 0xbf363f34,0xbea6bf72,0x3f7f3dd7,0xbf073f5a,0x3f7fbd9e,0xbf743e98,0xbebabf6f,0x3f103f54
.long 0xbe83bf77,0x3ecebf6a,0x3d10bf80,0x3f27bf42,0xbedb3f67,0xbf67bedb,0xbf673edb,0xbedbbf67
.long 0x3f69bed4,0xbee83f64,0x3f4b3f1b,0xbf803cac,0xbf76be8a,0x3f613ef5,0x3e33bf7c,0xbec73f6c
.long 0xbf773e83,0xbf6abece,0x3f803d10,0x3f423f27,0x3f673edb,0xbedb3f67,0xbedbbf67,0x3f67bedb
.long 0xbed4bf69,0x3f643ee8,0xbf1b3f4b,0xbcacbf80,0xbe8a3f76,0x3ef5bf61,0x3f7c3e33,0xbf6cbec7
.long 0xbf7d3e24,0,0xbf7f3d81,0,0xbf313f39,0,0xbf733e9f,0
.long 0xbdf43f7e,0,0xbf583f0a,0,0x3f013f5d,0,0xbf2f3f3b,0
.long 0x3e243f7d,0,0xbd81bf7f,0,0x3f393f31,0,0xbe9fbf73,0
.long 0x3f7e3df4,0,0xbf0abf58,0,0x3f5dbf01,0,0xbf3bbf2f,0
.long 0x3f63beee,0,0x3f7bbe41,0,0x3edbbf67,0,0x3f67bedb,0
.long 0xbe4fbf7b,0,0x3f45bf24,0,0xbf40bf29,0,0x3f16bf50,0
.long 0xbeeebf63,0,0x3e413f7b,0,0xbf67bedb,0,0x3edb3f67,0
.long 0xbf7b3e4f,0,0x3f243f45,0,0xbf293f40,0,0x3f503f16,0
.long 0xbf613ef5,0x3f7c3e33,0xbec7bf6c,0xbe8a3f76,0xbf783e79,0x3e793f78,0x3e79bf78,0xbf78be79
.long 0xbf80bbe6,0xbf493f1e,0x3f47bf21,0x3e5dbf7a,0,0,0,0
.long 0x3ef53f61,0x3e33bf7c,0x3f6cbec7,0xbf76be8a,0x3e793f78,0x3f78be79,0x3f783e79,0x3e79bf78
.long 0xbbe63f80,0x3f1e3f49,0x3f213f47,0x3f7a3e5d,0,0,0,0
.long 0xbf6f3eba,0x3f3b3f2f,0xbd9ebf7f,0xbf5d3f01,0xbf7e3df4,0xbea63f72,0x3f0abf58,0xbf07bf5a
.long 0xbf7ebe08,0xbf7f3dba,0x3f70beb3,0x3f56bf0d,0,0,0,0
.long 0x3eba3f6f,0x3f2fbf3b,0x3f7fbd9e,0xbf01bf5d,0x3df43f7e,0x3f723ea6,0x3f583f0a,0x3f5abf07
.long 0xbe083f7e,0x3dba3f7f,0x3eb33f70,0x3f0d3f56,0,0,0,0
.long 0xbf29bf40,0x3d493f80,0x3f50bf16,0xbf80bd49,0x3f78be79,0xbe79bf78,0xbe793f78,0x3f783e79
.long 0xbe6b3f79,0x3edb3f67,0xbee1bf66,0xbf67bedb,0,0,0,0
.long 0xbf403f29,0x3f80bd49,0x3f163f50,0x3d49bf80,0xbe79bf78,0xbf783e79,0xbf78be79,0xbe793f78
.long 0x3f793e6b,0x3f67bedb,0x3f66bee1,0x3edbbf67,0,0,0,0
.long 0x3e98bf74,0xbf7d3e16,0x3f543f10,0x3e16bf7d,0x3f363f34,0x3f71beac,0xbf7f3dd7,0xbeac3f71
.long 0xbf733e9f,0xbf5c3f04,0x3f31bf39,0x3f04bf5c,0,0,0,0
.long 0xbf74be98,0x3e163f7d,0xbf103f54,0x3f7d3e16,0x3f34bf36,0xbeacbf71,0xbdd7bf7f,0xbf71beac
.long 0x3e9f3f73,0x3f043f5c,0x3f393f31,0x3f5c3f04,0,0,0,0
.long 0x3f16bf50,0xbf763e8a,0x3f403f29,0xbe33bf7c,0xbf783e79,0x3e793f78,0x3e79bf78,0xbf78be79
.long 0x3f663ee1,0x3f7abe5d,0xbf793e6b,0xbf1e3f49,0,0,0,0
.long 0xbf50bf16,0x3e8a3f76,0xbf293f40,0x3f7cbe33,0x3e793f78,0x3f78be79,0x3f783e79,0x3e79bf78
.long 0x3ee1bf66,0xbe5dbf7a,0xbe6bbf79,0xbf49bf1e,0,0,0,0
.long 0x3f103f54,0x3f01bf5d,0xbf743e98,0x3f2f3f3b,0x3dd7bf7f,0xbf5abf07,0x3f343f36,0x3f72bea6
.long 0xbf393f31,0xbf0d3f56,0x3e9fbf73,0x3dbabf7f,0,0,0,0
.long 0x3f54bf10,0xbf5dbf01,0xbe98bf74,0xbf3b3f2f,0xbf7fbdd7,0xbf073f5a,0xbf363f34,0x3ea63f72
.long 0x3f313f39,0x3f563f0d,0x3f733e9f,0x3f7f3dba,0,0,0,0
.long 0x3f6c3ec7,0,0xbef53f61,0,0x3f78be79,0,0xbe793f78,0
.long 0x3f21bf47,0,0x3be63f80,0,0,0,0,0
.long 0x3ec7bf6c,0,0xbf61bef5,0,0xbe79bf78,0,0xbf78be79,0
.long 0xbf47bf21,0,0xbf803be6,0,0,0,0,0
.long 0xbf7fbd9e,0,0x3ebabf6f,0,0xbf583f0a,0,0x3df4bf7e,0
.long 0xbeb33f70,0,0xbe08bf7e,0,0,0,0,0
.long 0xbd9e3f7f,0,0x3f6f3eba,0,0x3f0a3f58,0,0x3f7e3df4,0
.long 0x3f703eb3,0,0x3f7ebe08,0,0,0,0,0
.long 0xbd8f3f7f,0xbe953f75,0xbe1d3f7d,0xbebd3f6e,0xbeb03f70,0xbf7f3dc9,0xbf323f38,0xbf73bea2
.long 0xbf173f4f,0xbef1bf62,0xbf7c3e3a,0x3e87bf77,0xbf4a3f1d,0x3f22bf46,0xbf68bed8,0x3f7a3e56
.long 0x3f7f3d8f,0x3f753e95,0xbf7dbe1d,0xbf6ebebd,0x3f703eb0,0x3dc93f7f,0xbf38bf32,0x3ea2bf73
.long 0x3f4f3f17,0xbf623ef1,0xbe3abf7c,0x3f773e87,0x3f1d3f4a,0xbf46bf22,0x3ed8bf68,0xbe563f7a
.long 0xbe563f7a,0xbf463f22,0xbee53f65,0xbf683ed8,0xbef13f62,0xbf62bef1,0xbf623ef1,0xbef1bf62
.long 0xbf323f38,0x3dc9bf7f,0xbf7ebe01,0x3f5bbf05,0xbf5e3efe,0x3f75be95,0xbf3cbf2d,0x3f113f53
.long 0x3f7a3e56,0x3f223f46,0xbf65bee5,0xbed8bf68,0x3f623ef1,0xbef13f62,0xbef1bf62,0x3f62bef1
.long 0x3f383f32,0xbf7fbdc9,0x3e01bf7e,0x3f053f5b,0x3efe3f5e,0xbe95bf75,0x3f2dbf3c,0xbf533f11
.long 0xbefe3f5e,0xbf2d3f3c,0xbf113f53,0xbf3c3f2d,0xbf05bf5b,0x3f0bbf57,0xbe01bf7e,0x3f57bf0b
.long 0x3f80bd2c,0xbecb3f6b,0x3f413f28,0xbf6b3ecb,0xbee53f65,0x3e72bf79,0xbf803c66,0x3f79be72
.long 0x3f5e3efe,0x3f3c3f2d,0xbf53bf11,0xbf2dbf3c,0xbf5b3f05,0xbf57bf0b,0x3f7ebe01,0x3f0b3f57
.long 0xbd2cbf80,0x3f6b3ecb,0xbf283f41,0xbecbbf6b,0x3f653ee5,0xbf79be72,0xbc66bf80,0x3e723f79
.long 0xbf803c66,0xbf4abf1d,0xbf79be72,0xbf1dbf4a,0x3ef1bf62,0x3f623ef1,0x3f62bef1,0x3ef13f62
.long 0x3f0b3f57,0xbf73bea2,0xbeb03f70,0xbea2bf73,0xbf7f3d8f,0x3f7d3e1d,0xbebdbf6e,0x3e1d3f7d
.long 0x3c663f80,0xbf1d3f4a,0x3e72bf79,0x3f4abf1d,0xbf62bef1,0x3ef1bf62,0x3ef13f62,0xbf623ef1
.long 0x3f57bf0b,0xbea23f73,0xbf70beb0,0x3f73bea2,0x3d8f3f7f,0x3e1dbf7d,0x3f6ebebd,0xbf7d3e1d
.long 0xbf533f11,0xbf6e3ebd,0xbf5e3efe,0xbf753e95,0x3f7e3e01,0x3ea23f73,0x3f5b3f05,0xbdc93f7f
.long 0xbf28bf41,0x3f77be87,0x3d2cbf80,0x3f623ef1,0xbc663f80,0xbe56bf7a,0xbf653ee5,0x3f46bf22
.long 0x3f113f53,0x3ebd3f6e,0xbefebf5e,0xbe95bf75,0x3e01bf7e,0x3f73bea2,0xbf053f5b,0xbf7fbdc9
.long 0xbf413f28,0xbe87bf77,0x3f803d2c,0xbef13f62,0x3f803c66,0xbf7a3e56,0xbee5bf65,0x3f223f46
.long 0xbe72bf79,0x3ed8bf68,0x3c66bf80,0x3f22bf46,0xbef13f62,0xbf62bef1,0xbf623ef1,0xbef1bf62
.long 0x3f70beb0,0xbf053f5b,0x3f573f0b,0xbf7f3dc9,0xbf6ebebd,0x3f533f11,0x3d8fbf7f,0xbe953f75
.long 0xbf793e72,0xbf68bed8,0x3f803c66,0x3f463f22,0x3f623ef1,0xbef13f62,0xbef1bf62,0x3f62bef1
.long 0xbeb0bf70,0x3f5b3f05,0xbf0b3f57,0xbdc9bf7f,0xbebd3f6e,0x3f11bf53,0x3f7f3d8f,0xbf75be95
.long 0xbf7d3e1d,0,0xbf7f3d8f,0,0xbf383f32,0,0xbf703eb0,0
.long 0xbe3a3f7c,0,0xbf4f3f17,0,0x3ed83f68,0,0xbf1d3f4a,0
.long 0x3e1d3f7d,0,0xbd8fbf7f,0,0x3f323f38,0,0xbeb0bf70,0
.long 0x3f7c3e3a,0,0xbf17bf4f,0,0x3f68bed8,0,0xbf4abf1d,0
.long 0x3f65bee5,0,0x3f7abe56,0,0x3ef1bf62,0,0x3f62bef1,0
.long 0xbe01bf7e,0,0x3f38bf32,0,0xbf2dbf3c,0,0x3efebf5e,0
.long 0xbee5bf65,0,0x3e563f7a,0,0xbf62bef1,0,0x3ef13f62,0
.long 0xbf7e3e01,0,0x3f323f38,0,0xbf3c3f2d,0,0x3f5e3efe,0
.long 0xbf6e3ebd,0x3f753e95,0xbefebf5e,0xbe1d3f7d,0xbf7f3dc9,0x3dc93f7f,0x3dc9bf7f,0xbf7fbdc9
.long 0xbf7cbe3a,0xbf623ef1,0x3f28bf41,0x3d2cbf80,0,0,0,0
.long 0x3ebd3f6e,0x3e95bf75,0x3f5ebefe,0xbf7dbe1d,0x3dc93f7f,0x3f7fbdc9,0x3f7f3dc9,0x3dc9bf7f
.long 0xbe3a3f7c,0x3ef13f62,0x3f413f28,0x3f803d2c,0,0,0,0
.long 0xbf793e72,0x3f223f46,0xbe56bf7a,0xbf4a3f1d,0xbf80bd2c,0xbef13f62,0x3ecbbf6b,0xbf28bf41
.long 0xbf73bea2,0xbf7fbdc9,0x3f5bbf05,0x3f38bf32,0,0,0,0
.long 0x3e723f79,0x3f46bf22,0x3f7abe56,0xbf1dbf4a,0xbd2c3f80,0x3f623ef1,0x3f6b3ecb,0x3f41bf28
.long 0xbea23f73,0xbdc93f7f,0x3f053f5b,0x3f323f38,0,0,0,0
.long 0xbf11bf53,0xbd8f3f7f,0x3f3cbf2d,0xbf7f3d8f,0x3f7fbdc9,0xbdc9bf7f,0xbdc93f7f,0x3f7f3dc9
.long 0xbecb3f6b,0x3e873f77,0xbf17bf4f,0xbf77be87,0,0,0,0
.long 0xbf533f11,0x3f7f3d8f,0x3f2d3f3c,0xbd8fbf7f,0xbdc9bf7f,0xbf7f3dc9,0xbf7fbdc9,0xbdc93f7f
.long 0x3f6b3ecb,0x3f77be87,0x3f4fbf17,0x3e87bf77,0,0,0,0
.long 0x3ed8bf68,0xbf803c66,0x3f653ee5,0x3c66bf80,0x3f173f4f,0x3f7cbe3a,0xbf773e87,0xbe3a3f7c
.long 0xbf7e3e01,0xbf703eb0,0x3f0bbf57,0x3eb0bf70,0,0,0,0
.long 0xbf68bed8,0x3c663f80,0xbee53f65,0x3f803c66,0x3f4fbf17,0xbe3abf7c,0xbe87bf77,0xbf7cbe3a
.long 0x3e013f7e,0x3eb03f70,0x3f573f0b,0x3f703eb0,0,0,0,0
.long 0x3f2dbf3c,0xbf7d3e1d,0x3f533f11,0xbe95bf75,0xbf7f3dc9,0x3dc93f7f,0x3dc9bf7f,0xbf7fbdc9
.long 0x3f4f3f17,0x3f80bd2c,0xbf6b3ecb,0xbef13f62,0,0,0,0
.long 0xbf3cbf2d,0x3e1d3f7d,0xbf113f53,0x3f75be95,0x3dc93f7f,0x3f7fbdc9,0x3f7f3dc9,0x3dc9bf7f
.long 0x3f17bf4f,0xbd2cbf80,0xbecbbf6b,0xbf62bef1,0,0,0,0
.long 0x3ee53f65,0x3f1dbf4a,0xbf683ed8,0x3f463f22,0x3e87bf77,0xbf41bf28,0x3f4f3f17,0x3f62bef1
.long 0xbf573f0b,0xbf323f38,0x3e01bf7e,0xbdc9bf7f,0,0,0,0
.long 0x3f65bee5,0xbf4abf1d,0xbed8bf68,0xbf223f46,0xbf77be87,0xbf283f41,0xbf173f4f,0x3ef13f62
.long 0x3f0b3f57,0x3f383f32,0x3f7e3e01,0x3f7fbdc9,0,0,0,0
.long 0x3f5e3efe,0,0xbebd3f6e,0,0x3f7fbdc9,0,0xbdc93f7f,0
.long 0x3f41bf28,0,0x3e3a3f7c,0,0,0,0,0
.long 0x3efebf5e,0,0xbf6ebebd,0,0xbdc9bf7f,0,0xbf7fbdc9,0
.long 0xbf28bf41,0,0xbf7c3e3a,0,0,0,0,0
.long 0xbf7abe56,0,0x3e72bf79,0,0xbf6b3ecb,0,0xbd2cbf80,0
.long 0xbf053f5b,0,0xbea2bf73,0,0,0,0,0
.long 0xbe563f7a,0,0x3f793e72,0,0x3ecb3f6b,0,0x3f80bd2c,0
.long 0x3f5b3f05,0,0x3f73bea2,0,0,0,0,0
.long 0xbd9e3f7f,0xbe983f74,0xbe163f7d,0xbeba3f6f,0xbec13f6d,0xbf7f3d81,0xbf2c3f3e,0xbf75be91
.long 0xbf243f45,0xbed4bf69,0xbf783e79,0x3e4fbf7b,0xbf583f0a,0x3f34bf36,0xbf71beac,0x3f7e3df4
.long 0x3f7f3d9e,0x3f743e98,0xbf7dbe16,0xbf6fbeba,0x3f6d3ec1,0x3d813f7f,0xbf3ebf2c,0x3e91bf75
.long 0x3f453f24,0xbf693ed4,0xbe79bf78,0x3f7b3e4f,0x3f0a3f58,0xbf36bf34,0x3eacbf71,0xbdf43f7e
.long 0xbe6b3f79,0xbf493f1e,0xbedb3f67,0xbf663ee1,0xbf043f5c,0xbf5cbf04,0xbf5c3f04,0xbf04bf5c
.long 0xbf403f29,0x3e33bf7c,0xbf80bd49,0x3f50bf16,0xbf6a3ece,0x3f7bbe41,0xbf4ebf18,0x3f273f42
.long 0x3f793e6b,0x3f1e3f49,0xbf67bedb,0xbee1bf66,0x3f5c3f04,0xbf043f5c,0xbf04bf5c,0x3f5cbf04
.long 0x3f293f40,0xbf7cbe33,0x3d49bf80,0x3f163f50,0x3ece3f6a,0xbe41bf7b,0x3f18bf4e,0xbf423f27
.long 0xbf013f5d,0xbf2f3f3b,0xbf103f54,0xbf3b3f2f,0xbefbbf5f,0x3f13bf52,0xbe24bf7d,0x3f52bf13
.long 0x3f803cac,0xbee83f64,0x3f4b3f1b,0xbf643ee8,0xbf073f5a,0x3ea6bf72,0xbf7f3dd7,0x3f72bea6
.long 0x3f5d3f01,0x3f3b3f2f,0xbf54bf10,0xbf2fbf3b,0xbf5f3efb,0xbf52bf13,0x3f7dbe24,0x3f133f52
.long 0x3cacbf80,0x3f643ee8,0xbf1b3f4b,0xbee8bf64,0x3f5a3f07,0xbf72bea6,0xbdd7bf7f,0x3ea63f72
.long 0xbf80bbe6,0xbf47bf21,0xbf7abe5d,0xbf21bf47,0x3f04bf5c,0x3f5c3f04,0x3f5cbf04,0x3f043f5c
.long 0x3ef53f61,0xbf6cbec7,0xbe8a3f76,0xbec7bf6c,0xbf80bd10,0x3f773e83,0xbeeebf63,0x3e833f77
.long 0xbbe63f80,0xbf213f47,0x3e5dbf7a,0x3f47bf21,0xbf5cbf04,0x3f04bf5c,0x3f043f5c,0xbf5c3f04
.long 0x3f61bef5,0xbec73f6c,0xbf76be8a,0x3f6cbec7,0xbd103f80,0x3e83bf77,0x3f63beee,0xbf773e83
.long 0xbf543f10,0xbf6f3eba,0xbf5d3f01,0xbf743e98,0x3f7d3e24,0x3e913f75,0x3f5f3efb,0xbd813f7f
.long 0xbf1bbf4b,0x3f7bbe4f,0xbcacbf80,0x3f693ed4,0xbdd73f7f,0xbdf4bf7e,0xbf5a3f07,0x3f36bf34
.long 0x3f103f54,0x3eba3f6f,0xbf01bf5d,0xbe98bf74,0x3e24bf7d,0x3f75be91,0xbefb3f5f,0xbf7fbd81
.long 0xbf4b3f1b,0xbe4fbf7b,0x3f80bcac,0xbed43f69,0x3f7f3dd7,0xbf7e3df4,0xbf07bf5a,0x3f343f36
.long 0xbe5dbf7a,0x3ee1bf66,0xbbe6bf80,0x3f1ebf49,0xbf043f5c,0xbf5cbf04,0xbf5c3f04,0xbf04bf5c
.long 0x3f76be8a,0xbf163f50,0x3f613ef5,0xbf7c3e33,0xbf63beee,0x3f423f27,0xbd10bf80,0xbe413f7b
.long 0xbf7a3e5d,0xbf66bee1,0x3f80bbe6,0x3f493f1e,0x3f5c3f04,0xbf043f5c,0xbf04bf5c,0x3f5cbf04
.long 0xbe8abf76,0x3f503f16,0xbef53f61,0xbe33bf7c,0xbeee3f63,0x3f27bf42,0x3f80bd10,0xbf7bbe41
.long 0xbf7d3e16,0,0xbf7f3d9e,0,0xbf3e3f2c,0,0xbf6d3ec1,0
.long 0xbe793f78,0,0xbf453f24,0,0x3eac3f71,0,0xbf0a3f58,0
.long 0x3e163f7d,0,0xbd9ebf7f,0,0x3f2c3f3e,0,0xbec1bf6d,0
.long 0x3f783e79,0,0xbf24bf45,0,0x3f71beac,0,0xbf58bf0a,0
.long 0x3f67bedb,0,0x3f79be6b,0,0x3f04bf5c,0,0x3f5cbf04,0
.long 0xbd49bf80,0,0x3f29bf40,0,0xbf18bf4e,0,0x3ecebf6a,0
.long 0xbedbbf67,0,0x3e6b3f79,0,0xbf5cbf04,0,0x3f043f5c,0
.long 0xbf803d49,0,0x3f403f29,0,0xbf4e3f18,0,0x3f6a3ece,0
.long 0xbf773e83,0x3f6a3ece,0xbf18bf4e,0xbd103f80,0xbf80bd49,0xbd493f80,0xbd49bf80,0xbf803d49
.long 0xbf70beb3,0xbf733e9f,0x3f04bf5c,0xbe08bf7e,0,0,0,0
.long 0x3e833f77,0x3ecebf6a,0x3f4ebf18,0xbf80bd10,0xbd493f80,0x3f803d49,0x3f80bd49,0xbd49bf80
.long 0xbeb33f70,0x3e9f3f73,0x3f5c3f04,0x3f7ebe08,0,0,0,0
.long 0xbf7f3dd7,0x3f073f5a,0xbeacbf71,0xbf343f36,0xbf7bbe4f,0xbf1b3f4b,0x3e79bf78,0xbf45bf24
.long 0xbf5fbefb,0xbf75be91,0x3f3ebf2c,0x3f13bf52,0,0,0,0
.long 0x3dd73f7f,0x3f5abf07,0x3f71beac,0xbf36bf34,0xbe4f3f7b,0x3f4b3f1b,0x3f783e79,0x3f24bf45
.long 0xbefb3f5f,0xbe913f75,0x3f2c3f3e,0x3f523f13,0,0,0,0
.long 0xbeeebf63,0xbe413f7b,0x3f27bf42,0xbf7b3e41,0x3f803d49,0x3d49bf80,0x3d493f80,0x3f80bd49
.long 0xbf0d3f56,0x3dba3f7f,0xbf39bf31,0xbf7fbdba,0,0,0,0
.long 0xbf633eee,0x3f7b3e41,0x3f423f27,0xbe41bf7b,0x3d49bf80,0xbf80bd49,0xbf803d49,0x3d493f80
.long 0x3f563f0d,0x3f7fbdba,0x3f31bf39,0x3dbabf7f,0,0,0,0
.long 0x3f0abf58,0xbf7ebdf4,0x3f723ea6,0xbdf4bf7e,0x3ee83f64,0x3f80bcac,0xbf693ed4,0xbcac3f80
.long 0xbf7fbd81,0xbf7d3e24,0x3ec1bf6d,0x3e24bf7d,0,0,0,0
.long 0xbf58bf0a,0xbdf43f7e,0xbea63f72,0x3f7ebdf4,0x3f64bee8,0xbcacbf80,0xbed4bf69,0xbf80bcac
.long 0xbd813f7f,0x3e243f7d,0x3f6d3ec1,0x3f7d3e24,0,0,0,0
.long 0x3f42bf27,0xbf803d10,0x3f633eee,0xbecebf6a,0xbf80bd49,0xbd493f80,0xbd49bf80,0xbf803d49
.long 0x3f313f39,0x3f7e3e08,0xbf563f0d,0xbe9f3f73,0,0,0,0
.long 0xbf27bf42,0x3d103f80,0xbeee3f63,0x3f6abece,0xbd493f80,0x3f803d49,0x3f80bd49,0xbd49bf80
.long 0x3f39bf31,0x3e08bf7e,0xbf0dbf56,0xbf73be9f,0,0,0,0
.long 0x3ea63f72,0x3f36bf34,0xbf583f0a,0x3f5a3f07,0x3ed4bf69,0xbf24bf45,0x3f643ee8,0x3f4bbf1b
.long 0xbf6d3ec1,0xbf523f13,0xbd81bf7f,0xbe91bf75,0,0,0,0
.long 0x3f72bea6,0xbf34bf36,0xbf0abf58,0xbf073f5a,0xbf69bed4,0xbf453f24,0xbee83f64,0x3f1b3f4b
.long 0x3ec13f6d,0x3f133f52,0x3f7fbd81,0x3f75be91,0,0,0,0
.long 0x3f4e3f18,0,0xbe833f77,0,0x3f803d49,0,0x3d493f80,0
.long 0x3f5cbf04,0,0x3eb33f70,0,0,0,0,0
.long 0x3f18bf4e,0,0xbf77be83,0,0x3d49bf80,0,0xbf803d49,0
.long 0xbf04bf5c,0,0xbf703eb3,0,0,0,0,0
.long 0xbf71beac,0,0x3dd7bf7f,0,0xbf783e79,0,0xbe4fbf7b,0
.long 0xbf2c3f3e,0,0xbefbbf5f,0,0,0,0,0
.long 0xbeac3f71,0,0x3f7f3dd7,0,0x3e793f78,0,0x3f7bbe4f,0
.long 0x3f3e3f2c,0,0x3f5fbefb,0,0,0,0,0
.long 0xbdac3f7f,0xbe9b3f74,0xbe0f3f7d,0xbeb73f6f,0xbed13f6a,0xbf803ce6,0xbf253f44,0xbf78be80
.long 0xbf303f3a,0xbeb7bf6f,0xbf743e9b,0x3e0fbf7d,0xbf633eeb,0x3f44bf25,0xbf78be80,0x3f803ce6
.long 0x3f7f3dac,0x3f743e9b,0xbf7dbe0f,0xbf6fbeb7,0x3f6a3ed1,0x3ce63f80,0xbf44bf25,0x3e80bf78
.long 0x3f3a3f30,0xbf6f3eb7,0xbe9bbf74,0x3f7d3e0f,0x3eeb3f63,0xbf25bf44,0x3e80bf78,0xbce63f80
.long 0xbe803f78,0xbf4d3f1a,0xbed13f6a,0xbf633eeb,0xbf0e3f55,0xbf55bf0e,0xbf553f0e,0xbf0ebf55
.long 0xbf4d3f1a,0x3e80bf78,0xbf803ce6,0x3f44bf25,0xbf743e9b,0x3f7fbdac,0xbf5cbf02,0x3f3a3f30
.long 0x3f783e80,0x3f1a3f4d,0xbf6abed1,0xbeebbf63,0x3f553f0e,0xbf0e3f55,0xbf0ebf55,0x3f55bf0e
.long 0x3f1a3f4d,0xbf78be80,0xbce6bf80,0x3f253f44,0x3e9b3f74,0xbdacbf7f,0x3f02bf5c,0xbf303f3a
.long 0xbf023f5c,0xbf303f3a,0xbf0e3f55,0xbf3a3f30,0xbeebbf63,0x3f1abf4d,0xbe48bf7b,0x3f4dbf1a
.long 0x3f7f3dac,0xbf023f5c,0x3f553f0e,0xbf5c3f02,0xbf1a3f4d,0x3ed1bf6a,0xbf7b3e48,0x3f6abed1
.long 0x3f5c3f02,0x3f3a3f30,0xbf55bf0e,0xbf30bf3a,0xbf633eeb,0xbf4dbf1a,0x3f7bbe48,0x3f1a3f4d
.long 0x3dacbf7f,0x3f5c3f02,0xbf0e3f55,0xbf02bf5c,0x3f4d3f1a,0xbf6abed1,0xbe48bf7b,0x3ed13f6a
.long 0xbf80bce6,0xbf44bf25,0xbf7bbe48,0xbf25bf44,0x3f0ebf55,0x3f553f0e,0x3f55bf0e,0x3f0e3f55
.long 0x3ed13f6a,0xbf63beeb,0xbe483f7b,0xbeebbf63,0xbf7dbe0f,0x3f6f3eb7,0xbf0ebf55,0x3eb73f6f
.long 0xbce63f80,0xbf253f44,0x3e48bf7b,0x3f44bf25,0xbf55bf0e,0x3f0ebf55,0x3f0e3f55,0xbf553f0e
.long 0x3f6abed1,0xbeeb3f63,0xbf7bbe48,0x3f63beeb,0xbe0f3f7d,0x3eb7bf6f,0x3f55bf0e,0xbf6f3eb7
.long 0xbf553f0e,0xbf6f3eb7,0xbf5c3f02,0xbf743e9b,0x3f7b3e48,0x3e803f78,0x3f633eeb,0xbce63f80
.long 0xbf0ebf55,0x3f7dbe0f,0xbdacbf7f,0x3f6f3eb7,0xbe483f7b,0xbce6bf80,0xbf4d3f1a,0x3f25bf44
.long 0x3f0e3f55,0x3eb73f6f,0xbf02bf5c,0xbe9bbf74,0x3e48bf7b,0x3f78be80,0xbeeb3f63,0xbf80bce6
.long 0xbf553f0e,0xbe0fbf7d,0x3f7fbdac,0xbeb73f6f,0x3f7b3e48,0xbf803ce6,0xbf1abf4d,0x3f443f25
.long 0xbe48bf7b,0x3eebbf63,0xbce6bf80,0x3f1abf4d,0xbf0e3f55,0xbf55bf0e,0xbf553f0e,0xbf0ebf55
.long 0x3f7bbe48,0xbf253f44,0x3f6a3ed1,0xbf783e80,0xbf55bf0e,0x3f303f3a,0xbe0fbf7d,0xbdac3f7f
.long 0xbf7b3e48,0xbf63beeb,0x3f80bce6,0x3f4d3f1a,0x3f553f0e,0xbf0e3f55,0xbf0ebf55,0x3f55bf0e
.long 0xbe48bf7b,0x3f443f25,0xbed13f6a,0xbe80bf78,0xbf0e3f55,0x3f3abf30,0x3f7dbe0f,0xbf7fbdac
.long 0xbf7d3e0f,0,0xbf7f3dac,0,0xbf443f25,0,0xbf6a3ed1,0
.long 0xbe9b3f74,0,0xbf3a3f30,0,0x3e803f78,0,0xbeeb3f63,0
.long 0x3e0f3f7d,0,0xbdacbf7f,0,0x3f253f44,0,0xbed1bf6a,0
.long 0x3f743e9b,0,0xbf30bf3a,0,0x3f78be80,0,0xbf63beeb,0
.long 0x3f6abed1,0,0x3f78be80,0,0x3f0ebf55,0,0x3f55bf0e,0
.long 0x3ce6bf80,0,0x3f1abf4d,0,0xbf02bf5c,0,0x3e9bbf74,0
.long 0xbed1bf6a,0,0x3e803f78,0,0xbf55bf0e,0,0x3f0e3f55,0
.long 0xbf80bce6,0,0x3f4d3f1a,0,0xbf5c3f02,0,0x3f743e9b,0
.long 0xbf7d3e0f,0x3f5c3f02,0xbf30bf3a,0x3dac3f7f,0xbf7bbe48,0xbe483f7b,0xbe48bf7b,0xbf7b3e48
.long 0xbf5cbf02,0xbf7d3e0f,0x3eb7bf6f,0xbe9bbf74,0,0,0,0
.long 0x3e0f3f7d,0x3f02bf5c,0x3f3abf30,0xbf7f3dac,0xbe483f7b,0x3f7b3e48,0x3f7bbe48,0xbe48bf7b
.long 0xbf023f5c,0x3e0f3f7d,0x3f6f3eb7,0x3f74be9b,0,0,0,0
.long 0xbf80bce6,0x3ed13f6a,0xbeebbf63,0xbf1a3f4d,0xbf6fbeb7,0xbf3a3f30,0x3dacbf7f,0xbf5cbf02
.long 0xbf44bf25,0xbf63beeb,0x3f1abf4d,0x3ed1bf6a,0,0,0,0
.long 0xbce63f80,0x3f6abed1,0x3f63beeb,0xbf4dbf1a,0xbeb73f6f,0x3f303f3a,0x3f7f3dac,0x3f02bf5c
.long 0xbf253f44,0xbeeb3f63,0x3f4d3f1a,0x3f6a3ed1,0,0,0,0
.long 0xbeb7bf6f,0xbe9b3f74,0x3f0ebf55,0xbf743e9b,0x3f7b3e48,0x3e48bf7b,0x3e483f7b,0x3f7bbe48
.long 0xbf303f3a,0xbdac3f7f,0xbf55bf0e,0xbf7f3dac,0,0,0,0
.long 0xbf6f3eb7,0x3f743e9b,0x3f553f0e,0xbe9bbf74,0x3e48bf7b,0xbf7bbe48,0xbf7b3e48,0x3e483f7b
.long 0x3f3a3f30,0x3f7f3dac,0x3f0ebf55,0xbdacbf7f,0,0,0,0
.long 0x3f25bf44,0xbf78be80,0x3f7b3e48,0xbe80bf78,0x3e9b3f74,0x3f7d3e0f,0xbf553f0e,0x3e0f3f7d
.long 0xbf78be80,0xbf80bce6,0x3e48bf7b,0xbce6bf80,0,0,0,0
.long 0xbf44bf25,0xbe803f78,0xbe483f7b,0x3f78be80,0x3f74be9b,0x3e0fbf7d,0xbf0ebf55,0xbf7d3e0f
.long 0xbe803f78,0xbce63f80,0x3f7b3e48,0x3f80bce6,0,0,0,0
.long 0x3f55bf0e,0xbf7fbdac,0x3f6f3eb7,0xbf02bf5c,0xbf7bbe48,0xbe483f7b,0xbe48bf7b,0xbf7b3e48
.long 0x3f0e3f55,0x3f743e9b,0xbf3a3f30,0xbe0f3f7d,0,0,0,0
.long 0xbf0ebf55,0xbdac3f7f,0xbeb73f6f,0x3f5cbf02,0xbe483f7b,0x3f7b3e48,0x3f7bbe48,0xbe48bf7b
.long 0x3f55bf0e,0x3e9bbf74,0xbf30bf3a,0xbf7dbe0f,0,0,0,0
.long 0x3e483f7b,0x3f4dbf1a,0xbf443f25,0x3f6a3ed1,0x3f0ebf55,0xbf02bf5c,0x3f743e9b,0x3f30bf3a
.long 0xbf7b3e48,0xbf6a3ed1,0xbe80bf78,0xbeebbf63,0,0,0,0
.long 0x3f7bbe48,0xbf1abf4d,0xbf25bf44,0xbed13f6a,0xbf55bf0e,0xbf5c3f02,0xbe9b3f74,0x3f3a3f30
.long 0x3e483f7b,0x3ed13f6a,0x3f78be80,0x3f63beeb,0,0,0,0
.long 0x3f3a3f30,0,0xbe0f3f7d,0,0x3f7b3e48,0,0x3e483f7b,0
.long 0x3f6fbeb7,0,0x3f023f5c,0,0,0,0,0
.long 0x3f30bf3a,0,0xbf7dbe0f,0,0x3e48bf7b,0,0xbf7b3e48,0
.long 0xbeb7bf6f,0,0xbf5c3f02,0,0,0,0,0
.long 0xbf63beeb,0,0xbce6bf80,0,0xbf7f3dac,0,0xbeb7bf6f,0
.long 0xbf4d3f1a,0,0xbf25bf44,0,0,0,0,0
.long 0xbeeb3f63,0,0x3f80bce6,0,0x3dac3f7f,0,0x3f6fbeb7,0
.long 0x3f1a3f4d,0,0x3f44bf25,0,0,0,0,0
.long 0xbdba3f7f,0xbe9f3f73,0xbe083f7e,0xbeb33f70,0xbee13f66,0xbf80bbe6,0xbf1e3f49,0xbf7abe5d
.long 0xbf3b3f2f,0xbe98bf74,0xbf6f3eba,0x3d9ebf7f,0xbf6d3ec1,0x3f52bf13,0xbf7dbe24,0x3f7fbd81
.long 0x3f7f3dba,0x3f733e9f,0xbf7ebe08,0xbf70beb3,0x3f663ee1,0xbbe63f80,0xbf49bf1e,0x3e5dbf7a
.long 0x3f2f3f3b,0xbf743e98,0xbebabf6f,0x3f7f3d9e,0x3ec13f6d,0xbf13bf52,0x3e24bf7d,0x3d813f7f
.long 0xbe8a3f76,0xbf503f16,0xbec73f6c,0xbf613ef5,0xbf183f4e,0xbf4ebf18,0xbf4e3f18,0xbf18bf4e
.long 0xbf583f0a,0x3ea6bf72,0xbf7f3dd7,0x3f36bf34,0xbf7b3e4f,0x3f803cac,0xbf69bed4,0x3f4b3f1b
.long 0x3f763e8a,0x3f163f50,0xbf6cbec7,0xbef5bf61,0x3f4e3f18,0xbf183f4e,0xbf18bf4e,0x3f4ebf18
.long 0x3f0a3f58,0xbf72bea6,0xbdd7bf7f,0x3f343f36,0x3e4f3f7b,0x3cacbf80,0x3ed4bf69,0xbf1b3f4b
.long 0xbf043f5c,0xbf313f39,0xbf0d3f56,0xbf393f31,0xbedbbf67,0x3f21bf47,0xbe6bbf79,0x3f47bf21
.long 0x3f7d3e16,0xbf103f54,0x3f5d3f01,0xbf543f10,0xbf2c3f3e,0x3efbbf5f,0xbf753e91,0x3f5fbefb
.long 0x3f5c3f04,0x3f393f31,0xbf56bf0d,0xbf31bf39,0xbf673edb,0xbf47bf21,0x3f79be6b,0x3f213f47
.long 0x3e16bf7d,0x3f543f10,0xbf013f5d,0xbf10bf54,0x3f3e3f2c,0xbf5fbefb,0xbe91bf75,0x3efb3f5f
.long 0xbf80bd49,0xbf40bf29,0xbf7cbe33,0xbf29bf40,0x3f18bf4e,0x3f4e3f18,0x3f4ebf18,0x3f183f4e
.long 0x3eac3f71,0xbf5abf07,0xbdf43f7e,0xbf07bf5a,0xbf78be79,0x3f643ee8,0xbf24bf45,0x3ee83f64
.long 0xbd493f80,0xbf293f40,0x3e33bf7c,0x3f40bf29,0xbf4ebf18,0x3f18bf4e,0x3f183f4e,0xbf4e3f18
.long 0x3f71beac,0xbf073f5a,0xbf7ebdf4,0x3f5abf07,0xbe793f78,0x3ee8bf64,0x3f45bf24,0xbf643ee8
.long 0xbf563f0d,0xbf703eb3,0xbf5c3f04,0xbf733e9f,0x3f793e6b,0x3e5d3f7a,0x3f673edb,0x3be63f80
.long 0xbf01bf5d,0x3f7fbd9e,0xbe16bf7d,0x3f743e98,0xbe913f75,0x3d81bf7f,0xbf3e3f2c,0x3f13bf52
.long 0x3f0d3f56,0x3eb33f70,0xbf04bf5c,0xbe9fbf73,0x3e6bbf79,0x3f7abe5d,0xbedb3f67,0xbf803be6
.long 0xbf5d3f01,0xbd9ebf7f,0x3f7dbe16,0xbe983f74,0x3f753e91,0xbf7fbd81,0xbf2cbf3e,0x3f523f13
.long 0xbe33bf7c,0x3ef5bf61,0xbd49bf80,0x3f16bf50,0xbf183f4e,0xbf4ebf18,0xbf4e3f18,0xbf18bf4e
.long 0x3f7ebdf4,0xbf343f36,0x3f713eac,0xbf723ea6,0xbf45bf24,0x3f1b3f4b,0xbe79bf78,0x3cac3f80
.long 0xbf7c3e33,0xbf61bef5,0x3f80bd49,0x3f503f16,0x3f4e3f18,0xbf183f4e,0xbf18bf4e,0x3f4ebf18
.long 0xbdf4bf7e,0x3f363f34,0xbeac3f71,0xbea6bf72,0xbf243f45,0x3f4bbf1b,0x3f78be79,0xbf803cac
.long 0xbf7e3e08,0,0xbf7f3dba,0,0xbf493f1e,0,0xbf663ee1,0
.long 0xbeba3f6f,0,0xbf2f3f3b,0,0x3e243f7d,0,0xbec13f6d,0
.long 0x3e083f7e,0,0xbdbabf7f,0,0x3f1e3f49,0,0xbee1bf66,0
.long 0x3f6f3eba,0,0xbf3bbf2f,0,0x3f7dbe24,0,0xbf6dbec1,0
.long 0x3f6cbec7,0,0x3f76be8a,0,0x3f18bf4e,0,0x3f4ebf18,0
.long 0x3dd7bf7f,0,0x3f0abf58,0,0xbed4bf69,0,0x3e4fbf7b,0
.long 0xbec7bf6c,0,0x3e8a3f76,0,0xbf4ebf18,0,0x3f183f4e,0
.long 0xbf7fbdd7,0,0x3f583f0a,0,0xbf693ed4,0,0x3f7b3e4f,0
.long 0xbf803cac,0x3f4b3f1b,0xbf45bf24,0x3e4f3f7b,0xbf71beac,0xbeac3f71,0xbeacbf71,0xbf713eac
.long 0xbf42bf27,0xbf80bd10,0x3e41bf7b,0xbeeebf63,0,0,0,0
.long 0x3cac3f80,0x3f1bbf4b,0x3f24bf45,0xbf7b3e4f,0xbeac3f71,0x3f713eac,0x3f71beac,0xbeacbf71
.long 0xbf273f42,0xbd103f80,0x3f7b3e41,0x3f63beee,0,0,0,0
.long 0xbf7dbe24,0x3e913f75,0xbf13bf52,0xbefb3f5f,0xbf5dbf01,0xbf543f10,0xbd9ebf7f,0xbf6fbeba
.long 0xbf21bf47,0xbf49bf1e,0x3ee1bf66,0x3e6bbf79,0,0,0,0
.long 0xbe243f7d,0x3f75be91,0x3f52bf13,0xbf5fbefb,0xbf013f5d,0x3f103f54,0x3f7fbd9e,0x3ebabf6f
.long 0xbf473f21,0xbf1e3f49,0x3f663ee1,0x3f793e6b,0,0,0,0
.long 0xbe79bf78,0xbed43f69,0x3ee8bf64,0xbf693ed4,0x3f713eac,0x3eacbf71,0x3eac3f71,0x3f71beac
.long 0xbf4e3f18,0xbe833f77,0xbf6abece,0xbf773e83,0,0,0,0
.long 0xbf783e79,0x3f693ed4,0x3f643ee8,0xbed4bf69,0x3eacbf71,0xbf71beac,0xbf713eac,0x3eac3f71
.long 0x3f183f4e,0x3f773e83,0x3ecebf6a,0xbe83bf77,0,0,0,0
.long 0x3f3ebf2c,0xbf6dbec1,0x3f7f3d81,0xbec1bf6d,0x3e163f7d,0x3f743e98,0xbf3b3f2f,0x3e983f74
.long 0xbf67bedb,0xbf7abe5d,0x3be6bf80,0xbe5dbf7a,0,0,0,0
.long 0xbf2cbf3e,0xbec13f6d,0xbd813f7f,0x3f6dbec1,0x3f7dbe16,0x3e98bf74,0xbf2fbf3b,0xbf743e98
.long 0xbedb3f67,0xbe5d3f7a,0x3f803be6,0x3f7abe5d,0,0,0,0
.long 0x3f64bee8,0xbf7bbe4f,0x3f783e79,0xbf1bbf4b,0xbf71beac,0xbeac3f71,0xbeacbf71,0xbf713eac
.long 0x3ece3f6a,0x3f633eee,0xbf183f4e,0x3d103f80,0,0,0,0
.long 0xbee8bf64,0xbe4f3f7b,0xbe793f78,0x3f4bbf1b,0xbeac3f71,0x3f713eac,0x3f71beac,0xbeacbf71
.long 0x3f6abece,0x3eeebf63,0xbf4ebf18,0xbf803d10,0,0,0,0
.long 0x3d813f7f,0x3f5fbefb,0xbf2c3f3e,0x3f753e91,0x3f2fbf3b,0xbebabf6f,0x3f7d3e16,0x3f10bf54
.long 0xbf803be6,0xbf793e6b,0xbedbbf67,0xbf1ebf49,0,0,0,0
.long 0x3f7fbd81,0xbefbbf5f,0xbf3ebf2c,0xbe913f75,0xbf3bbf2f,0xbf6f3eba,0xbe163f7d,0x3f543f10
.long 0x3be63f80,0x3e6b3f79,0x3f67bedb,0x3f49bf1e,0,0,0,0
.long 0x3f243f45,0,0xbcac3f80,0,0x3f713eac,0,0x3eac3f71,0
.long 0x3f7bbe41,0,0x3f273f42,0,0,0,0,0
.long 0x3f45bf24,0,0xbf80bcac,0,0x3eacbf71,0,0xbf713eac,0
.long 0xbe41bf7b,0,0xbf423f27,0,0,0,0,0
.long 0xbf52bf13,0,0xbe24bf7d,0,0xbf7fbd9e,0,0xbf01bf5d,0
.long 0xbf663ee1,0,0xbf47bf21,0,0,0,0,0
.long 0xbf133f52,0,0x3f7dbe24,0,0xbd9e3f7f,0,0x3f5dbf01,0
.long 0x3ee13f66,0,0x3f21bf47,0,0,0,0,0
.long 0xbdc93f7f,0xbea23f73,0xbe013f7e,0xbeb03f70,0xbef13f62,0xbf80bd2c,0xbf173f4f,0xbf7cbe3a
.long 0xbf463f22,0xbe72bf79,0xbf683ed8,0x3c66bf80,0xbf753e95,0x3f5ebefe,0xbf7fbd8f,0x3f7dbe1d
.long 0x3f7f3dc9,0x3f733ea2,0xbf7ebe01,0xbf70beb0,0x3f623ef1,0xbd2c3f80,0xbf4fbf17,0x3e3abf7c
.long 0x3f223f46,0xbf793e72,0xbed8bf68,0x3f803c66,0x3e953f75,0xbefebf5e,0x3d8fbf7f,0x3e1d3f7d
.long 0xbe953f75,0xbf533f11,0xbebd3f6e,0xbf5e3efe,0xbf223f46,0xbf46bf22,0xbf463f22,0xbf22bf46
.long 0xbf623ef1,0x3ecbbf6b,0xbf7c3e3a,0x3f28bf41,0xbf7f3dc9,0x3f7e3e01,0xbf73bea2,0x3f5b3f05
.long 0x3f753e95,0x3f113f53,0xbf6ebebd,0xbefebf5e,0x3f463f22,0xbf223f46,0xbf22bf46,0x3f46bf22
.long 0x3ef13f62,0xbf6bbecb,0xbe3abf7c,0x3f413f28,0x3dc93f7f,0x3e01bf7e,0x3ea2bf73,0xbf053f5b
.long 0xbf053f5b,0xbf323f38,0xbf0b3f57,0xbf383f32,0xbecbbf6b,0x3f28bf41,0xbe87bf77,0x3f41bf28
.long 0x3f7a3e56,0xbf1d3f4a,0x3f653ee5,0xbf4a3f1d,0xbf3c3f2d,0x3f11bf53,0xbf6e3ebd,0x3f53bf11
.long 0x3f5b3f05,0x3f383f32,0xbf57bf0b,0xbf32bf38,0xbf6b3ecb,0xbf41bf28,0x3f77be87,0x3f283f41
.long 0x3e56bf7a,0x3f4a3f1d,0xbee53f65,0xbf1dbf4a,0x3f2d3f3c,0xbf53bf11,0xbebdbf6e,0x3f113f53
.long 0xbf7fbd8f,0xbf3cbf2d,0xbf7dbe1d,0xbf2dbf3c,0x3f22bf46,0x3f463f22,0x3f46bf22,0x3f223f46
.long 0x3e873f77,0xbf4fbf17,0xbd2c3f80,0xbf17bf4f,0xbf70beb0,0x3f573f0b,0xbf38bf32,0x3f0b3f57
.long 0xbd8f3f7f,0xbf2d3f3c,0x3e1dbf7d,0x3f3cbf2d,0xbf46bf22,0x3f22bf46,0x3f223f46,0xbf463f22
.long 0x3f77be87,0xbf173f4f,0xbf80bd2c,0x3f4fbf17,0xbeb03f70,0x3f0bbf57,0x3f32bf38,0xbf573f0b
.long 0xbf573f0b,0xbf703eb0,0xbf5b3f05,0xbf733ea2,0x3f773e87,0x3e3a3f7c,0x3f6b3ecb,0x3d2c3f80
.long 0xbee5bf65,0x3f80bc66,0xbe56bf7a,0x3f793e72,0xbebd3f6e,0x3e1dbf7d,0xbf2d3f3c,0x3efebf5e
.long 0x3f0b3f57,0x3eb03f70,0xbf05bf5b,0xbea2bf73,0x3e87bf77,0x3f7cbe3a,0xbecb3f6b,0xbf803d2c
.long 0xbf653ee5,0xbc66bf80,0x3f7abe56,0xbe723f79,0x3f6e3ebd,0xbf7dbe1d,0xbf3cbf2d,0x3f5e3efe
.long 0xbe1dbf7d,0x3efebf5e,0xbd8fbf7f,0x3f11bf53,0xbf223f46,0xbf46bf22,0xbf463f22,0xbf22bf46
.long 0x3f80bd2c,0xbf413f28,0x3f773e87,0xbf6b3ecb,0xbf32bf38,0x3f053f5b,0xbeb0bf70,0x3e013f7e
.long 0xbf7d3e1d,0xbf5ebefe,0x3f7fbd8f,0x3f533f11,0x3f463f22,0xbf223f46,0xbf22bf46,0x3f46bf22
.long 0xbd2cbf80,0x3f283f41,0xbe873f77,0xbecbbf6b,0xbf383f32,0x3f5bbf05,0x3f70beb0,0xbf7e3e01
.long 0xbf7e3e01,0,0xbf7f3dc9,0,0xbf4f3f17,0,0xbf623ef1,0
.long 0xbed83f68,0,0xbf223f46,0,0x3d8f3f7f,0,0xbe953f75,0
.long 0x3e013f7e,0,0xbdc9bf7f,0,0x3f173f4f,0,0xbef1bf62,0
.long 0x3f683ed8,0,0xbf46bf22,0,0x3f7fbd8f,0,0xbf75be95,0
.long 0x3f6ebebd,0,0x3f75be95,0,0x3f22bf46,0,0x3f46bf22,0
.long 0x3e3abf7c,0,0x3ef1bf62,0,0xbea2bf73,0,0x3dc9bf7f,0
.long 0xbebdbf6e,0,0x3e953f75,0,0xbf46bf22,0,0x3f223f46,0
.long 0xbf7cbe3a,0,0x3f623ef1,0,0xbf733ea2,0,0x3f7f3dc9,0
.long 0xbf7fbdc9,0x3f383f32,0xbf57bf0b,0x3ea23f73,0xbf62bef1,0xbef13f62,0xbef1bf62,0xbf623ef1
.long 0xbf22bf46,0xbf7abe56,0x3c66bf80,0xbf1dbf4a,0,0,0,0
.long 0xbdc93f7f,0x3f32bf38,0x3f0bbf57,0xbf733ea2,0xbef13f62,0x3f623ef1,0x3f62bef1,0xbef1bf62
.long 0xbf463f22,0xbe563f7a,0x3f803c66,0x3f4abf1d,0,0,0,0
.long 0xbf75be95,0x3e1d3f7d,0xbf2dbf3c,0xbebd3f6e,0xbf46bf22,0xbf683ed8,0xbe72bf79,0xbf7abe56
.long 0xbef1bf62,0xbf28bf41,0x3e87bf77,0x3d2cbf80,0,0,0,0
.long 0xbe953f75,0x3f7dbe1d,0x3f3cbf2d,0xbf6ebebd,0xbf223f46,0x3ed83f68,0x3f79be72,0x3e56bf7a
.long 0xbf623ef1,0xbf413f28,0x3f773e87,0x3f803d2c,0,0,0,0
.long 0xbe01bf7e,0xbf053f5b,0x3eb0bf70,0xbf5b3f05,0x3f623ef1,0x3ef1bf62,0x3ef13f62,0x3f62bef1
.long 0xbf653ee5,0xbed83f68,0xbf79be72,0xbf683ed8,0,0,0,0
.long 0xbf7e3e01,0x3f5b3f05,0x3f703eb0,0xbf05bf5b,0x3ef1bf62,0xbf62bef1,0xbf623ef1,0x3ef13f62
.long 0x3ee53f65,0x3f683ed8,0x3e72bf79,0xbed8bf68,0,0,0,0
.long 0x3f53bf11,0xbf5ebefe,0x3f7fbd8f,0xbefebf5e,0xbc663f80,0x3f653ee5,0xbf1d3f4a,0x3ee53f65
.long 0xbf4fbf17,0xbf6bbecb,0xbe3abf7c,0xbecbbf6b,0,0,0,0
.long 0xbf11bf53,0xbefe3f5e,0x3d8f3f7f,0x3f5ebefe,0x3f803c66,0x3ee5bf65,0xbf4abf1d,0xbf653ee5
.long 0xbf173f4f,0xbecb3f6b,0x3f7cbe3a,0x3f6bbecb,0,0,0,0
.long 0x3f70beb0,0xbf73bea2,0x3f7e3e01,0xbf32bf38,0xbf62bef1,0xbef13f62,0xbef1bf62,0xbf623ef1
.long 0x3e723f79,0x3f4a3f1d,0xbee53f65,0x3e563f7a,0,0,0,0
.long 0xbeb0bf70,0xbea23f73,0xbe013f7e,0x3f38bf32,0xbef13f62,0x3f623ef1,0x3f62bef1,0xbef1bf62
.long 0x3f79be72,0x3f1dbf4a,0xbf65bee5,0xbf7a3e56,0,0,0,0
.long 0xbd8f3f7f,0x3f6ebebd,0xbf113f53,0x3f7d3e1d,0x3f4abf1d,0xbe56bf7a,0x3f80bc66,0x3ed8bf68
.long 0xbf7cbe3a,0xbf803d2c,0xbf17bf4f,0xbf41bf28,0,0,0,0
.long 0x3f7f3d8f,0xbebdbf6e,0xbf53bf11,0xbe1d3f7d,0xbf1dbf4a,0xbf7a3e56,0x3c663f80,0x3f683ed8
.long 0xbe3a3f7c,0x3d2c3f80,0x3f4fbf17,0x3f28bf41,0,0,0,0
.long 0x3f0b3f57,0,0x3dc93f7f,0,0x3f623ef1,0,0x3ef13f62,0
.long 0x3f80bc66,0,0x3f463f22,0,0,0,0,0
.long 0x3f57bf0b,0,0xbf7f3dc9,0,0x3ef1bf62,0,0xbf623ef1,0
.long 0xbc66bf80,0,0xbf223f46,0,0,0,0,0
.long 0xbf3cbf2d,0,0xbe95bf75,0,0xbf79be72,0,0xbf22bf46,0
.long 0xbf773e87,0,0xbf62bef1,0,0,0,0,0
.long 0xbf2d3f3c,0,0x3f75be95,0,0xbe723f79,0,0x3f46bf22,0
.long 0x3e873f77,0,0x3ef1bf62,0,0,0,0,0
.long 0xbdd73f7f,0xbea63f72,0xbdf43f7e,0xbeac3f71,0xbf013f5d,0xbf7fbd9e,0xbf103f54,0xbf7dbe16
.long 0xbf503f16,0xbe33bf7c,0xbf613ef5,0xbd49bf80,0xbf7b3e4f,0x3f69bed4,0xbf803cac,0x3f78be79
.long 0x3f7f3dd7,0x3f723ea6,0xbf7ebdf4,0xbf71beac,0x3f5d3f01,0xbd9e3f7f,0xbf54bf10,0x3e16bf7d
.long 0x3f163f50,0xbf7c3e33,0xbef5bf61,0x3f80bd49,0x3e4f3f7b,0xbed4bf69,0xbcacbf80,0x3e793f78
.long 0xbe9f3f73,0xbf563f0d,0xbeb33f70,0xbf5c3f04,0xbf2c3f3e,0xbf3ebf2c,0xbf3e3f2c,0xbf2cbf3e
.long 0xbf6a3ece,0x3eeebf63,0xbf773e83,0x3f18bf4e,0xbf80bbe6,0x3f793e6b,0xbf7abe5d,0x3f673edb
.long 0x3f733e9f,0x3f0d3f56,0xbf70beb3,0xbf04bf5c,0x3f3e3f2c,0xbf2c3f3e,0xbf2cbf3e,0x3f3ebf2c
.long 0x3ece3f6a,0xbf63beee,0xbe83bf77,0x3f4e3f18,0xbbe63f80,0x3e6bbf79,0x3e5dbf7a,0xbedb3f67
.long 0xbf073f5a,0xbf343f36,0xbf0a3f58,0xbf363f34,0xbebabf6f,0x3f2fbf3b,0xbe98bf74,0x3f3bbf2f
.long 0x3f763e8a,0xbf293f40,0x3f6c3ec7,0xbf403f29,0xbf4b3f1b,0x3f24bf45,0xbf643ee8,0x3f45bf24
.long 0x3f5a3f07,0x3f363f34,0xbf58bf0a,0xbf34bf36,0xbf6f3eba,0xbf3bbf2f,0x3f74be98,0x3f2f3f3b
.long 0x3e8abf76,0x3f403f29,0xbec73f6c,0xbf29bf40,0x3f1b3f4b,0xbf45bf24,0xbee8bf64,0x3f243f45
.long 0xbf7fbdba,0xbf39bf31,0xbf7ebe08,0xbf31bf39,0x3f2cbf3e,0x3f3e3f2c,0x3f3ebf2c,0x3f2c3f3e
.long 0x3e413f7b,0xbf42bf27,0x3d103f80,0xbf27bf42,0xbf66bee1,0x3f473f21,0xbf49bf1e,0x3f213f47
.long 0xbdba3f7f,0xbf313f39,0x3e08bf7e,0x3f39bf31,0xbf3ebf2c,0x3f2cbf3e,0x3f2c3f3e,0xbf3e3f2c
.long 0x3f7bbe41,0xbf273f42,0xbf803d10,0x3f42bf27,0xbee13f66,0x3f21bf47,0x3f1ebf49,0xbf473f21
.long 0xbf583f0a,0xbf713eac,0xbf5a3f07,0xbf723ea6,0x3f743e98,0x3e163f7d,0x3f6f3eba,0x3d9e3f7f
.long 0xbec7bf6c,0x3f803d49,0xbe8abf76,0x3f7c3e33,0xbee83f64,0x3e79bf78,0xbf1b3f4b,0x3ed4bf69
.long 0x3f0a3f58,0x3eac3f71,0xbf07bf5a,0xbea6bf72,0x3e98bf74,0x3f7dbe16,0xbeba3f6f,0xbf7f3d9e
.long 0xbf6c3ec7,0x3d49bf80,0x3f76be8a,0xbe333f7c,0x3f643ee8,0xbf78be79,0xbf4bbf1b,0x3f693ed4
.long 0xbe08bf7e,0x3f04bf5c,0xbdbabf7f,0x3f0dbf56,0xbf2c3f3e,0xbf3ebf2c,0xbf3e3f2c,0xbf2cbf3e
.long 0x3f803d10,0xbf4e3f18,0x3f7b3e41,0xbf633eee,0xbf1ebf49,0x3edb3f67,0xbee1bf66,0x3e6b3f79
.long 0xbf7e3e08,0xbf5cbf04,0x3f7fbdba,0x3f563f0d,0x3f3e3f2c,0xbf2c3f3e,0xbf2cbf3e,0x3f3ebf2c
.long 0x3d10bf80,0x3f183f4e,0xbe413f7b,0xbeeebf63,0xbf493f1e,0x3f67bedb,0x3f66bee1,0xbf793e6b
.long 0xbf7e3df4,0,0xbf7f3dd7,0,0xbf543f10,0,0xbf5d3f01,0
.long 0xbef53f61,0,0xbf163f50,0,0xbcac3f80,0,0xbe4f3f7b,0
.long 0x3df43f7e,0,0xbdd7bf7f,0,0x3f103f54,0,0xbf01bf5d,0
.long 0x3f613ef5,0,0xbf50bf16,0,0x3f803cac,0,0xbf7bbe4f,0
.long 0x3f70beb3,0,0x3f73be9f,0,0x3f2cbf3e,0,0x3f3ebf2c,0
.long 0x3e83bf77,0,0x3ecebf6a,0,0xbe5dbf7a,0,0xbbe6bf80,0
.long 0xbeb3bf70,0,0x3e9f3f73,0,0xbf3ebf2c,0,0x3f2c3f3e,0
.long 0xbf77be83,0,0x3f6a3ece,0,0xbf7a3e5d,0,0x3f80bbe6,0
.long 0xbf7abe5d,0x3f213f47,0xbf66bee1,0x3edb3f67,0xbf4ebf18,0xbf183f4e,0xbf18bf4e,0xbf4e3f18
.long 0xbefbbf5f,0xbf6dbec1,0xbe24bf7d,0xbf3ebf2c,0,0,0,0
.long 0xbe5d3f7a,0x3f47bf21,0x3ee1bf66,0xbf673edb,0xbf183f4e,0x3f4e3f18,0x3f4ebf18,0xbf18bf4e
.long 0xbf5f3efb,0xbec13f6d,0x3f7dbe24,0x3f2cbf3e,0,0,0,0
.long 0xbf69bed4,0x3cac3f80,0xbf45bf24,0xbe793f78,0xbf29bf40,0xbf763e8a,0xbec7bf6c,0xbf80bd49
.long 0xbe98bf74,0xbf01bf5d,0x3d9ebf7f,0xbe16bf7d,0,0,0,0
.long 0xbed43f69,0x3f80bcac,0x3f24bf45,0xbf78be79,0xbf403f29,0x3e8a3f76,0x3f6cbec7,0x3d49bf80
.long 0xbf743e98,0xbf5d3f01,0x3f7f3d9e,0x3f7dbe16,0,0,0,0
.long 0xbbe6bf80,0xbf1e3f49,0x3e6bbf79,0xbf493f1e,0x3f4e3f18,0x3f18bf4e,0x3f183f4e,0x3f4ebf18
.long 0xbf753e91,0xbf133f52,0xbf7fbd81,0xbf523f13,0,0,0,0
.long 0xbf803be6,0x3f493f1e,0x3f793e6b,0xbf1ebf49,0x3f18bf4e,0xbf4ebf18,0xbf4e3f18,0x3f183f4e
.long 0x3e913f75,0x3f523f13,0x3d81bf7f,0xbf13bf52,0,0,0,0
.long 0x3f64bee8,0xbf4bbf1b,0x3f7bbe4f,0xbf1bbf4b,0xbe333f7c,0x3f503f16,0xbef53f61,0x3f163f50
.long 0xbf2fbf3b,0xbf54bf10,0xbebabf6f,0xbf10bf54,0,0,0,0
.long 0xbee8bf64,0xbf1b3f4b,0x3e4f3f7b,0x3f4bbf1b,0x3f7c3e33,0x3f16bf50,0xbf61bef5,0xbf503f16
.long 0xbf3b3f2f,0xbf103f54,0x3f6fbeba,0x3f54bf10,0,0,0,0
.long 0x3f79be6b,0xbf67bedb,0x3f803be6,0xbf47bf21,0xbf4ebf18,0xbf183f4e,0xbf18bf4e,0xbf4e3f18
.long 0x3d813f7f,0x3f2c3f3e,0xbe913f75,0x3ec13f6d,0,0,0,0
.long 0xbe6bbf79,0xbedb3f67,0xbbe63f80,0x3f21bf47,0xbf183f4e,0x3f4e3f18,0x3f4ebf18,0xbf18bf4e
.long 0x3f7fbd81,0x3f3ebf2c,0xbf75be91,0xbf6d3ec1,0,0,0,0
.long 0xbe4f3f7b,0x3f78be79,0xbee83f64,0x3f803cac,0x3f61bef5,0xbd49bf80,0x3f7cbe33,0x3e8abf76
.long 0xbf6fbeba,0xbf7dbe16,0xbf3bbf2f,0xbf5dbf01,0,0,0,0
.long 0x3f7b3e4f,0xbe79bf78,0xbf64bee8,0xbcac3f80,0xbef5bf61,0xbf803d49,0x3e333f7c,0x3f763e8a
.long 0xbeba3f6f,0xbe163f7d,0x3f2fbf3b,0x3f01bf5d,0,0,0,0
.long 0x3ee13f66,0,0x3e5d3f7a,0,0x3f4e3f18,0,0x3f183f4e,0
.long 0x3f7d3e24,0,0x3f5f3efb,0,0,0,0,0
.long 0x3f66bee1,0,0xbf7a3e5d,0,0x3f18bf4e,0,0xbf4e3f18,0
.long 0x3e24bf7d,0,0xbefb3f5f,0,0,0,0,0
.long 0xbf24bf45,0,0xbed4bf69,0,0xbf6cbec7,0,0xbf40bf29,0
.long 0xbf7f3d9e,0,0xbf74be98,0,0,0,0,0
.long 0xbf453f24,0,0x3f69bed4,0,0xbec73f6c,0,0x3f29bf40,0
.long 0x3d9e3f7f,0,0x3e98bf74,0,0,0,0,0
.long 0x40003f80,0x40004000,0x40004000,0x40004000,0,0,0,0
.long 0x3ffb3f80,0x3fd53fed,0x3f8e3fb5,0x3ec83f44,0,0,0,0
.long 0x3f80,0xc000,0x4000,0xc000,0,0,0,0
.long 0xbec83f80,0x3f8ebfed,0xbfd53fb5,0x3ffbbf44,0,0,0,0
.long 0xc0003f80,0xc0004000,0xc0004000,0xc0004000,0,0,0,0
.long 0xbffb3f80,0xbfd53fed,0xbf8e3fb5,0xbec83f44,0,0,0,0
.long 0x3f80,0xc000,0x4000,0xc000,0,0,0,0
.long 0x3ec83f80,0xbf8ebfed,0x3fd53fb5,0xbffbbf44,0,0,0,0
.long 0x3f80,0,0,0,0,0,0,0
.long 0xbec8bf80,0xbf8ebf44,0xbfd5bfb5,0xbffbbfed,0,0,0,0
.long 0xc0003f80,0x40000000,0xc0000000,0x40000000,0,0,0,0
.long 0xbffbbf80,0x3fd53f44,0xbf8ebfb5,0x3ec83fed,0,0,0,0
.long 0x3f80,0,0,0,0,0,0,0
.long 0x3ec8bf80,0x3f8ebf44,0x3fd5bfb5,0x3ffbbfed,0,0,0,0
.long 0x40003f80,0xc0000000,0x40000000,0xc0000000,0,0,0,0
.long 0x3ffbbf80,0xbfd53f44,0x3f8ebfb5,0xbec83fed,0,0,0,0
.long 0,0,0,0,0x40003f80,0x40004000,0x40004000,0x40004000
.long 0,0,0,0,0x3ffb3f80,0x3fd53fed,0x3f8e3fb5,0x3ec83f44
.long 0,0,0,0,0x3f80,0xc000,0x4000,0xc000
.long 0,0,0,0,0xbec83f80,0x3f8ebfed,0xbfd53fb5,0x3ffbbf44
.long 0,0,0,0,0xc0003f80,0xc0004000,0xc0004000,0xc0004000
.long 0,0,0,0,0xbffb3f80,0xbfd53fed,0xbf8e3fb5,0xbec83f44
.long 0,0,0,0,0x3f80,0xc000,0x4000,0xc000
.long 0,0,0,0,0x3ec83f80,0xbf8ebfed,0x3fd53fb5,0xbffbbf44
.long 0,0,0,0,0x3f80,0,0,0
.long 0,0,0,0,0xbec8bf80,0xbf8ebf44,0xbfd5bfb5,0xbffbbfed
.long 0,0,0,0,0xc0003f80,0x40000000,0xc0000000,0x40000000
.long 0,0,0,0,0xbffbbf80,0x3fd53f44,0xbf8ebfb5,0x3ec83fed
.long 0,0,0,0,0x3f80,0,0,0
.long 0,0,0,0,0x3ec8bf80,0x3f8ebf44,0x3fd5bfb5,0x3ffbbfed
.long 0,0,0,0,0x40003f80,0xc0000000,0x40000000,0xc0000000
.long 0,0,0,0,0x3ffbbf80,0xbfd53f44,0x3f8ebfb5,0xbec83fed
.long 0x40004000,0x40004000,0x40004000,0x40004000,0,0,0,0
.long 0xbec80000,0xbf8ebf44,0xbfd5bfb5,0xbffbbfed,0,0,0,0
.long 0x4000,0xc000,0x4000,0xc000,0,0,0,0
.long 0xbffb0000,0x3fd53f44,0xbf8ebfb5,0x3ec83fed,0,0,0,0
.long 0xc0004000,0xc0004000,0xc0004000,0xc0004000,0,0,0,0
.long 0x3ec80000,0x3f8ebf44,0x3fd5bfb5,0x3ffbbfed,0,0,0,0
.long 0x4000,0xc000,0x4000,0xc000,0,0,0,0
.long 0x3ffb0000,0xbfd53f44,0x3f8ebfb5,0xbec83fed,0,0,0,0
.long 0,0,0,0,0,0,0,0
.long 0xbffbc000,0xbfd5bfed,0xbf8ebfb5,0xbec8bf44,0,0,0,0
.long 0xc0000000,0x40000000,0xc0000000,0x40000000,0,0,0,0
.long 0x3ec8c000,0xbf8e3fed,0x3fd5bfb5,0xbffb3f44,0,0,0,0
.long 0,0,0,0,0,0,0,0
.long 0x3ffbc000,0x3fd5bfed,0x3f8ebfb5,0x3ec8bf44,0,0,0,0
.long 0x40000000,0xc0000000,0x40000000,0xc0000000,0,0,0,0
.long 0xbec8c000,0x3f8e3fed,0xbfd5bfb5,0x3ffb3f44,0,0,0,0
.long 0,0,0,0,0x40004000,0x40004000,0x40004000,0x40004000
.long 0,0,0,0,0xbec80000,0xbf8ebf44,0xbfd5bfb5,0xbffbbfed
.long 0,0,0,0,0x4000,0xc000,0x4000,0xc000
.long 0,0,0,0,0xbffb0000,0x3fd53f44,0xbf8ebfb5,0x3ec83fed
.long 0,0,0,0,0xc0004000,0xc0004000,0xc0004000,0xc0004000
.long 0,0,0,0,0x3ec80000,0x3f8ebf44,0x3fd5bfb5,0x3ffbbfed
.long 0,0,0,0,0x4000,0xc000,0x4000,0xc000
.long 0,0,0,0,0x3ffb0000,0xbfd53f44,0x3f8ebfb5,0xbec83fed
.long 0,0,0,0,0,0,0,0
.long 0,0,0,0,0xbffbc000,0xbfd5bfed,0xbf8ebfb5,0xbec8bf44
.long 0,0,0,0,0xc0000000,0x40000000,0xc0000000,0x40000000
.long 0,0,0,0,0x3ec8c000,0xbf8e3fed,0x3fd5bfb5,0xbffb3f44
.long 0,0,0,0,0,0,0,0
.long 0,0,0,0,0x3ffbc000,0x3fd5bfed,0x3f8ebfb5,0x3ec8bf44
.long 0,0,0,0,0x40000000,0xc0000000,0x40000000,0xc0000000
.long 0,0,0,0,0xbec8c000,0x3f8e3fed,0xbfd5bfb5,0x3ffb3f44
.long 0x3fed3f80,0x3f443fb5,0xbf440000,0xbfedbfb5,0,0,0,0
.long 0x3fd53f80,0xbec83f44,0xbffbbfb5,0xbf8ebfed,0,0,0,0
.long 0xbf443f80,0x3fedbfb5,0xbfed0000,0x3f443fb5,0,0,0,0
.long 0xbf8e3f80,0x3ffbbf44,0xbec8bfb5,0xbfd53fed,0,0,0,0
.long 0xbfed3f80,0xbf443fb5,0x3f440000,0x3fedbfb5,0,0,0,0
.long 0xbfd53f80,0x3ec83f44,0x3ffbbfb5,0x3f8ebfed,0,0,0,0
.long 0x3f443f80,0xbfedbfb5,0x3fed0000,0xbf443fb5,0,0,0,0
.long 0x3f8e3f80,0xbffbbf44,0x3ec8bfb5,0x3fd53fed,0,0,0,0
.long 0xbf443f80,0xbfedbfb5,0xbfedc000,0xbf44bfb5,0,0,0,0
.long 0xbf8ebf80,0xbffbbfed,0xbec8bfb5,0x3fd53f44,0,0,0,0
.long 0xbfed3f80,0x3f443fb5,0x3f44c000,0xbfed3fb5,0,0,0,0
.long 0xbfd5bf80,0xbec83fed,0x3ffbbfb5,0xbf8ebf44,0,0,0,0
.long 0x3f443f80,0x3fedbfb5,0x3fedc000,0x3f44bfb5,0,0,0,0
.long 0x3f8ebf80,0x3ffbbfed,0x3ec8bfb5,0xbfd53f44,0,0,0,0
.long 0x3fed3f80,0xbf443fb5,0xbf44c000,0x3fed3fb5,0,0,0,0
.long 0x3fd5bf80,0x3ec83fed,0xbffbbfb5,0x3f8ebf44,0,0,0,0
.long 0,0,0,0,0x3fed3f80,0x3f443fb5,0xbf440000,0xbfedbfb5
.long 0,0,0,0,0x3fd53f80,0xbec83f44,0xbffbbfb5,0xbf8ebfed
.long 0,0,0,0,0xbf443f80,0x3fedbfb5,0xbfed0000,0x3f443fb5
.long 0,0,0,0,0xbf8e3f80,0x3ffbbf44,0xbec8bfb5,0xbfd53fed
.long 0,0,0,0,0xbfed3f80,0xbf443fb5,0x3f440000,0x3fedbfb5
.long 0,0,0,0,0xbfd53f80,0x3ec83f44,0x3ffbbfb5,0x3f8ebfed
.long 0,0,0,0,0x3f443f80,0xbfedbfb5,0x3fed0000,0xbf443fb5
.long 0,0,0,0,0x3f8e3f80,0xbffbbf44,0x3ec8bfb5,0x3fd53fed
.long 0,0,0,0,0xbf443f80,0xbfedbfb5,0xbfedc000,0xbf44bfb5
.long 0,0,0,0,0xbf8ebf80,0xbffbbfed,0xbec8bfb5,0x3fd53f44
.long 0,0,0,0,0xbfed3f80,0x3f443fb5,0x3f44c000,0xbfed3fb5
.long 0,0,0,0,0xbfd5bf80,0xbec83fed,0x3ffbbfb5,0xbf8ebf44
.long 0,0,0,0,0x3f443f80,0x3fedbfb5,0x3fedc000,0x3f44bfb5
.long 0,0,0,0,0x3f8ebf80,0x3ffbbfed,0x3ec8bfb5,0xbfd53f44
.long 0,0,0,0,0x3fed3f80,0xbf443fb5,0xbf44c000,0x3fed3fb5
.long 0,0,0,0,0x3fd5bf80,0x3ec83fed,0xbffbbfb5,0x3f8ebf44
.long 0xbfedc000,0xbf44bfb5,0x3f440000,0x3fed3fb5,0,0,0,0
.long 0x3f8e0000,0x3ffb3fed,0x3ec83fb5,0xbfd5bf44,0,0,0,0
.long 0x3f44c000,0xbfed3fb5,0x3fed0000,0xbf44bfb5,0,0,0,0
.long 0x3fd50000,0x3ec8bfed,0xbffb3fb5,0x3f8e3f44,0,0,0,0
.long 0x3fedc000,0x3f44bfb5,0xbf440000,0xbfed3fb5,0,0,0,0
.long 0xbf8e0000,0xbffb3fed,0xbec83fb5,0x3fd5bf44,0,0,0,0
.long 0xbf44c000,0x3fed3fb5,0xbfed0000,0x3f44bfb5,0,0,0,0
.long 0xbfd50000,0xbec8bfed,0x3ffb3fb5,0xbf8e3f44,0,0,0,0
.long 0x3f440000,0x3fed3fb5,0x3fed4000,0x3f443fb5,0,0,0,0
.long 0x3fd54000,0xbec83f44,0xbffbbfb5,0xbf8ebfed,0,0,0,0
.long 0x3fed0000,0xbf44bfb5,0xbf444000,0x3fedbfb5,0,0,0,0
.long 0xbf8e4000,0x3ffbbf44,0xbec8bfb5,0xbfd53fed,0,0,0,0
.long 0xbf440000,0xbfed3fb5,0xbfed4000,0xbf443fb5,0,0,0,0
.long 0xbfd54000,0x3ec83f44,0x3ffbbfb5,0x3f8ebfed,0,0,0,0
.long 0xbfed0000,0x3f44bfb5,0x3f444000,0xbfedbfb5,0,0,0,0
.long 0x3f8e4000,0xbffbbf44,0x3ec8bfb5,0x3fd53fed,0,0,0,0
.long 0,0,0,0,0xbfedc000,0xbf44bfb5,0x3f440000,0x3fed3fb5
.long 0,0,0,0,0x3f8e0000,0x3ffb3fed,0x3ec83fb5,0xbfd5bf44
.long 0,0,0,0,0x3f44c000,0xbfed3fb5,0x3fed0000,0xbf44bfb5
.long 0,0,0,0,0x3fd50000,0x3ec8bfed,0xbffb3fb5,0x3f8e3f44
.long 0,0,0,0,0x3fedc000,0x3f44bfb5,0xbf440000,0xbfed3fb5
.long 0,0,0,0,0xbf8e0000,0xbffb3fed,0xbec83fb5,0x3fd5bf44
.long 0,0,0,0,0xbf44c000,0x3fed3fb5,0xbfed0000,0x3f44bfb5
.long 0,0,0,0,0xbfd50000,0xbec8bfed,0x3ffb3fb5,0xbf8e3f44
.long 0,0,0,0,0x3f440000,0x3fed3fb5,0x3fed4000,0x3f443fb5
.long 0,0,0,0,0x3fd54000,0xbec83f44,0xbffbbfb5,0xbf8ebfed
.long 0,0,0,0,0x3fed0000,0xbf44bfb5,0xbf444000,0x3fedbfb5
.long 0,0,0,0,0xbf8e4000,0x3ffbbf44,0xbec8bfb5,0xbfd53fed
.long 0,0,0,0,0xbf440000,0xbfed3fb5,0xbfed4000,0xbf443fb5
.long 0,0,0,0,0xbfd54000,0x3ec83f44,0x3ffbbfb5,0x3f8ebfed
.long 0,0,0,0,0xbfed0000,0x3f44bfb5,0x3f444000,0xbfedbfb5
.long 0,0,0,0,0x3f8e4000,0xbffbbf44,0x3ec8bfb5,0x3fd53fed
.long 0x3fb53f80,0xbfb50000,0xbfb5c000,0x3fb50000,0,0,0,0
.long 0x3f8e3f80,0xbffbbf44,0x3ec8bfb5,0x3fd53fed,0,0,0,0
.long 0xbfb53f80,0x3fb50000,0x3fb5c000,0xbfb50000,0,0,0,0
.long 0xbfd53f80,0x3ec83f44,0x3ffbbfb5,0x3f8ebfed,0,0,0,0
.long 0xbfb53f80,0x3fb50000,0x3fb5c000,0xbfb50000,0,0,0,0
.long 0xbf8e3f80,0x3ffbbf44,0xbec8bfb5,0xbfd53fed,0,0,0,0
.long 0x3fb53f80,0xbfb50000,0xbfb5c000,0x3fb50000,0,0,0,0
.long 0x3fd53f80,0xbec83f44,0xbffbbfb5,0xbf8ebfed,0,0,0,0
.long 0xbfb53f80,0xbfb5c000,0x3fb50000,0x3fb54000,0,0,0,0
.long 0xbfd5bf80,0xbec8bfed,0x3ffb3fb5,0xbf8e3f44,0,0,0,0
.long 0xbfb53f80,0xbfb54000,0x3fb50000,0x3fb5c000,0,0,0,0
.long 0xbf8ebf80,0xbffb3fed,0xbec83fb5,0x3fd5bf44,0,0,0,0
.long 0x3fb53f80,0x3fb5c000,0xbfb50000,0xbfb54000,0,0,0,0
.long 0x3fd5bf80,0x3ec8bfed,0xbffb3fb5,0x3f8e3f44,0,0,0,0
.long 0x3fb53f80,0x3fb54000,0xbfb50000,0xbfb5c000,0,0,0,0
.long 0x3f8ebf80,0x3ffb3fed,0x3ec83fb5,0xbfd5bf44,0,0,0,0
.long 0,0,0,0,0x3fb53f80,0xbfb50000,0xbfb5c000,0x3fb50000
.long 0,0,0,0,0x3f8e3f80,0xbffbbf44,0x3ec8bfb5,0x3fd53fed
.long 0,0,0,0,0xbfb53f80,0x3fb50000,0x3fb5c000,0xbfb50000
.long 0,0,0,0,0xbfd53f80,0x3ec83f44,0x3ffbbfb5,0x3f8ebfed
.long 0,0,0,0,0xbfb53f80,0x3fb50000,0x3fb5c000,0xbfb50000
.long 0,0,0,0,0xbf8e3f80,0x3ffbbf44,0xbec8bfb5,0xbfd53fed
.long 0,0,0,0,0x3fb53f80,0xbfb50000,0xbfb5c000,0x3fb50000
.long 0,0,0,0,0x3fd53f80,0xbec83f44,0xbffbbfb5,0xbf8ebfed
.long 0,0,0,0,0xbfb53f80,0xbfb5c000,0x3fb50000,0x3fb54000
.long 0,0,0,0,0xbfd5bf80,0xbec8bfed,0x3ffb3fb5,0xbf8e3f44
.long 0,0,0,0,0xbfb53f80,0xbfb54000,0x3fb50000,0x3fb5c000
.long 0,0,0,0,0xbf8ebf80,0xbffb3fed,0xbec83fb5,0x3fd5bf44
.long 0,0,0,0,0x3fb53f80,0x3fb5c000,0xbfb50000,0xbfb54000
.long 0,0,0,0,0x3fd5bf80,0x3ec8bfed,0xbffb3fb5,0x3f8e3f44
.long 0,0,0,0,0x3fb53f80,0x3fb54000,0xbfb50000,0xbfb5c000
.long 0,0,0,0,0x3f8ebf80,0x3ffb3fed,0x3ec83fb5,0xbfd5bf44
.long 0x3fb54000,0xbfb50000,0xbfb5c000,0x3fb50000,0,0,0,0
.long 0xbfd50000,0xbec8bfed,0x3ffb3fb5,0xbf8e3f44,0,0,0,0
.long 0xbfb54000,0x3fb50000,0x3fb5c000,0xbfb50000,0,0,0,0
.long 0xbf8e0000,0xbffb3fed,0xbec83fb5,0x3fd5bf44,0,0,0,0
.long 0xbfb54000,0x3fb50000,0x3fb5c000,0xbfb50000,0,0,0,0
.long 0x3fd50000,0x3ec8bfed,0xbffb3fb5,0x3f8e3f44,0,0,0,0
.long 0x3fb54000,0xbfb50000,0xbfb5c000,0x3fb50000,0,0,0,0
.long 0x3f8e0000,0x3ffb3fed,0x3ec83fb5,0xbfd5bf44,0,0,0,0
.long 0xbfb50000,0xbfb5c000,0x3fb50000,0x3fb54000,0,0,0,0
.long 0xbf8ec000,0x3ffb3f44,0xbec83fb5,0xbfd5bfed,0,0,0,0
.long 0xbfb50000,0xbfb54000,0x3fb50000,0x3fb5c000,0,0,0,0
.long 0x3fd5c000,0xbec8bf44,0xbffb3fb5,0xbf8e3fed,0,0,0,0
.long 0x3fb50000,0x3fb5c000,0xbfb50000,0xbfb54000,0,0,0,0
.long 0x3f8ec000,0xbffb3f44,0x3ec83fb5,0x3fd5bfed,0,0,0,0
.long 0x3fb50000,0x3fb54000,0xbfb50000,0xbfb5c000,0,0,0,0
.long 0xbfd5c000,0x3ec8bf44,0x3ffb3fb5,0x3f8e3fed,0,0,0,0
.long 0,0,0,0,0x3fb54000,0xbfb50000,0xbfb5c000,0x3fb50000
.long 0,0,0,0,0xbfd50000,0xbec8bfed,0x3ffb3fb5,0xbf8e3f44
.long 0,0,0,0,0xbfb54000,0x3fb50000,0x3fb5c000,0xbfb50000
.long 0,0,0,0,0xbf8e0000,0xbffb3fed,0xbec83fb5,0x3fd5bf44
.long 0,0,0,0,0xbfb54000,0x3fb50000,0x3fb5c000,0xbfb50000
.long 0,0,0,0,0x3fd50000,0x3ec8bfed,0xbffb3fb5,0x3f8e3f44
.long 0,0,0,0,0x3fb54000,0xbfb50000,0xbfb5c000,0x3fb50000
.long 0,0,0,0,0x3f8e0000,0x3ffb3fed,0x3ec83fb5,0xbfd5bf44
.long 0,0,0,0,0xbfb50000,0xbfb5c000,0x3fb50000,0x3fb54000
.long 0,0,0,0,0xbf8ec000,0x3ffb3f44,0xbec83fb5,0xbfd5bfed
.long 0,0,0,0,0xbfb50000,0xbfb54000,0x3fb50000,0x3fb5c000
.long 0,0,0,0,0x3fd5c000,0xbec8bf44,0xbffb3fb5,0xbf8e3fed
.long 0,0,0,0,0x3fb50000,0x3fb5c000,0xbfb50000,0xbfb54000
.long 0,0,0,0,0x3f8ec000,0xbffb3f44,0x3ec83fb5,0x3fd5bfed
.long 0,0,0,0,0x3fb50000,0x3fb54000,0xbfb50000,0xbfb5c000
.long 0,0,0,0,0xbfd5c000,0x3ec8bf44,0x3ffb3fb5,0x3f8e3fed
.long 0x3f443f80,0xbfedbfb5,0x3fed0000,0xbf443fb5,0,0,0,0
.long 0x3ec83f80,0xbf8ebfed,0x3fd53fb5,0xbffbbf44,0,0,0,0
.long 0xbfed3f80,0xbf443fb5,0x3f440000,0x3fedbfb5,0,0,0,0
.long 0xbffb3f80,0xbfd53fed,0xbf8e3fb5,0xbec83f44,0,0,0,0
.long 0xbf443f80,0x3fedbfb5,0xbfed0000,0x3f443fb5,0,0,0,0
.long 0xbec83f80,0x3f8ebfed,0xbfd53fb5,0x3ffbbf44,0,0,0,0
.long 0x3fed3f80,0x3f443fb5,0xbf440000,0xbfedbfb5,0,0,0,0
.long 0x3ffb3f80,0x3fd53fed,0x3f8e3fb5,0x3ec83f44,0,0,0,0
.long 0xbfed3f80,0x3f44bfb5,0x3f444000,0xbfedbfb5,0,0,0,0
.long 0xbffbbf80,0x3fd5bf44,0xbf8e3fb5,0x3ec8bfed,0,0,0,0
.long 0xbf443f80,0xbfed3fb5,0xbfed4000,0xbf443fb5,0,0,0,0
.long 0xbec8bf80,0xbf8e3f44,0xbfd53fb5,0xbffb3fed,0,0,0,0
.long 0x3fed3f80,0xbf44bfb5,0xbf444000,0x3fedbfb5,0,0,0,0
.long 0x3ffbbf80,0xbfd5bf44,0x3f8e3fb5,0xbec8bfed,0,0,0,0
.long 0x3f443f80,0x3fed3fb5,0x3fed4000,0x3f443fb5,0,0,0,0
.long 0x3ec8bf80,0x3f8e3f44,0x3fd53fb5,0x3ffb3fed,0,0,0,0
.long 0,0,0,0,0x3f443f80,0xbfedbfb5,0x3fed0000,0xbf443fb5
.long 0,0,0,0,0x3ec83f80,0xbf8ebfed,0x3fd53fb5,0xbffbbf44
.long 0,0,0,0,0xbfed3f80,0xbf443fb5,0x3f440000,0x3fedbfb5
.long 0,0,0,0,0xbffb3f80,0xbfd53fed,0xbf8e3fb5,0xbec83f44
.long 0,0,0,0,0xbf443f80,0x3fedbfb5,0xbfed0000,0x3f443fb5
.long 0,0,0,0,0xbec83f80,0x3f8ebfed,0xbfd53fb5,0x3ffbbf44
.long 0,0,0,0,0x3fed3f80,0x3f443fb5,0xbf440000,0xbfedbfb5
.long 0,0,0,0,0x3ffb3f80,0x3fd53fed,0x3f8e3fb5,0x3ec83f44
.long 0,0,0,0,0xbfed3f80,0x3f44bfb5,0x3f444000,0xbfedbfb5
.long 0,0,0,0,0xbffbbf80,0x3fd5bf44,0xbf8e3fb5,0x3ec8bfed
.long 0,0,0,0,0xbf443f80,0xbfed3fb5,0xbfed4000,0xbf443fb5
.long 0,0,0,0,0xbec8bf80,0xbf8e3f44,0xbfd53fb5,0xbffb3fed
.long 0,0,0,0,0x3fed3f80,0xbf44bfb5,0xbf444000,0x3fedbfb5
.long 0,0,0,0,0x3ffbbf80,0xbfd5bf44,0x3f8e3fb5,0xbec8bfed
.long 0,0,0,0,0x3f443f80,0x3fed3fb5,0x3fed4000,0x3f443fb5
.long 0,0,0,0,0x3ec8bf80,0x3f8e3f44,0x3fd53fb5,0x3ffb3fed
.long 0xbf44c000,0x3fed3fb5,0xbfed0000,0x3f44bfb5,0,0,0,0
.long 0x3ffb0000,0xbfd53f44,0x3f8ebfb5,0xbec83fed,0,0,0,0
.long 0x3fedc000,0x3f44bfb5,0xbf440000,0xbfed3fb5,0,0,0,0
.long 0x3ec80000,0x3f8ebf44,0x3fd5bfb5,0x3ffbbfed,0,0,0,0
.long 0x3f44c000,0xbfed3fb5,0x3fed0000,0xbf44bfb5,0,0,0,0
.long 0xbffb0000,0x3fd53f44,0xbf8ebfb5,0x3ec83fed,0,0,0,0
.long 0xbfedc000,0xbf44bfb5,0x3f440000,0x3fed3fb5,0,0,0,0
.long 0xbec80000,0xbf8ebf44,0xbfd5bfb5,0xbffbbfed,0,0,0,0
.long 0x3fed0000,0xbf443fb5,0xbf44c000,0x3fed3fb5,0,0,0,0
.long 0x3ec84000,0xbf8ebfed,0x3fd53fb5,0xbffbbf44,0,0,0,0
.long 0x3f440000,0x3fedbfb5,0x3fedc000,0x3f44bfb5,0,0,0,0
.long 0xbffb4000,0xbfd53fed,0xbf8e3fb5,0xbec83f44,0,0,0,0
.long 0xbfed0000,0x3f443fb5,0x3f44c000,0xbfed3fb5,0,0,0,0
.long 0xbec84000,0x3f8ebfed,0xbfd53fb5,0x3ffbbf44,0,0,0,0
.long 0xbf440000,0xbfedbfb5,0xbfedc000,0xbf44bfb5,0,0,0,0
.long 0x3ffb4000,0x3fd53fed,0x3f8e3fb5,0x3ec83f44,0,0,0,0
.long 0,0,0,0,0xbf44c000,0x3fed3fb5,0xbfed0000,0x3f44bfb5
.long 0,0,0,0,0x3ffb0000,0xbfd53f44,0x3f8ebfb5,0xbec83fed
.long 0,0,0,0,0x3fedc000,0x3f44bfb5,0xbf440000,0xbfed3fb5
.long 0,0,0,0,0x3ec80000,0x3f8ebf44,0x3fd5bfb5,0x3ffbbfed
.long 0,0,0,0,0x3f44c000,0xbfed3fb5,0x3fed0000,0xbf44bfb5
.long 0,0,0,0,0xbffb0000,0x3fd53f44,0xbf8ebfb5,0x3ec83fed
.long 0,0,0,0,0xbfedc000,0xbf44bfb5,0x3f440000,0x3fed3fb5
.long 0,0,0,0,0xbec80000,0xbf8ebf44,0xbfd5bfb5,0xbffbbfed
.long 0,0,0,0,0x3fed0000,0xbf443fb5,0xbf44c000,0x3fed3fb5
.long 0,0,0,0,0x3ec84000,0xbf8ebfed,0x3fd53fb5,0xbffbbf44
.long 0,0,0,0,0x3f440000,0x3fedbfb5,0x3fedc000,0x3f44bfb5
.long 0,0,0,0,0xbffb4000,0xbfd53fed,0xbf8e3fb5,0xbec83f44
.long 0,0,0,0,0xbfed0000,0x3f443fb5,0x3f44c000,0xbfed3fb5
.long 0,0,0,0,0xbec84000,0x3f8ebfed,0xbfd53fb5,0x3ffbbf44
.long 0,0,0,0,0xbf440000,0xbfedbfb5,0xbfedc000,0xbf44bfb5
.long 0,0,0,0,0x3ffb4000,0x3fd53fed,0x3f8e3fb5,0x3ec83f44
.size const_tbl, 40960
.section .rodata,"a"
.p2align 6
.amdhsa_kernel adaLN_cond__spectral_gfnet__dense_activation_silu__prompt_kernel
  .amdhsa_next_free_vgpr 512
  .amdhsa_next_free_sgpr 102
  .amdhsa_accum_offset 256
  .amdhsa_group_segment_fixed_size 0
  .amdhsa_kernarg_size 88
  .amdhsa_user_sgpr_count 2
  .amdhsa_user_sgpr_kernarg_segment_ptr 1
  .amdhsa_system_sgpr_workgroup_id_x 1
.end_amdhsa_kernel
```
